```python
import torch

def _softmax(x, axis=-1):
    return torch.softmax(x, dim=axis)
def _gelu(x):
    return torch.nn.functional.gelu(x, approximate="tanh")
def _silu(x):
    return torch.nn.functional.silu(x)
def _sigmoid(x):
    return torch.sigmoid(x)
def _layernorm(x, axis=-1, eps=1e-5):
    m = x.mean(dim=axis, keepdim=True)
    v = x.var(dim=axis, keepdim=True, unbiased=False)
    return (x - m) / torch.sqrt(v + eps)
def _scatter_add(tgt, idx, src, axis=0):
    return tgt.clone().index_add_(axis, idx, src)
def _segment_sum(src, seg, n):
    out = torch.zeros((n,) + src.shape[1:], dtype=src.dtype)
    return out.index_add_(0, seg, src)
def _pad(x, pw):
    flat = tuple(v for pair in reversed(pw) for v in pair)
    return torch.nn.functional.pad(x, flat)

kernel_name = 'interleave_layers__mha_block__dense_activation_relu__prompt'

def setup_inputs():

    _w = (lambda a: (lambda t: t.to(torch.bfloat16) if t.is_floating_point() else t)(torch.as_tensor(a)))
    def _A_setup():
        B, S, D, H = 1, 2048, 448, 16
        return {
            "x": _w((lambda *s: torch.randn(*s, dtype=torch.bfloat16) * 0.05)(B, S, D)),
            "wqkv": _w((lambda *s: torch.randn(*s, dtype=torch.bfloat16) * 0.05)(D, 3 * D)),
            "wo": _w((lambda *s: torch.randn(*s, dtype=torch.bfloat16) * 0.05)(D, D)),
        }
    _A_in = _A_setup()

    def _B_setup():
        B, S, D, Dff = 1, 2048, 448, 1792
        return {
            "x": _w((lambda *s: torch.randn(*s, dtype=torch.bfloat16) * 0.05)(B, S, D)),
            "w1": _w((lambda *s: torch.randn(*s, dtype=torch.bfloat16) * 0.05)(D, Dff)),
            "w2": _w((lambda *s: torch.randn(*s, dtype=torch.bfloat16) * 0.05)(Dff, D)),
        }
    _B_in = _B_setup()

    return {
        "A_x": _A_in["x"],
        "A_wqkv": _A_in["wqkv"],
        "A_wo": _A_in["wo"],
        "B_x": _B_in["x"],
        "B_w1": _B_in["w1"],
        "B_w2": _B_in["w2"],
    }

def reference(A_x, A_wqkv, A_wo, B_x, B_w1, B_w2):
    def _A_ref(x, wqkv, wo):
        B, S, D = x.shape
        H = 16
        Dh = D // H
        qkv = (lambda x, *d: x.permute(*d))((x @ wqkv).reshape(B, S, 3, H, Dh), 2, 0, 3, 1, 4)
        q, k, v = qkv[0], qkv[1], qkv[2]
        scores = torch.einsum("bhqd,bhkd->bhqk", q, k) * (Dh ** -0.5)
        p = _softmax(scores, axis=-1)
        o = torch.einsum("bhqk,bhkd->bhqd", p, v)
        return (lambda x, *d: x.permute(*d))(o, 0, 2, 1, 3).reshape(B, S, D) @ wo

    def _B_ref(x, w1, w2):
        h = torch.einsum("bsd,df->bsf", x, w1)
        zero = torch.zeros_like(h)
        h = torch.maximum(h, zero)
        return torch.einsum("bsf,fd->bsd", h, w2)

    x = A_x
    x = x + _A_ref(_layernorm(x, axis=-1), A_wqkv, A_wo)
    x = x + _B_ref(_layernorm(x, axis=-1), B_w1, B_w2)
    x = x + _A_ref(_layernorm(x, axis=-1), A_wqkv, A_wo)
    x = x + _B_ref(_layernorm(x, axis=-1), B_w1, B_w2)
    return x
```

```asm
; @launch grid=(256,1,1) block=(256,1,1) lds=163840
.amdgcn_target "amdgcn-amd-amdhsa--gfx950"
.text
.globl interleave_layers__mha_block__dense_activation_relu__prompt_kernel
.p2align 8
.type interleave_layers__mha_block__dense_activation_relu__prompt_kernel,@function
interleave_layers__mha_block__dense_activation_relu__prompt_kernel:
  s_cmp_ge_u32 s2, 256
  s_cbranch_scc1 mk_end
  s_load_dwordx16 s[76:91], s[0:1], 0
  s_load_dwordx2 s[92:93], s[0:1], 64
  v_lshrrev_b32 v4, 6, v0
  v_and_b32 v1, 63, v0
  v_readfirstlane_b32 s20, v4
  v_and_b32 v2, 31, v1
  v_lshrrev_b32 v3, 5, v1
  v_lshlrev_b32 v1, 4, v1
  s_getreg_b32 s19, hwreg(HW_REG_XCC_ID, 0, 4)
  s_and_b32 s21, s2, 7
  s_lshr_b32 s22, s2, 3
  s_lshl_b32 s23, s21, 1
  s_and_b32 s30, s22, 1
  s_add_u32 s23, s23, s30
  s_lshr_b32 s24, s22, 1
  s_lshl_b32 s30, s30, 2
  s_add_u32 s25, s30, s20
  s_and_b32 s31, s22, 2
  s_add_u32 s30, s30, s31
  s_lshr_b32 s31, s20, 1
  s_add_u32 s26, s30, s31
  s_xor_b32 s27, s26, 1
  s_lshr_b32 s30, s22, 2
  s_lshl_b32 s30, s30, 1
  s_and_b32 s31, s20, 1
  s_add_u32 s28, s30, s31
  s_xor_b32 s29, s28, 1
  s_mov_b32 s16, 0
  s_lshl_b32 s18, s21, 21
  s_add_u32 s18, s18, 16777216
  s_mov_b32 s57, s18
  s_mov_b32 s47, 8388608
  s_mov_b32 s48, 3801088
  s_mov_b64 s[52:53], -1
  s_mov_b32 s17, 0
  s_waitcnt lgkmcnt(0)
  s_mov_b32 s4, s92
  s_mov_b32 s5, s93
  s_mov_b32 s6, 0x10000000
  s_mov_b32 s7, 0x00020000
  s_mov_b32 s12, s78
  s_mov_b32 s13, s79
  s_mov_b32 s14, 0x126000
  s_mov_b32 s15, 0x00020000
  s_mov_b32 s96, s76
  s_mov_b32 s97, s77
  s_mov_b32 s98, 0x1c0000
  s_mov_b32 s99, 0x00020000
  s_add_u32 s92, s92, 3796992
  s_addc_u32 s93, s93, 0
  s_load_dwordx2 s[58:59], s[92:93], 0
  s_lshl_b32 s32, s22, 2
  s_add_u32 s32, s32, s20
  v_lshrrev_b32 v4, 8, v1
  v_mul_u32_u24 v4, 2688, v4
  v_lshlrev_b32 v5, 3, v1
  v_and_b32 v5, 0x780, v5
  v_add_u32 v4, v4, v5
  s_mul_i32 s30, s32, 10752
  s_add_u32 s31, s30, 896
  buffer_load_dword v62, v4, s[12:15], s31 offen
  v_lshlrev_b32 v5, 3, v1
  s_mov_b64 exec, 0x3fff
  s_mul_i32 s31, s21, 229376
  s_mul_i32 s35, s32, 1792
  s_add_u32 s31, s31, s35
  buffer_load_dword v62, v5, s[96:99], s31 offen
  s_mov_b64 exec, -1
  v_lshrrev_b32 v57, 7, v1
  v_mul_u32_u24 v57, 896, v57
  v_lshrrev_b32 v5, 4, v1
  v_and_b32 v5, 48, v5
  v_and_b32 v7, 0x70, v1
  v_xor_b32 v5, v5, v7
  v_add_u32 v60, v57, v5
  v_xor_b32 v5, 64, v5
  v_add_u32 v61, v57, v5
  v_lshrrev_b32 v56, 6, v1
  v_mul_u32_u24 v56, 2688, v56
  v_and_b32 v4, 48, v1
  v_add_u32 v56, v56, v4
  s_mul_i32 s40, s21, 229376
  s_mul_i32 s35, s25, 28672
  s_add_u32 s40, s40, s35
  s_mul_i32 s41, s20, 28672
  s_add_u32 s41, s41, 49152
  s_mul_i32 s42, s20, 43008
  s_mul_i32 s35, s24, 56
  s_add_u32 s42, s42, s35
  s_add_u32 s42, s42, 896
  s_lshl_b32 s44, s20, 11
  s_add_u32 m0, s44, 0
  s_add_u32 s35, s42, 0
  buffer_load_dwordx4 v56, s[12:15], s35 offen lds
  s_add_u32 m0, s44, 1024
  s_add_u32 s35, s42, 896
  buffer_load_dwordx4 v56, s[12:15], s35 offen lds
  s_add_u32 m0, s41, 0
  s_add_u32 s35, s40, 0
  buffer_load_dwordx4 v60, s[96:99], s35 offen lds
  s_add_u32 m0, s41, 1024
  s_add_u32 s35, s40, 7168
  buffer_load_dwordx4 v61, s[96:99], s35 offen lds
  s_add_u32 m0, s41, 2048
  s_add_u32 s35, s40, 14336
  buffer_load_dwordx4 v60, s[96:99], s35 offen lds
  s_add_u32 m0, s41, 3072
  s_add_u32 s35, s40, 21504
  buffer_load_dwordx4 v61, s[96:99], s35 offen lds
  v_and_b32 v6, 0xc0, v1
  v_lshrrev_b32 v4, 3, v1
  v_and_b32 v4, 32, v4
  v_lshrrev_b32 v5, 1, v1
  v_and_b32 v5, 24, v5
  v_add3_u32 v6, v6, v4, v5
  v_lshlrev_b32 v4, 8, v3
  v_add_u32 v6, v6, v4
  v_add_u32 v0, 0x10000, v6
  v_add_u32 v63, 0x20000, v6
  v_add_u32 v254, s44, v6
  v_add_u32 v255, s41, v6
  v_lshlrev_b32 v104, 7, v2
  v_lshlrev_b32 v4, 3, v2
  v_and_b32 v4, 0x70, v4
  v_lshlrev_b32 v5, 3, v3
  v_add3_u32 v104, v104, v4, v5
  v_add_u32 v104, s41, v104
  v_mov_b32 v253, 0x3f803f80
  v_xor_b32 v105, 16, v104
  v_xor_b32 v106, 32, v104
  v_xor_b32 v107, 48, v104
  v_xor_b32 v108, 64, v104
  v_xor_b32 v109, 80, v104
  v_xor_b32 v110, 96, v104
  v_xor_b32 v111, 112, v104
  v_mov_b32 v240, 0
  v_mov_b32 v241, 0
  v_mov_b32 v242, 0
  v_mov_b32 v243, 0
  v_mov_b32 v250, 0
  v_mov_b32 v251, 0
  v_mov_b32 v252, 0
  s_add_u32 m0, s44, 8192
  s_add_u32 s35, s42, 172032
  buffer_load_dwordx4 v56, s[12:15], s35 offen lds
  s_add_u32 m0, s44, 9216
  s_add_u32 s35, s42, 172928
  buffer_load_dwordx4 v56, s[12:15], s35 offen lds
  s_add_u32 m0, s41, 4096
  s_add_u32 s35, s40, 128
  buffer_load_dwordx4 v60, s[96:99], s35 offen lds
  s_add_u32 m0, s41, 5120
  s_add_u32 s35, s40, 7296
  buffer_load_dwordx4 v61, s[96:99], s35 offen lds
  s_add_u32 m0, s41, 6144
  s_add_u32 s35, s40, 14464
  buffer_load_dwordx4 v60, s[96:99], s35 offen lds
  s_add_u32 m0, s41, 7168
  s_add_u32 s35, s40, 21632
  buffer_load_dwordx4 v61, s[96:99], s35 offen lds
  s_mov_b32 s8, s88
  s_mov_b32 s9, s89
  s_mov_b32 s10, 0x1c0000
  s_mov_b32 s11, 0x00020000
  s_mov_b32 s60, s84
  s_mov_b32 s61, s85
  s_mov_b32 s62, 0x188000
  s_mov_b32 s63, 0x00020000
  s_mul_i32 s49, s28, 114688
  s_mul_i32 s35, s20, 28672
  s_add_u32 s49, s49, s35
  s_add_u32 s49, s49, 1900544
  s_mul_i32 s50, s29, 114688
  s_mul_i32 s35, s20, 28672
  s_add_u32 s50, s50, s35
  s_add_u32 s50, s50, 1900544
  s_lshl_b32 s38, s24, 18
  s_lshl_b32 s35, s23, 14
  s_add_u32 s38, s38, s35
  s_lshl_b32 s35, s20, 12
  s_add_u32 s38, s38, s35
  s_add_u32 s38, s38, s47
  s_lshl_b32 s37, s24, 11
  s_lshl_b32 s35, s23, 7
  s_add_u32 s37, s37, s35
  s_add_u32 s37, s37, s48
  s_and_b32 s55, s24, 1
  s_lshl_b32 s55, s55, 4
  s_add_u32 s55, s55, s23
  s_lshl_b32 s55, s55, 2
  s_add_u32 s55, s55, s20
  s_sub_u32 s43, s42, 896
  s_getpc_b64 s[32:33]
mk_pc:
  s_lshl_b32 s30, s22, 2
  s_add_u32 s30, s30, s20
  s_mul_i32 s30, s30, 640
  v_lshlrev_b32 v4, 3, v1
  v_add_u32 v4, s30, v4
  v_min_u32 v4, mk_last-mk_pc, v4
  s_mov_b64 exec, 31
  global_load_dword v62, v4, s[32:33]
  s_mov_b64 exec, -1
  s_waitcnt lgkmcnt(0)
  s_mov_b64 s[92:93], s[80:81]
  s_mov_b64 s[100:101], s[86:87]
  s_mul_hi_u32 s30, s58, 0x4c957f2d
  s_mul_i32 s31, s59, 0x4c957f2d
  s_add_u32 s30, s30, s31
  s_mul_i32 s31, s58, 0x5851f42d
  s_add_u32 s30, s30, s31
  s_mul_i32 s58, s58, 0x4c957f2d
  s_add_u32 s58, s58, 0xf767814f
  s_addc_u32 s59, s30, 0x14057b7e
  s_waitcnt vmcnt(7)
  s_barrier
  ds_read_b64 v[128:129], v104 offset:0
  ds_read_b64 v[130:131], v105 offset:0
  ds_read_b64 v[132:133], v106 offset:0
  ds_read_b64 v[134:135], v107 offset:0
  ds_read_b64 v[136:137], v108 offset:0
  ds_read_b64 v[138:139], v109 offset:0
  ds_read_b64 v[140:141], v110 offset:0
  ds_read_b64 v[142:143], v111 offset:0
  ds_read_b64_tr_b16 v[96:97], v254 offset:0
  ds_read_b64_tr_b16 v[98:99], v254 offset:512
  ds_read_b64_tr_b16 v[100:101], v254 offset:1024
  ds_read_b64_tr_b16 v[102:103], v254 offset:1536
  ds_read_b64_tr_b16 a[64:65], v6 offset:0
  ds_read_b64_tr_b16 a[66:67], v6 offset:512
  ds_read_b64_tr_b16 a[68:69], v6 offset:1024
  s_waitcnt lgkmcnt(14)
  ds_read_b64_tr_b16 a[70:71], v6 offset:1536
  s_waitcnt lgkmcnt(14)
  ds_read_b64_tr_b16 a[72:73], v6 offset:2048
  s_waitcnt lgkmcnt(14)
  ds_read_b64_tr_b16 a[74:75], v6 offset:2560
  s_waitcnt lgkmcnt(14)
  ds_read_b64_tr_b16 a[76:77], v6 offset:3072
  s_waitcnt lgkmcnt(14)
  ds_read_b64_tr_b16 a[78:79], v6 offset:3584
  s_waitcnt lgkmcnt(14)
  ds_read_b64_tr_b16 a[80:81], v6 offset:4096
  s_waitcnt lgkmcnt(14)
  ds_read_b64_tr_b16 a[82:83], v6 offset:4608
  s_waitcnt lgkmcnt(14)
  ds_read_b64_tr_b16 a[84:85], v6 offset:5120
  s_waitcnt lgkmcnt(14)
  ds_read_b64_tr_b16 a[86:87], v6 offset:5632
  s_waitcnt lgkmcnt(14)
  ds_read_b64_tr_b16 a[88:89], v6 offset:6144
  s_waitcnt lgkmcnt(14)
  ds_read_b64_tr_b16 a[90:91], v6 offset:6656
  s_waitcnt lgkmcnt(14)
  ds_read_b64_tr_b16 a[92:93], v6 offset:7168
  s_waitcnt lgkmcnt(14)
  ds_read_b64_tr_b16 a[94:95], v6 offset:7680
  s_add_u32 m0, s44, 16384
  s_add_u32 s35, s42, 344064
  buffer_load_dwordx4 v56, s[12:15], s35 offen lds
  s_add_u32 m0, s44, 17408
  s_add_u32 s35, s42, 344960
  buffer_load_dwordx4 v56, s[12:15], s35 offen lds
  s_add_u32 m0, s41, 8192
  s_add_u32 s35, s40, 256
  buffer_load_dwordx4 v60, s[96:99], s35 offen lds
  s_add_u32 m0, s41, 9216
  s_add_u32 s35, s40, 7424
  buffer_load_dwordx4 v61, s[96:99], s35 offen lds
  s_add_u32 m0, s41, 10240
  s_add_u32 s35, s40, 14592
  buffer_load_dwordx4 v60, s[96:99], s35 offen lds
  s_add_u32 m0, s41, 11264
  s_add_u32 s35, s40, 21760
  buffer_load_dwordx4 v61, s[96:99], s35 offen lds
  v_dot2c_f32_bf16 v240, v128, v253
  v_dot2c_f32_bf16 v241, v128, v128
  v_dot2c_f32_bf16 v242, v129, v253
  v_dot2c_f32_bf16 v243, v129, v129
  v_dot2c_f32_bf16 v240, v130, v253
  v_dot2c_f32_bf16 v241, v130, v130
  v_dot2c_f32_bf16 v242, v131, v253
  v_dot2c_f32_bf16 v243, v131, v131
  v_dot2c_f32_bf16 v240, v132, v253
  v_dot2c_f32_bf16 v241, v132, v132
  v_dot2c_f32_bf16 v242, v133, v253
  v_dot2c_f32_bf16 v243, v133, v133
  v_dot2c_f32_bf16 v240, v134, v253
  v_dot2c_f32_bf16 v241, v134, v134
  v_dot2c_f32_bf16 v242, v135, v253
  v_dot2c_f32_bf16 v243, v135, v135
  v_dot2c_f32_bf16 v240, v136, v253
  v_dot2c_f32_bf16 v241, v136, v136
  v_dot2c_f32_bf16 v242, v137, v253
  v_dot2c_f32_bf16 v243, v137, v137
  v_dot2c_f32_bf16 v240, v138, v253
  v_dot2c_f32_bf16 v241, v138, v138
  v_dot2c_f32_bf16 v242, v139, v253
  v_dot2c_f32_bf16 v243, v139, v139
  v_dot2c_f32_bf16 v240, v140, v253
  v_dot2c_f32_bf16 v241, v140, v140
  v_dot2c_f32_bf16 v242, v141, v253
  v_dot2c_f32_bf16 v243, v141, v141
  v_dot2c_f32_bf16 v240, v142, v253
  v_dot2c_f32_bf16 v241, v142, v142
  v_dot2c_f32_bf16 v242, v143, v253
  v_dot2c_f32_bf16 v243, v143, v143
  v_dot2c_f32_bf16 v250, v96, v253
  v_dot2c_f32_bf16 v250, v97, v253
  v_dot2c_f32_bf16 v250, v98, v253
  v_dot2c_f32_bf16 v250, v99, v253
  v_dot2c_f32_bf16 v251, v100, v253
  v_dot2c_f32_bf16 v251, v101, v253
  v_dot2c_f32_bf16 v251, v102, v253
  v_dot2c_f32_bf16 v251, v103, v253
  s_waitcnt vmcnt(7)
  s_barrier
  s_waitcnt lgkmcnt(0)
  v_mfma_f32_32x32x16_bf16 v[64:79], a[64:67], v[128:131], 0
  s_add_u32 m0, s44, 24576
  s_add_u32 s35, s42, 516096
  buffer_load_dwordx4 v56, s[12:15], s35 offen lds
  ds_read_b64 v[144:145], v104 offset:4096
  ds_read_b64 v[146:147], v105 offset:4096
  ds_read_b64 v[148:149], v106 offset:4096
  v_mfma_f32_32x32x16_bf16 v[80:95], v[128:131], a[68:71], 0
  s_add_u32 m0, s44, 25600
  s_add_u32 s35, s42, 516992
  buffer_load_dwordx4 v56, s[12:15], s35 offen lds
  ds_read_b64 v[150:151], v107 offset:4096
  ds_read_b64 v[152:153], v108 offset:4096
  ds_read_b64 v[154:155], v109 offset:4096
  v_mfma_f32_32x32x16_bf16 v[64:79], a[72:75], v[132:135], v[64:79]
  s_add_u32 m0, s41, 12288
  s_add_u32 s35, s40, 384
  buffer_load_dwordx4 v60, s[96:99], s35 offen lds
  ds_read_b64 v[156:157], v110 offset:4096
  ds_read_b64 v[158:159], v111 offset:4096
  ds_read_b64_tr_b16 v[96:97], v254 offset:8192
  ds_read_b64_tr_b16 v[98:99], v254 offset:8704
  v_mfma_f32_32x32x16_bf16 v[80:95], v[132:135], a[76:79], v[80:95]
  s_add_u32 m0, s41, 13312
  s_add_u32 s35, s40, 7552
  buffer_load_dwordx4 v61, s[96:99], s35 offen lds
  ds_read_b64_tr_b16 v[100:101], v254 offset:9216
  ds_read_b64_tr_b16 v[102:103], v254 offset:9728
  ds_read_b64_tr_b16 a[96:97], v6 offset:8192
  ds_read_b64_tr_b16 a[98:99], v6 offset:8704
  ds_read_b64_tr_b16 a[100:101], v6 offset:9216
  s_waitcnt lgkmcnt(14)
  ds_read_b64_tr_b16 a[102:103], v6 offset:9728
  v_mfma_f32_32x32x16_bf16 v[64:79], a[80:83], v[136:139], v[64:79]
  s_add_u32 m0, s41, 14336
  s_add_u32 s35, s40, 14720
  buffer_load_dwordx4 v60, s[96:99], s35 offen lds
  s_waitcnt lgkmcnt(14)
  ds_read_b64_tr_b16 a[104:105], v6 offset:10240
  s_waitcnt lgkmcnt(14)
  ds_read_b64_tr_b16 a[106:107], v6 offset:10752
  s_waitcnt lgkmcnt(14)
  ds_read_b64_tr_b16 a[108:109], v6 offset:11264
  s_waitcnt lgkmcnt(14)
  ds_read_b64_tr_b16 a[110:111], v6 offset:11776
  s_waitcnt lgkmcnt(14)
  ds_read_b64_tr_b16 a[112:113], v6 offset:12288
  s_waitcnt lgkmcnt(14)
  ds_read_b64_tr_b16 a[114:115], v6 offset:12800
  v_mfma_f32_32x32x16_bf16 v[80:95], v[136:139], a[84:87], v[80:95]
  s_add_u32 m0, s41, 15360
  s_add_u32 s35, s40, 21888
  buffer_load_dwordx4 v61, s[96:99], s35 offen lds
  s_waitcnt lgkmcnt(14)
  ds_read_b64_tr_b16 a[116:117], v6 offset:13312
  s_waitcnt lgkmcnt(14)
  ds_read_b64_tr_b16 a[118:119], v6 offset:13824
  s_waitcnt lgkmcnt(14)
  ds_read_b64_tr_b16 a[120:121], v6 offset:14336
  s_waitcnt lgkmcnt(14)
  ds_read_b64_tr_b16 a[122:123], v6 offset:14848
  s_waitcnt lgkmcnt(14)
  ds_read_b64_tr_b16 a[124:125], v6 offset:15360
  s_waitcnt lgkmcnt(14)
  ds_read_b64_tr_b16 a[126:127], v6 offset:15872
  v_mfma_f32_32x32x16_bf16 v[64:79], a[88:91], v[140:143], v[64:79]
  s_add_u32 m0, s44, 32768
  s_add_u32 s35, s42, 688128
  buffer_load_dwordx4 v56, s[12:15], s35 offen lds
  v_mfma_f32_32x32x16_bf16 v[80:95], v[140:143], a[92:95], v[80:95]
  s_add_u32 m0, s44, 33792
  s_add_u32 s35, s42, 689024
  buffer_load_dwordx4 v56, s[12:15], s35 offen lds
  v_dot2c_f32_bf16 v240, v144, v253
  v_dot2c_f32_bf16 v241, v144, v144
  v_dot2c_f32_bf16 v242, v145, v253
  v_dot2c_f32_bf16 v243, v145, v145
  v_dot2c_f32_bf16 v240, v146, v253
  v_dot2c_f32_bf16 v241, v146, v146
  v_dot2c_f32_bf16 v242, v147, v253
  v_dot2c_f32_bf16 v243, v147, v147
  v_dot2c_f32_bf16 v240, v148, v253
  v_dot2c_f32_bf16 v241, v148, v148
  v_dot2c_f32_bf16 v242, v149, v253
  v_dot2c_f32_bf16 v243, v149, v149
  v_dot2c_f32_bf16 v240, v150, v253
  v_dot2c_f32_bf16 v241, v150, v150
  v_dot2c_f32_bf16 v242, v151, v253
  v_dot2c_f32_bf16 v243, v151, v151
  v_dot2c_f32_bf16 v240, v152, v253
  v_dot2c_f32_bf16 v241, v152, v152
  v_dot2c_f32_bf16 v242, v153, v253
  v_dot2c_f32_bf16 v243, v153, v153
  v_dot2c_f32_bf16 v240, v154, v253
  v_dot2c_f32_bf16 v241, v154, v154
  v_dot2c_f32_bf16 v242, v155, v253
  v_dot2c_f32_bf16 v243, v155, v155
  v_dot2c_f32_bf16 v240, v156, v253
  v_dot2c_f32_bf16 v241, v156, v156
  v_dot2c_f32_bf16 v242, v157, v253
  v_dot2c_f32_bf16 v243, v157, v157
  v_dot2c_f32_bf16 v240, v158, v253
  v_dot2c_f32_bf16 v241, v158, v158
  v_dot2c_f32_bf16 v242, v159, v253
  v_dot2c_f32_bf16 v243, v159, v159
  v_dot2c_f32_bf16 v250, v96, v253
  v_dot2c_f32_bf16 v250, v97, v253
  v_dot2c_f32_bf16 v250, v98, v253
  v_dot2c_f32_bf16 v250, v99, v253
  v_dot2c_f32_bf16 v251, v100, v253
  v_dot2c_f32_bf16 v251, v101, v253
  v_dot2c_f32_bf16 v251, v102, v253
  v_dot2c_f32_bf16 v251, v103, v253
  s_waitcnt vmcnt(8)
  s_barrier
  s_waitcnt lgkmcnt(0)
  v_mfma_f32_32x32x16_bf16 v[64:79], a[96:99], v[144:147], v[64:79]
  s_add_u32 m0, s41, 16384
  s_add_u32 s35, s40, 512
  buffer_load_dwordx4 v60, s[96:99], s35 offen lds
  ds_read_b64 v[160:161], v104 offset:8192
  ds_read_b64 v[162:163], v105 offset:8192
  ds_read_b64 v[164:165], v106 offset:8192
  v_mfma_f32_32x32x16_bf16 v[80:95], v[144:147], a[100:103], v[80:95]
  s_add_u32 m0, s41, 17408
  s_add_u32 s35, s40, 7680
  buffer_load_dwordx4 v61, s[96:99], s35 offen lds
  ds_read_b64 v[166:167], v107 offset:8192
  ds_read_b64 v[168:169], v108 offset:8192
  ds_read_b64 v[170:171], v109 offset:8192
  v_mfma_f32_32x32x16_bf16 v[64:79], a[104:107], v[148:151], v[64:79]
  s_add_u32 m0, s41, 18432
  s_add_u32 s35, s40, 14848
  buffer_load_dwordx4 v60, s[96:99], s35 offen lds
  ds_read_b64 v[172:173], v110 offset:8192
  ds_read_b64 v[174:175], v111 offset:8192
  ds_read_b64_tr_b16 v[96:97], v254 offset:16384
  ds_read_b64_tr_b16 v[98:99], v254 offset:16896
  v_mfma_f32_32x32x16_bf16 v[80:95], v[148:151], a[108:111], v[80:95]
  s_add_u32 m0, s41, 19456
  s_add_u32 s35, s40, 22016
  buffer_load_dwordx4 v61, s[96:99], s35 offen lds
  ds_read_b64_tr_b16 v[100:101], v254 offset:17408
  ds_read_b64_tr_b16 v[102:103], v254 offset:17920
  ds_read_b64_tr_b16 a[64:65], v6 offset:16384
  ds_read_b64_tr_b16 a[66:67], v6 offset:16896
  ds_read_b64_tr_b16 a[68:69], v6 offset:17408
  s_waitcnt lgkmcnt(14)
  ds_read_b64_tr_b16 a[70:71], v6 offset:17920
  v_mfma_f32_32x32x16_bf16 v[64:79], a[112:115], v[152:155], v[64:79]
  s_add_u32 m0, s44, 40960
  s_add_u32 s35, s42, 860160
  buffer_load_dwordx4 v56, s[12:15], s35 offen lds
  s_waitcnt lgkmcnt(14)
  ds_read_b64_tr_b16 a[72:73], v6 offset:18432
  s_waitcnt lgkmcnt(14)
  ds_read_b64_tr_b16 a[74:75], v6 offset:18944
  s_waitcnt lgkmcnt(14)
  ds_read_b64_tr_b16 a[76:77], v6 offset:19456
  s_waitcnt lgkmcnt(14)
  ds_read_b64_tr_b16 a[78:79], v6 offset:19968
  s_waitcnt lgkmcnt(14)
  ds_read_b64_tr_b16 a[80:81], v6 offset:20480
  s_waitcnt lgkmcnt(14)
  ds_read_b64_tr_b16 a[82:83], v6 offset:20992
  v_mfma_f32_32x32x16_bf16 v[80:95], v[152:155], a[116:119], v[80:95]
  s_add_u32 m0, s44, 41984
  s_add_u32 s35, s42, 861056
  buffer_load_dwordx4 v56, s[12:15], s35 offen lds
  s_waitcnt lgkmcnt(14)
  ds_read_b64_tr_b16 a[84:85], v6 offset:21504
  s_waitcnt lgkmcnt(14)
  ds_read_b64_tr_b16 a[86:87], v6 offset:22016
  s_waitcnt lgkmcnt(14)
  ds_read_b64_tr_b16 a[88:89], v6 offset:22528
  s_waitcnt lgkmcnt(14)
  ds_read_b64_tr_b16 a[90:91], v6 offset:23040
  s_waitcnt lgkmcnt(14)
  ds_read_b64_tr_b16 a[92:93], v6 offset:23552
  s_waitcnt lgkmcnt(14)
  ds_read_b64_tr_b16 a[94:95], v6 offset:24064
  v_mfma_f32_32x32x16_bf16 v[64:79], a[120:123], v[156:159], v[64:79]
  s_add_u32 m0, s41, 20480
  s_add_u32 s35, s40, 640
  buffer_load_dwordx4 v60, s[96:99], s35 offen lds
  v_mfma_f32_32x32x16_bf16 v[80:95], v[156:159], a[124:127], v[80:95]
  s_add_u32 m0, s41, 21504
  s_add_u32 s35, s40, 7808
  buffer_load_dwordx4 v61, s[96:99], s35 offen lds
  v_dot2c_f32_bf16 v240, v160, v253
  v_dot2c_f32_bf16 v241, v160, v160
  v_dot2c_f32_bf16 v242, v161, v253
  v_dot2c_f32_bf16 v243, v161, v161
  v_dot2c_f32_bf16 v240, v162, v253
  v_dot2c_f32_bf16 v241, v162, v162
  v_dot2c_f32_bf16 v242, v163, v253
  v_dot2c_f32_bf16 v243, v163, v163
  v_dot2c_f32_bf16 v240, v164, v253
  v_dot2c_f32_bf16 v241, v164, v164
  v_dot2c_f32_bf16 v242, v165, v253
  v_dot2c_f32_bf16 v243, v165, v165
  v_dot2c_f32_bf16 v240, v166, v253
  v_dot2c_f32_bf16 v241, v166, v166
  v_dot2c_f32_bf16 v242, v167, v253
  v_dot2c_f32_bf16 v243, v167, v167
  v_dot2c_f32_bf16 v240, v168, v253
  v_dot2c_f32_bf16 v241, v168, v168
  v_dot2c_f32_bf16 v242, v169, v253
  v_dot2c_f32_bf16 v243, v169, v169
  v_dot2c_f32_bf16 v240, v170, v253
  v_dot2c_f32_bf16 v241, v170, v170
  v_dot2c_f32_bf16 v242, v171, v253
  v_dot2c_f32_bf16 v243, v171, v171
  v_dot2c_f32_bf16 v240, v172, v253
  v_dot2c_f32_bf16 v241, v172, v172
  v_dot2c_f32_bf16 v242, v173, v253
  v_dot2c_f32_bf16 v243, v173, v173
  v_dot2c_f32_bf16 v240, v174, v253
  v_dot2c_f32_bf16 v241, v174, v174
  v_dot2c_f32_bf16 v242, v175, v253
  v_dot2c_f32_bf16 v243, v175, v175
  v_dot2c_f32_bf16 v250, v96, v253
  v_dot2c_f32_bf16 v250, v97, v253
  v_dot2c_f32_bf16 v250, v98, v253
  v_dot2c_f32_bf16 v250, v99, v253
  v_dot2c_f32_bf16 v251, v100, v253
  v_dot2c_f32_bf16 v251, v101, v253
  v_dot2c_f32_bf16 v251, v102, v253
  v_dot2c_f32_bf16 v251, v103, v253
  s_waitcnt vmcnt(10)
  s_barrier
  s_waitcnt lgkmcnt(0)
  v_mfma_f32_32x32x16_bf16 v[64:79], a[64:67], v[160:163], v[64:79]
  s_add_u32 m0, s41, 22528
  s_add_u32 s35, s40, 14976
  buffer_load_dwordx4 v60, s[96:99], s35 offen lds
  ds_read_b64 v[176:177], v104 offset:12288
  ds_read_b64 v[178:179], v105 offset:12288
  ds_read_b64 v[180:181], v106 offset:12288
  v_mfma_f32_32x32x16_bf16 v[80:95], v[160:163], a[68:71], v[80:95]
  s_add_u32 m0, s41, 23552
  s_add_u32 s35, s40, 22144
  buffer_load_dwordx4 v61, s[96:99], s35 offen lds
  ds_read_b64 v[182:183], v107 offset:12288
  ds_read_b64 v[184:185], v108 offset:12288
  ds_read_b64 v[186:187], v109 offset:12288
  v_mfma_f32_32x32x16_bf16 v[64:79], a[72:75], v[164:167], v[64:79]
  s_add_u32 m0, s41, 24576
  s_add_u32 s35, s40, 768
  buffer_load_dwordx4 v60, s[96:99], s35 offen lds
  ds_read_b64 v[188:189], v110 offset:12288
  ds_read_b64 v[190:191], v111 offset:12288
  ds_read_b64_tr_b16 v[96:97], v254 offset:24576
  ds_read_b64_tr_b16 v[98:99], v254 offset:25088
  v_mfma_f32_32x32x16_bf16 v[80:95], v[164:167], a[76:79], v[80:95]
  s_add_u32 m0, s41, 25600
  s_add_u32 s35, s40, 7936
  buffer_load_dwordx4 v61, s[96:99], s35 offen lds
  ds_read_b64_tr_b16 v[100:101], v254 offset:25600
  ds_read_b64_tr_b16 v[102:103], v254 offset:26112
  ds_read_b64_tr_b16 a[96:97], v6 offset:24576
  ds_read_b64_tr_b16 a[98:99], v6 offset:25088
  ds_read_b64_tr_b16 a[100:101], v6 offset:25600
  s_waitcnt lgkmcnt(14)
  ds_read_b64_tr_b16 a[102:103], v6 offset:26112
  v_mfma_f32_32x32x16_bf16 v[64:79], a[80:83], v[168:171], v[64:79]
  s_add_u32 m0, s41, 26624
  s_add_u32 s35, s40, 15104
  buffer_load_dwordx4 v60, s[96:99], s35 offen lds
  s_waitcnt lgkmcnt(14)
  ds_read_b64_tr_b16 a[104:105], v6 offset:26624
  s_waitcnt lgkmcnt(14)
  ds_read_b64_tr_b16 a[106:107], v6 offset:27136
  s_waitcnt lgkmcnt(14)
  ds_read_b64_tr_b16 a[108:109], v6 offset:27648
  s_waitcnt lgkmcnt(14)
  ds_read_b64_tr_b16 a[110:111], v6 offset:28160
  s_waitcnt lgkmcnt(14)
  ds_read_b64_tr_b16 a[112:113], v6 offset:28672
  s_waitcnt lgkmcnt(14)
  ds_read_b64_tr_b16 a[114:115], v6 offset:29184
  v_mfma_f32_32x32x16_bf16 v[80:95], v[168:171], a[84:87], v[80:95]
  s_add_u32 m0, s41, 27648
  s_add_u32 s35, s40, 22272
  buffer_load_dwordx4 v61, s[96:99], s35 offen lds
  s_waitcnt lgkmcnt(14)
  ds_read_b64_tr_b16 a[116:117], v6 offset:29696
  s_waitcnt lgkmcnt(14)
  ds_read_b64_tr_b16 a[118:119], v6 offset:30208
  s_waitcnt lgkmcnt(14)
  ds_read_b64_tr_b16 a[120:121], v6 offset:30720
  s_waitcnt lgkmcnt(14)
  ds_read_b64_tr_b16 a[122:123], v6 offset:31232
  s_waitcnt lgkmcnt(14)
  ds_read_b64_tr_b16 a[124:125], v6 offset:31744
  s_waitcnt lgkmcnt(14)
  ds_read_b64_tr_b16 a[126:127], v6 offset:32256
  v_mfma_f32_32x32x16_bf16 v[64:79], a[88:91], v[172:175], v[64:79]
  s_add_u32 m0, s41, 0
  s_add_u32 s35, s42, 1032192
  buffer_load_dwordx4 v56, s[12:15], s35 offen lds
  v_mfma_f32_32x32x16_bf16 v[80:95], v[172:175], a[92:95], v[80:95]
  s_add_u32 m0, s41, 1024
  s_add_u32 s35, s42, 1033088
  buffer_load_dwordx4 v56, s[12:15], s35 offen lds
  v_dot2c_f32_bf16 v240, v176, v253
  v_dot2c_f32_bf16 v241, v176, v176
  v_dot2c_f32_bf16 v242, v177, v253
  v_dot2c_f32_bf16 v243, v177, v177
  v_dot2c_f32_bf16 v240, v178, v253
  v_dot2c_f32_bf16 v241, v178, v178
  v_dot2c_f32_bf16 v242, v179, v253
  v_dot2c_f32_bf16 v243, v179, v179
  v_dot2c_f32_bf16 v240, v180, v253
  v_dot2c_f32_bf16 v241, v180, v180
  v_dot2c_f32_bf16 v242, v181, v253
  v_dot2c_f32_bf16 v243, v181, v181
  v_dot2c_f32_bf16 v240, v182, v253
  v_dot2c_f32_bf16 v241, v182, v182
  v_dot2c_f32_bf16 v242, v183, v253
  v_dot2c_f32_bf16 v243, v183, v183
  v_dot2c_f32_bf16 v240, v184, v253
  v_dot2c_f32_bf16 v241, v184, v184
  v_dot2c_f32_bf16 v242, v185, v253
  v_dot2c_f32_bf16 v243, v185, v185
  v_dot2c_f32_bf16 v240, v186, v253
  v_dot2c_f32_bf16 v241, v186, v186
  v_dot2c_f32_bf16 v242, v187, v253
  v_dot2c_f32_bf16 v243, v187, v187
  v_dot2c_f32_bf16 v240, v188, v253
  v_dot2c_f32_bf16 v241, v188, v188
  v_dot2c_f32_bf16 v242, v189, v253
  v_dot2c_f32_bf16 v243, v189, v189
  v_dot2c_f32_bf16 v240, v190, v253
  v_dot2c_f32_bf16 v241, v190, v190
  v_dot2c_f32_bf16 v242, v191, v253
  v_dot2c_f32_bf16 v243, v191, v191
  v_dot2c_f32_bf16 v250, v96, v253
  v_dot2c_f32_bf16 v250, v97, v253
  v_dot2c_f32_bf16 v250, v98, v253
  v_dot2c_f32_bf16 v250, v99, v253
  v_dot2c_f32_bf16 v251, v100, v253
  v_dot2c_f32_bf16 v251, v101, v253
  v_dot2c_f32_bf16 v251, v102, v253
  v_dot2c_f32_bf16 v251, v103, v253
  s_waitcnt vmcnt(12)
  s_barrier
  s_waitcnt lgkmcnt(0)
  v_mfma_f32_32x32x16_bf16 v[64:79], a[96:99], v[176:179], v[64:79]
  v_lshrrev_b32 v4, 7, v1
  v_mul_u32_u24 v4, 2688, v4
  v_lshlrev_b32 v5, 3, v1
  v_and_b32 v5, 0x380, v5
  v_add_u32 v4, v4, v5
  s_lshl_b32 s30, s22, 2
  s_add_u32 s30, s30, s20
  s_mul_i32 s30, s30, 10752
  s_mov_b32 exec_hi, 0
  buffer_load_dword v62, v4, s[12:15], s30 offen
  s_mov_b32 exec_hi, -1
  ds_read_b64 v[192:193], v104 offset:16384
  ds_read_b64 v[194:195], v105 offset:16384
  ds_read_b64 v[196:197], v106 offset:16384
  v_mfma_f32_32x32x16_bf16 v[80:95], v[176:179], a[100:103], v[80:95]
  s_lshl_b32 s30, s21, 8
  s_lshl_b32 s35, s22, 3
  s_add_u32 s30, s30, s35
  s_add_u32 s30, s30, 3784704
  s_xor_b32 s31, s59, s19
  v_mov_b32 v4, s58
  v_mov_b32 v5, s31
  s_mov_b64 exec, 1
  buffer_store_dwordx2 v[4:5], v1, s[4:7], s30 offen sc1
  s_mov_b64 exec, -1
  ds_read_b64 v[198:199], v107 offset:16384
  ds_read_b64 v[200:201], v108 offset:16384
  ds_read_b64 v[202:203], v109 offset:16384
  v_mfma_f32_32x32x16_bf16 v[64:79], a[104:107], v[180:183], v[64:79]
  ds_read_b64 v[204:205], v110 offset:16384
  ds_read_b64 v[206:207], v111 offset:16384
  ds_read_b64_tr_b16 v[96:97], v254 offset:32768
  ds_read_b64_tr_b16 v[98:99], v254 offset:33280
  v_mfma_f32_32x32x16_bf16 v[80:95], v[180:183], a[108:111], v[80:95]
  ds_read_b64_tr_b16 v[100:101], v254 offset:33792
  ds_read_b64_tr_b16 v[102:103], v254 offset:34304
  ds_read_b64_tr_b16 a[64:65], v6 offset:32768
  ds_read_b64_tr_b16 a[66:67], v6 offset:33280
  ds_read_b64_tr_b16 a[68:69], v6 offset:33792
  s_waitcnt lgkmcnt(14)
  ds_read_b64_tr_b16 a[70:71], v6 offset:34304
  v_mfma_f32_32x32x16_bf16 v[64:79], a[112:115], v[184:187], v[64:79]
  s_waitcnt lgkmcnt(14)
  ds_read_b64_tr_b16 a[72:73], v6 offset:34816
  s_waitcnt lgkmcnt(14)
  ds_read_b64_tr_b16 a[74:75], v6 offset:35328
  s_waitcnt lgkmcnt(14)
  ds_read_b64_tr_b16 a[76:77], v6 offset:35840
  s_waitcnt lgkmcnt(14)
  ds_read_b64_tr_b16 a[78:79], v6 offset:36352
  s_waitcnt lgkmcnt(14)
  ds_read_b64_tr_b16 a[80:81], v6 offset:36864
  s_waitcnt lgkmcnt(14)
  ds_read_b64_tr_b16 a[82:83], v6 offset:37376
  v_mfma_f32_32x32x16_bf16 v[80:95], v[184:187], a[116:119], v[80:95]
  s_waitcnt lgkmcnt(14)
  ds_read_b64_tr_b16 a[84:85], v6 offset:37888
  s_waitcnt lgkmcnt(14)
  ds_read_b64_tr_b16 a[86:87], v6 offset:38400
  s_waitcnt lgkmcnt(14)
  ds_read_b64_tr_b16 a[88:89], v6 offset:38912
  s_waitcnt lgkmcnt(14)
  ds_read_b64_tr_b16 a[90:91], v6 offset:39424
  s_waitcnt lgkmcnt(14)
  ds_read_b64_tr_b16 a[92:93], v6 offset:39936
  s_waitcnt lgkmcnt(14)
  ds_read_b64_tr_b16 a[94:95], v6 offset:40448
  v_mfma_f32_32x32x16_bf16 v[64:79], a[120:123], v[188:191], v[64:79]
  v_mfma_f32_32x32x16_bf16 v[80:95], v[188:191], a[124:127], v[80:95]
  v_dot2c_f32_bf16 v240, v192, v253
  v_dot2c_f32_bf16 v241, v192, v192
  v_dot2c_f32_bf16 v242, v193, v253
  v_dot2c_f32_bf16 v243, v193, v193
  v_dot2c_f32_bf16 v240, v194, v253
  v_dot2c_f32_bf16 v241, v194, v194
  v_dot2c_f32_bf16 v242, v195, v253
  v_dot2c_f32_bf16 v243, v195, v195
  v_dot2c_f32_bf16 v240, v196, v253
  v_dot2c_f32_bf16 v241, v196, v196
  v_dot2c_f32_bf16 v242, v197, v253
  v_dot2c_f32_bf16 v243, v197, v197
  v_dot2c_f32_bf16 v240, v198, v253
  v_dot2c_f32_bf16 v241, v198, v198
  v_dot2c_f32_bf16 v242, v199, v253
  v_dot2c_f32_bf16 v243, v199, v199
  v_dot2c_f32_bf16 v240, v200, v253
  v_dot2c_f32_bf16 v241, v200, v200
  v_dot2c_f32_bf16 v242, v201, v253
  v_dot2c_f32_bf16 v243, v201, v201
  v_dot2c_f32_bf16 v240, v202, v253
  v_dot2c_f32_bf16 v241, v202, v202
  v_dot2c_f32_bf16 v242, v203, v253
  v_dot2c_f32_bf16 v243, v203, v203
  v_dot2c_f32_bf16 v240, v204, v253
  v_dot2c_f32_bf16 v241, v204, v204
  v_dot2c_f32_bf16 v242, v205, v253
  v_dot2c_f32_bf16 v243, v205, v205
  v_dot2c_f32_bf16 v240, v206, v253
  v_dot2c_f32_bf16 v241, v206, v206
  v_dot2c_f32_bf16 v242, v207, v253
  v_dot2c_f32_bf16 v243, v207, v207
  v_dot2c_f32_bf16 v250, v96, v253
  v_dot2c_f32_bf16 v250, v97, v253
  v_dot2c_f32_bf16 v250, v98, v253
  v_dot2c_f32_bf16 v250, v99, v253
  v_dot2c_f32_bf16 v251, v100, v253
  v_dot2c_f32_bf16 v251, v101, v253
  v_dot2c_f32_bf16 v251, v102, v253
  v_dot2c_f32_bf16 v251, v103, v253
  s_waitcnt vmcnt(8)
  s_barrier
  s_waitcnt lgkmcnt(0)
  v_mfma_f32_32x32x16_bf16 v[64:79], a[64:67], v[192:195], v[64:79]
  s_add_u32 m0, s41, 2048
  s_add_u32 s35, s43, 0
  buffer_load_dwordx4 v56, s[12:15], s35 offen lds
  ds_read_b64 v[208:209], v104 offset:20480
  ds_read_b64 v[210:211], v105 offset:20480
  ds_read_b64 v[212:213], v106 offset:20480
  v_mfma_f32_32x32x16_bf16 v[80:95], v[192:195], a[68:71], v[80:95]
  s_add_u32 m0, s41, 3072
  s_add_u32 s35, s43, 172032
  buffer_load_dwordx4 v56, s[12:15], s35 offen lds
  ds_read_b64 v[214:215], v107 offset:20480
  ds_read_b64 v[216:217], v108 offset:20480
  ds_read_b64 v[218:219], v109 offset:20480
  v_mfma_f32_32x32x16_bf16 v[64:79], a[72:75], v[196:199], v[64:79]
  s_add_u32 m0, s41, 4096
  s_add_u32 s35, s43, 344064
  buffer_load_dwordx4 v56, s[12:15], s35 offen lds
  ds_read_b64 v[220:221], v110 offset:20480
  ds_read_b64 v[222:223], v111 offset:20480
  ds_read_b64_tr_b16 v[96:97], v254 offset:40960
  ds_read_b64_tr_b16 v[98:99], v254 offset:41472
  v_mfma_f32_32x32x16_bf16 v[80:95], v[196:199], a[76:79], v[80:95]
  s_add_u32 m0, s41, 5120
  s_add_u32 s35, s43, 516096
  buffer_load_dwordx4 v56, s[12:15], s35 offen lds
  ds_read_b64_tr_b16 v[100:101], v254 offset:41984
  ds_read_b64_tr_b16 v[102:103], v254 offset:42496
  ds_read_b64_tr_b16 a[96:97], v6 offset:40960
  ds_read_b64_tr_b16 a[98:99], v6 offset:41472
  ds_read_b64_tr_b16 a[100:101], v6 offset:41984
  s_waitcnt lgkmcnt(14)
  ds_read_b64_tr_b16 a[102:103], v6 offset:42496
  v_mfma_f32_32x32x16_bf16 v[64:79], a[80:83], v[200:203], v[64:79]
  s_add_u32 m0, s41, 6144
  s_add_u32 s35, s43, 688128
  buffer_load_dwordx4 v56, s[12:15], s35 offen lds
  s_waitcnt lgkmcnt(14)
  ds_read_b64_tr_b16 a[104:105], v6 offset:43008
  s_waitcnt lgkmcnt(14)
  ds_read_b64_tr_b16 a[106:107], v6 offset:43520
  s_waitcnt lgkmcnt(14)
  ds_read_b64_tr_b16 a[108:109], v6 offset:44032
  s_waitcnt lgkmcnt(14)
  ds_read_b64_tr_b16 a[110:111], v6 offset:44544
  s_waitcnt lgkmcnt(14)
  ds_read_b64_tr_b16 a[112:113], v6 offset:45056
  s_waitcnt lgkmcnt(14)
  ds_read_b64_tr_b16 a[114:115], v6 offset:45568
  v_mfma_f32_32x32x16_bf16 v[80:95], v[200:203], a[84:87], v[80:95]
  s_add_u32 m0, s41, 7168
  s_add_u32 s35, s43, 860160
  buffer_load_dwordx4 v56, s[12:15], s35 offen lds
  s_waitcnt lgkmcnt(14)
  ds_read_b64_tr_b16 a[116:117], v6 offset:46080
  s_waitcnt lgkmcnt(14)
  ds_read_b64_tr_b16 a[118:119], v6 offset:46592
  s_waitcnt lgkmcnt(14)
  ds_read_b64_tr_b16 a[120:121], v6 offset:47104
  s_waitcnt lgkmcnt(14)
  ds_read_b64_tr_b16 a[122:123], v6 offset:47616
  s_waitcnt lgkmcnt(14)
  ds_read_b64_tr_b16 a[124:125], v6 offset:48128
  s_waitcnt lgkmcnt(14)
  ds_read_b64_tr_b16 a[126:127], v6 offset:48640
  v_mfma_f32_32x32x16_bf16 v[64:79], a[88:91], v[204:207], v[64:79]
  s_add_u32 m0, s41, 8192
  s_add_u32 s35, s43, 1032192
  buffer_load_dwordx4 v56, s[12:15], s35 offen lds
  v_mfma_f32_32x32x16_bf16 v[80:95], v[204:207], a[92:95], v[80:95]
  v_dot2c_f32_bf16 v240, v208, v253
  v_dot2c_f32_bf16 v241, v208, v208
  v_dot2c_f32_bf16 v242, v209, v253
  v_dot2c_f32_bf16 v243, v209, v209
  v_dot2c_f32_bf16 v240, v210, v253
  v_dot2c_f32_bf16 v241, v210, v210
  v_dot2c_f32_bf16 v242, v211, v253
  v_dot2c_f32_bf16 v243, v211, v211
  v_dot2c_f32_bf16 v240, v212, v253
  v_dot2c_f32_bf16 v241, v212, v212
  v_dot2c_f32_bf16 v242, v213, v253
  v_dot2c_f32_bf16 v243, v213, v213
  v_dot2c_f32_bf16 v240, v214, v253
  v_dot2c_f32_bf16 v241, v214, v214
  v_dot2c_f32_bf16 v242, v215, v253
  v_dot2c_f32_bf16 v243, v215, v215
  v_dot2c_f32_bf16 v240, v216, v253
  v_dot2c_f32_bf16 v241, v216, v216
  v_dot2c_f32_bf16 v242, v217, v253
  v_dot2c_f32_bf16 v243, v217, v217
  v_dot2c_f32_bf16 v240, v218, v253
  v_dot2c_f32_bf16 v241, v218, v218
  v_dot2c_f32_bf16 v242, v219, v253
  v_dot2c_f32_bf16 v243, v219, v219
  v_dot2c_f32_bf16 v240, v220, v253
  v_dot2c_f32_bf16 v241, v220, v220
  v_dot2c_f32_bf16 v242, v221, v253
  v_dot2c_f32_bf16 v243, v221, v221
  v_dot2c_f32_bf16 v240, v222, v253
  v_dot2c_f32_bf16 v241, v222, v222
  v_dot2c_f32_bf16 v242, v223, v253
  v_dot2c_f32_bf16 v243, v223, v223
  v_dot2c_f32_bf16 v250, v96, v253
  v_dot2c_f32_bf16 v250, v97, v253
  v_dot2c_f32_bf16 v250, v98, v253
  v_dot2c_f32_bf16 v250, v99, v253
  v_dot2c_f32_bf16 v251, v100, v253
  v_dot2c_f32_bf16 v251, v101, v253
  v_dot2c_f32_bf16 v251, v102, v253
  v_dot2c_f32_bf16 v251, v103, v253
  s_waitcnt vmcnt(9)
  s_barrier
  s_waitcnt lgkmcnt(0)
  v_mfma_f32_32x32x16_bf16 v[64:79], a[96:99], v[208:211], v[64:79]
  s_mov_b32 s12, s100
  s_mov_b32 s13, s101
  s_mov_b32 s14, 0x188000
  s_mov_b32 s15, 0x00020000
  v_lshrrev_b32 v59, 7, v1
  v_mul_u32_u24 v59, 896, v59
  v_and_b32 v4, 0x70, v1
  v_add_u32 v59, v59, v4
  s_and_b32 s31, s24, 14
  s_lshl_b32 s31, s31, 6
  s_mul_i32 s32, s55, 14336
  s_add_u32 s32, s32, s31
  s_add_u32 m0, s41, 9216
  s_add_u32 s35, s32, 0
  buffer_load_dwordx4 v59, s[12:15], s35 offen lds
  s_add_u32 m0, s41, 10240
  s_add_u32 s35, s32, 7168
  buffer_load_dwordx4 v59, s[12:15], s35 offen lds
  ds_read_b64 v[224:225], v104 offset:24576
  ds_read_b64 v[226:227], v105 offset:24576
  ds_read_b64 v[228:229], v106 offset:24576
  v_mfma_f32_32x32x16_bf16 v[80:95], v[208:211], a[100:103], v[80:95]
  s_mov_b32 s12, s92
  s_mov_b32 s13, s93
  s_mov_b32 s14, 0x62000
  s_mov_b32 s15, 0x00020000
  s_lshr_b32 s32, s55, 1
  s_mul_i32 s32, s32, 25088
  s_and_b32 s30, s55, 1
  s_mul_i32 s33, s30, 14336
  s_add_u32 s32, s32, s33
  s_add_u32 s32, s32, s31
  s_add_u32 m0, s41, 11264
  s_add_u32 s35, s32, 0
  buffer_load_dwordx4 v59, s[12:15], s35 offen lds
  s_cmp_eq_u32 s30, 1
  s_cselect_b32 s30, 512, -1
  v_mov_b32 v4, 0x7fffff00
  v_cmp_le_u32 vcc, s30, v1
  s_nop 1
  v_cndmask_b32 v59, v59, v4, vcc
  s_add_u32 m0, s41, 12288
  s_add_u32 s35, s32, 7168
  buffer_load_dwordx4 v59, s[12:15], s35 offen lds
  ds_read_b64 v[230:231], v107 offset:24576
  ds_read_b64 v[232:233], v108 offset:24576
  ds_read_b64 v[234:235], v109 offset:24576
  v_mfma_f32_32x32x16_bf16 v[64:79], a[104:107], v[212:215], v[64:79]
  v_lshrrev_b32 v59, 6, v1
  v_mul_u32_u24 v59, 3584, v59
  v_and_b32 v4, 48, v1
  v_add_u32 v59, v59, v4
  s_lshr_b32 s30, s23, 2
  s_mul_i32 s30, s30, 7
  s_lshl_b32 s31, s20, 1
  s_add_u32 s30, s30, s31
  s_mul_i32 s30, s30, 57344
  s_and_b32 s31, s23, 3
  s_lshl_b32 s31, s31, 6
  s_add_u32 s30, s30, s31
  s_lshl_b32 s31, s24, 8
  s_add_u32 s30, s30, s31
  s_add_u32 s31, s30, 57344
  s_cmp_eq_u32 s20, 3
  s_cselect_b32 s31, 0x40000000, s31
  s_add_u32 m0, s41, 14336
  s_add_u32 s35, s30, 0
  buffer_load_dwordx4 v59, s[60:63], s35 offen lds
  s_add_u32 m0, s41, 15360
  s_add_u32 s35, s31, 0
  buffer_load_dwordx4 v59, s[60:63], s35 offen lds
  ds_read_b64 v[236:237], v110 offset:24576
  ds_read_b64 v[238:239], v111 offset:24576
  ds_read_b64_tr_b16 v[96:97], v255 offset:0
  ds_read_b64_tr_b16 v[98:99], v255 offset:512
  v_mfma_f32_32x32x16_bf16 v[80:95], v[212:215], a[108:111], v[80:95]
  ds_read_b64_tr_b16 v[100:101], v255 offset:1024
  ds_read_b64_tr_b16 v[102:103], v255 offset:1536
  ds_read_b64_tr_b16 a[64:65], v6 offset:49152
  ds_read_b64_tr_b16 a[66:67], v6 offset:49664
  ds_read_b64_tr_b16 a[68:69], v6 offset:50176
  s_waitcnt lgkmcnt(14)
  ds_read_b64_tr_b16 a[70:71], v6 offset:50688
  v_mfma_f32_32x32x16_bf16 v[64:79], a[112:115], v[216:219], v[64:79]
  s_waitcnt lgkmcnt(14)
  ds_read_b64_tr_b16 a[72:73], v0 offset:12288
  s_waitcnt lgkmcnt(14)
  ds_read_b64_tr_b16 a[74:75], v0 offset:12800
  s_waitcnt lgkmcnt(14)
  ds_read_b64_tr_b16 a[76:77], v0 offset:13312
  s_waitcnt lgkmcnt(14)
  ds_read_b64_tr_b16 a[78:79], v0 offset:13824
  s_waitcnt lgkmcnt(14)
  ds_read_b64_tr_b16 a[80:81], v0 offset:40960
  s_waitcnt lgkmcnt(14)
  ds_read_b64_tr_b16 a[82:83], v0 offset:41472
  v_mfma_f32_32x32x16_bf16 v[80:95], v[216:219], a[116:119], v[80:95]
  s_waitcnt lgkmcnt(14)
  ds_read_b64_tr_b16 a[84:85], v0 offset:41984
  s_waitcnt lgkmcnt(14)
  ds_read_b64_tr_b16 a[86:87], v0 offset:42496
  s_waitcnt lgkmcnt(14)
  ds_read_b64_tr_b16 a[88:89], v63 offset:4096
  s_waitcnt lgkmcnt(14)
  ds_read_b64_tr_b16 a[90:91], v63 offset:4608
  s_waitcnt lgkmcnt(14)
  ds_read_b64_tr_b16 a[92:93], v63 offset:5120
  s_waitcnt lgkmcnt(14)
  ds_read_b64_tr_b16 a[94:95], v63 offset:5632
  v_mfma_f32_32x32x16_bf16 v[64:79], a[120:123], v[220:223], v[64:79]
  v_mfma_f32_32x32x16_bf16 v[80:95], v[220:223], a[124:127], v[80:95]
  v_dot2c_f32_bf16 v240, v224, v253
  v_dot2c_f32_bf16 v241, v224, v224
  v_dot2c_f32_bf16 v242, v225, v253
  v_dot2c_f32_bf16 v243, v225, v225
  v_dot2c_f32_bf16 v240, v226, v253
  v_dot2c_f32_bf16 v241, v226, v226
  v_dot2c_f32_bf16 v242, v227, v253
  v_dot2c_f32_bf16 v243, v227, v227
  v_dot2c_f32_bf16 v240, v228, v253
  v_dot2c_f32_bf16 v241, v228, v228
  v_dot2c_f32_bf16 v242, v229, v253
  v_dot2c_f32_bf16 v243, v229, v229
  v_dot2c_f32_bf16 v240, v230, v253
  v_dot2c_f32_bf16 v241, v230, v230
  v_dot2c_f32_bf16 v242, v231, v253
  v_dot2c_f32_bf16 v243, v231, v231
  v_dot2c_f32_bf16 v240, v232, v253
  v_dot2c_f32_bf16 v241, v232, v232
  v_dot2c_f32_bf16 v242, v233, v253
  v_dot2c_f32_bf16 v243, v233, v233
  v_dot2c_f32_bf16 v240, v234, v253
  v_dot2c_f32_bf16 v241, v234, v234
  v_dot2c_f32_bf16 v242, v235, v253
  v_dot2c_f32_bf16 v243, v235, v235
  v_dot2c_f32_bf16 v240, v236, v253
  v_dot2c_f32_bf16 v241, v236, v236
  v_dot2c_f32_bf16 v242, v237, v253
  v_dot2c_f32_bf16 v243, v237, v237
  v_dot2c_f32_bf16 v240, v238, v253
  v_dot2c_f32_bf16 v241, v238, v238
  v_dot2c_f32_bf16 v242, v239, v253
  v_dot2c_f32_bf16 v243, v239, v239
  v_dot2c_f32_bf16 v250, v96, v253
  v_dot2c_f32_bf16 v250, v97, v253
  v_dot2c_f32_bf16 v250, v98, v253
  v_dot2c_f32_bf16 v250, v99, v253
  v_dot2c_f32_bf16 v251, v100, v253
  v_dot2c_f32_bf16 v251, v101, v253
  v_dot2c_f32_bf16 v251, v102, v253
  v_dot2c_f32_bf16 v251, v103, v253
  v_add_f32 v240, v240, v242
  v_add_f32 v241, v241, v243
  v_lshrrev_b32 v60, 1, v1
  v_add_u32 v60, s41, v60
  v_lshlrev_b32 v61, 3, v2
  v_add_u32 v61, 65536, v61
  v_add_u32 v62, 57344, v61
  v_lshlrev_b32 v4, 2, v2
  v_add_u32 v4, s41, v4
  v_lshlrev_b32 v5, 4, v3
  v_add_u32 v5, s41, v5
  s_waitcnt lgkmcnt(14)
  ds_write_b64 v60, v[250:251] offset:16384
  s_waitcnt lgkmcnt(0)
  s_barrier
  ds_read_b64 v[16:17], v61 offset:0
  ds_read_b64 v[18:19], v61 offset:256
  ds_read_b64 v[20:21], v61 offset:28672
  ds_read_b64 v[22:23], v61 offset:28928
  ds_read_b64 v[24:25], v62 offset:0
  ds_read_b64 v[26:27], v62 offset:256
  ds_read_b64 v[28:29], v62 offset:28672
  ds_read_b64 v[30:31], v62 offset:28928
  v_mfma_f32_32x32x16_bf16 v[64:79], a[64:67], v[224:227], v[64:79]
  v_mov_b32 v242, v240
  v_mov_b32 v243, v241
  v_mov_b32 v246, 0
  v_mov_b32 v247, 0
  v_permlane32_swap_b32 v240, v242
  v_permlane32_swap_b32 v241, v243
  v_mfma_f32_32x32x16_bf16 v[80:95], v[224:227], a[68:71], v[80:95]
  v_add_f32 v240, v240, v242
  v_add_f32 v241, v241, v243
  v_mul_f32 v240, 0xbb124925, v240
  v_mul_f32 v241, 0x3b124925, v241
  v_fma_f32 v241, -v240, v240, v241
  v_max_f32 v241, 0, v241
  v_mfma_f32_32x32x16_bf16 v[64:79], a[72:75], v[228:231], v[64:79]
  v_add_f32 v241, 0x3727c5ac, v241
  v_rsq_f32 v241, v241
  v_cvt_pk_bf16_f32 v244, v240, v240
  v_and_b32 v245, 0xffff0000, v244
  v_sub_f32 v245, v240, v245
  v_cvt_pk_bf16_f32 v245, v245, v245
  v_mfma_f32_32x32x16_bf16 v[80:95], v[228:231], a[76:79], v[80:95]
  ds_write_b32 v4, v241 offset:17408
  ds_read_b128 v[112:115], v5 offset:17408
  ds_read_b128 v[116:119], v5 offset:17440
  ds_read_b128 v[120:123], v5 offset:17472
  ds_read_b128 v[124:127], v5 offset:17504
  s_waitcnt lgkmcnt(5)
  v_add_f32 v16, v16, v18
  v_add_f32 v17, v17, v19
  v_add_f32 v20, v20, v22
  v_add_f32 v21, v21, v23
  v_mfma_f32_32x32x16_bf16 v[64:79], a[80:83], v[232:235], v[64:79]
  v_add_f32 v24, v24, v26
  v_add_f32 v25, v25, v27
  v_add_f32 v28, v28, v30
  v_add_f32 v29, v29, v31
  v_add_f32 v16, v16, v20
  v_add_f32 v17, v17, v21
  v_mfma_f32_32x32x16_bf16 v[80:95], v[232:235], a[84:87], v[80:95]
  v_add_f32 v24, v24, v28
  v_add_f32 v25, v25, v29
  v_add_f32 v16, v16, v24
  v_add_f32 v17, v17, v25
  v_cvt_pk_bf16_f32 v49, v16, v16
  v_and_b32 v49, 0xffff0000, v49
  v_mfma_f32_32x32x16_bf16 v[64:79], a[88:91], v[236:239], v[64:79]
  v_sub_f32 v16, v16, v49
  v_cvt_pk_bf16_f32 v48, v49, v16
  v_mov_b32 v49, v48
  v_mov_b32 v50, 0
  v_mov_b32 v51, 0
  s_mov_b32 exec_lo, 0xf0000000
  v_mov_b32 v48, 0
  v_mov_b32 v49, 0
  s_mov_b32 exec_lo, -1
  v_mfma_f32_32x32x16_bf16 v[80:95], v[236:239], a[92:95], v[80:95]
  v_cvt_pk_bf16_f32 v53, v17, v17
  v_and_b32 v53, 0xffff0000, v53
  v_sub_f32 v17, v17, v53
  v_cvt_pk_bf16_f32 v52, v53, v17
  v_mov_b32 v53, v52
  v_mov_b32 v54, 0
  v_mov_b32 v55, 0
  s_mov_b32 exec_lo, 0xf0000000
  v_mov_b32 v52, 0
  v_mov_b32 v53, 0
  s_mov_b32 exec_lo, -1
  v_mfma_f32_32x32x16_bf16 v[64:79], v[48:51], v[244:247], v[64:79]
  v_mfma_f32_32x32x16_bf16 v[80:95], v[244:247], v[52:55], v[80:95]
  v_mov_b32 v4, 0x3f803f80
  v_cmp_eq_u32 vcc, 28, v2
  s_waitcnt lgkmcnt(0)
  s_nop 7
  v_pk_mul_f32 v[64:65], v[64:65], v[240:241] op_sel:[0,1] op_sel_hi:[1,1]
  v_pk_mul_f32 v[66:67], v[66:67], v[240:241] op_sel:[0,1] op_sel_hi:[1,1]
  v_pk_mul_f32 v[68:69], v[68:69], v[240:241] op_sel:[0,1] op_sel_hi:[1,1]
  v_pk_mul_f32 v[70:71], v[70:71], v[240:241] op_sel:[0,1] op_sel_hi:[1,1]
  v_pk_mul_f32 v[72:73], v[72:73], v[240:241] op_sel:[0,1] op_sel_hi:[1,1]
  v_pk_mul_f32 v[74:75], v[74:75], v[240:241] op_sel:[0,1] op_sel_hi:[1,1]
  v_pk_mul_f32 v[76:77], v[76:77], v[240:241] op_sel:[0,1] op_sel_hi:[1,1]
  v_pk_mul_f32 v[78:79], v[78:79], v[240:241] op_sel:[0,1] op_sel_hi:[1,1]
  v_cvt_pk_bf16_f32 v64, v64, v65
  v_cvt_pk_bf16_f32 v65, v66, v67
  v_cvt_pk_bf16_f32 v66, v68, v69
  v_cvt_pk_bf16_f32 v67, v70, v71
  v_cvt_pk_bf16_f32 v68, v72, v73
  v_cvt_pk_bf16_f32 v69, v74, v75
  v_cvt_pk_bf16_f32 v70, v76, v77
  v_cvt_pk_bf16_f32 v71, v78, v79
  buffer_store_dwordx4 v[64:67], v1, s[4:7], s38 offen sc1
  buffer_store_dwordx4 v[68:71], v1, s[4:7], s38 offen offset:1024 sc1
  v_pk_mul_f32 v[80:81], v[80:81], v[112:113]
  v_pk_mul_f32 v[82:83], v[82:83], v[114:115]
  v_pk_mul_f32 v[84:85], v[84:85], v[116:117]
  v_pk_mul_f32 v[86:87], v[86:87], v[118:119]
  v_pk_mul_f32 v[88:89], v[88:89], v[120:121]
  v_pk_mul_f32 v[90:91], v[90:91], v[122:123]
  v_pk_mul_f32 v[92:93], v[92:93], v[124:125]
  v_pk_mul_f32 v[94:95], v[94:95], v[126:127]
  v_cvt_pk_bf16_f32 v80, v80, v81
  v_cvt_pk_bf16_f32 v81, v82, v83
  v_cvt_pk_bf16_f32 v82, v84, v85
  v_cvt_pk_bf16_f32 v83, v86, v87
  v_cvt_pk_bf16_f32 v84, v88, v89
  v_cvt_pk_bf16_f32 v85, v90, v91
  v_cvt_pk_bf16_f32 v86, v92, v93
  v_cvt_pk_bf16_f32 v87, v94, v95
  v_cndmask_b32 v80, v80, v4, vcc
  v_cndmask_b32 v81, v81, v4, vcc
  v_cndmask_b32 v82, v82, v4, vcc
  v_cndmask_b32 v83, v83, v4, vcc
  v_cndmask_b32 v84, v84, v4, vcc
  v_cndmask_b32 v85, v85, v4, vcc
  v_cndmask_b32 v86, v86, v4, vcc
  v_cndmask_b32 v87, v87, v4, vcc
  buffer_store_dwordx4 v[80:83], v1, s[4:7], s38 offen offset:2048 sc1
  buffer_store_dwordx4 v[84:87], v1, s[4:7], s38 offen offset:3072 sc1
  s_waitcnt vmcnt(4)
  ds_read_b64_tr_b16 v[16:17], v255 offset:2048
  ds_read_b64_tr_b16 v[18:19], v255 offset:2560
  ds_read_b64_tr_b16 v[20:21], v255 offset:3072
  ds_read_b64_tr_b16 v[22:23], v255 offset:3584
  ds_read_b64_tr_b16 v[24:25], v255 offset:4096
  ds_read_b64_tr_b16 v[26:27], v255 offset:4608
  ds_read_b64_tr_b16 v[28:29], v255 offset:5120
  ds_read_b64_tr_b16 v[30:31], v255 offset:5632
  ds_read_b64_tr_b16 v[32:33], v255 offset:6144
  ds_read_b64_tr_b16 v[34:35], v255 offset:6656
  ds_read_b64_tr_b16 v[36:37], v255 offset:7168
  ds_read_b64_tr_b16 v[38:39], v255 offset:7680
  ds_read_b64_tr_b16 v[40:41], v255 offset:8192
  ds_read_b64_tr_b16 v[42:43], v255 offset:8704
  s_waitcnt lgkmcnt(0)
  ds_read_b64_tr_b16 v[112:113], v255 offset:14336
  ds_read_b64_tr_b16 v[114:115], v255 offset:14848
  ds_read_b64_tr_b16 v[116:117], v255 offset:15360
  ds_read_b64_tr_b16 v[118:119], v255 offset:15872
  v_dot2c_f32_bf16 v252, v16, v253
  v_dot2c_f32_bf16 v252, v17, v253
  v_dot2c_f32_bf16 v252, v18, v253
  v_dot2c_f32_bf16 v252, v19, v253
  v_dot2c_f32_bf16 v252, v20, v253
  v_dot2c_f32_bf16 v252, v21, v253
  v_dot2c_f32_bf16 v252, v22, v253
  v_dot2c_f32_bf16 v252, v23, v253
  v_dot2c_f32_bf16 v252, v24, v253
  v_dot2c_f32_bf16 v252, v25, v253
  v_dot2c_f32_bf16 v252, v26, v253
  v_dot2c_f32_bf16 v252, v27, v253
  v_dot2c_f32_bf16 v252, v28, v253
  v_dot2c_f32_bf16 v252, v29, v253
  v_dot2c_f32_bf16 v252, v30, v253
  v_dot2c_f32_bf16 v252, v31, v253
  v_dot2c_f32_bf16 v252, v32, v253
  v_dot2c_f32_bf16 v252, v33, v253
  v_dot2c_f32_bf16 v252, v34, v253
  v_dot2c_f32_bf16 v252, v35, v253
  v_dot2c_f32_bf16 v252, v36, v253
  v_dot2c_f32_bf16 v252, v37, v253
  v_dot2c_f32_bf16 v252, v38, v253
  v_dot2c_f32_bf16 v252, v39, v253
  v_dot2c_f32_bf16 v252, v40, v253
  v_dot2c_f32_bf16 v252, v41, v253
  v_dot2c_f32_bf16 v252, v42, v253
  v_dot2c_f32_bf16 v252, v43, v253
  v_mov_b32 v251, 0
  s_waitcnt lgkmcnt(0)
  v_dot2c_f32_bf16 v251, v112, v253
  v_dot2c_f32_bf16 v251, v113, v253
  v_dot2c_f32_bf16 v251, v114, v253
  v_dot2c_f32_bf16 v251, v115, v253
  v_dot2c_f32_bf16 v251, v116, v253
  v_dot2c_f32_bf16 v251, v117, v253
  v_dot2c_f32_bf16 v251, v118, v253
  v_dot2c_f32_bf16 v251, v119, v253
  v_mov_b32 v250, v252
  s_nop 1
  ds_write_b64 v60, v[250:251] offset:16896
  s_waitcnt lgkmcnt(0)
  s_waitcnt vmcnt(0)
  s_barrier
  s_cmp_lg_u32 s20, 0
  s_cselect_b32 s37, 0x40000000, s37
  v_mov_b32 v4, s58
  v_mov_b32 v5, s59
  s_mov_b64 exec, 1
  buffer_store_dwordx2 v[4:5], v1, s[4:7], s37 offen sc1
  s_mov_b64 exec, -1
  ds_read_b64_tr_b16 v[16:17], v6 offset:51200
  ds_read_b64_tr_b16 v[18:19], v6 offset:51712
  ds_read_b64_tr_b16 v[20:21], v0 offset:14336
  ds_read_b64_tr_b16 v[22:23], v0 offset:14848
  ds_read_b64_tr_b16 v[24:25], v0 offset:43008
  ds_read_b64_tr_b16 v[26:27], v0 offset:43520
  ds_read_b64_tr_b16 v[28:29], v63 offset:6144
  ds_read_b64_tr_b16 v[30:31], v63 offset:6656
  v_mul_u32_u24 v58, 896, v2
  v_lshlrev_b32 v4, 4, v3
  v_add_u32 v58, v58, v4
  s_mul_i32 s30, s21, 229376
  s_mul_i32 s35, s26, 28672
  s_add_u32 s30, s30, s35
  s_lshl_b32 s35, s28, 6
  s_add_u32 s30, s30, s35
  buffer_load_dwordx4 v[8:11], v58, s[96:99], s30 offen
  buffer_load_dwordx4 v[12:15], v58, s[96:99], s30 offen offset:32
  s_lshl_b32 s30, s23, 1
  s_and_b32 s31, s30, 3
  s_mul_i32 s31, s31, 28672
  s_add_u32 s31, s31, 49152
  s_lshr_b32 s32, s30, 2
  s_lshl_b32 s32, s32, 10
  s_add_u32 s32, s32, s31
  s_add_u32 s32, s32, 2048
  s_lshl_b32 s30, s30, 11
  s_cmp_ge_u32 s23, 12
  s_cselect_b32 s30, s31, s30
  s_mov_b32 s33, 2048
  s_cselect_b32 s33, 28672, s33
  s_cmp_eq_u32 s20, 2
  s_cselect_b32 s31, 1024, 0
  s_add_u32 s30, s30, s31
  s_cmp_eq_u32 s20, 0
  s_cselect_b32 s30, s32, s30
  s_cselect_b32 s33, 28672, s33
  v_add_u32 v250, s30, v6
  v_add_u32 v251, s33, v250
  s_mul_i32 s40, s20, 458752
  s_mul_i32 s35, s24, 28672
  s_add_u32 s40, s40, s35
  s_lshl_b32 s35, s23, 11
  s_add_u32 s40, s40, s35
  s_cmp_eq_u32 s20, 3
  s_cselect_b32 s40, 0x40000000, s40
  s_cmp_ge_u32 s23, 14
  s_cselect_b32 s40, 0x40000000, s40
  v_and_b32 v252, 0x1c0, v6
  v_add_u32 v252, v252, v255
  s_and_b32 s31, s24, 14
  s_mul_i32 s41, s31, 114688
  s_lshl_b32 s32, s55, 10
  s_add_u32 s41, s41, s32
  s_add_u32 s41, s41, 1900544
  s_cmp_ge_u32 s55, 112
  s_cselect_b32 s41, 0x40000000, s41
  s_add_u32 s42, s41, 114688
  s_lshl_b32 s31, s31, 15
  s_add_u32 s43, s31, s32
  s_add_u32 s43, s43, 1376256
  s_cmp_ge_u32 s55, 32
  s_cselect_b32 s43, 0x40000000, s43
  s_add_u32 s45, s43, 32768
  s_waitcnt lgkmcnt(6)
  v_mfma_f32_32x32x16_bf16 v[96:111], v[16:19], v[128:131], 0
  ds_read_b64_tr_b16 v[32:33], v6 offset:52224
  ds_read_b64_tr_b16 v[34:35], v6 offset:52736
  ds_read_b64_tr_b16 a[128:129], v252 offset:9216
  ds_read_b64_tr_b16 a[130:131], v252 offset:10240
  s_waitcnt lgkmcnt(8)
  v_mfma_f32_32x32x16_bf16 v[96:111], v[20:23], v[132:135], v[96:111]
  ds_read_b64_tr_b16 v[36:37], v0 offset:15360
  ds_read_b64_tr_b16 v[38:39], v0 offset:15872
  ds_read_b64_tr_b16 a[132:133], v252 offset:9280
  ds_read_b64_tr_b16 a[134:135], v252 offset:10304
  s_waitcnt lgkmcnt(10)
  v_mfma_f32_32x32x16_bf16 v[96:111], v[24:27], v[136:139], v[96:111]
  ds_read_b64_tr_b16 v[40:41], v0 offset:44032
  ds_read_b64_tr_b16 v[42:43], v0 offset:44544
  ds_read_b64_tr_b16 a[136:137], v252 offset:11264
  ds_read_b64_tr_b16 a[138:139], v252 offset:12288
  s_waitcnt lgkmcnt(12)
  v_mfma_f32_32x32x16_bf16 v[96:111], v[28:31], v[140:143], v[96:111]
  ds_read_b64_tr_b16 v[44:45], v63 offset:7168
  ds_read_b64_tr_b16 v[46:47], v63 offset:7680
  ds_read_b64_tr_b16 a[140:141], v252 offset:11328
  s_waitcnt lgkmcnt(14)
  ds_read_b64_tr_b16 a[142:143], v252 offset:12352
  s_waitcnt lgkmcnt(14)
  v_mfma_f32_32x32x16_bf16 v[96:111], v[32:35], v[144:147], v[96:111]
  ds_read_b64_tr_b16 v[16:17], v6 offset:53248
  s_waitcnt lgkmcnt(14)
  ds_read_b64_tr_b16 v[18:19], v6 offset:53760
  s_waitcnt lgkmcnt(14)
  ds_read_b64 v[112:113], v61 offset:512
  s_waitcnt lgkmcnt(13)
  v_mfma_f32_32x32x16_bf16 v[96:111], v[36:39], v[148:151], v[96:111]
  ds_read_b64_tr_b16 v[20:21], v0 offset:16384
  ds_read_b64_tr_b16 v[22:23], v0 offset:16896
  s_waitcnt lgkmcnt(14)
  ds_read_b64 v[114:115], v61 offset:768
  s_waitcnt lgkmcnt(12)
  v_mfma_f32_32x32x16_bf16 v[96:111], v[40:43], v[152:155], v[96:111]
  ds_read_b64_tr_b16 v[24:25], v0 offset:45056
  ds_read_b64_tr_b16 v[26:27], v0 offset:45568
  ds_read_b64 v[116:117], v61 offset:29184
  s_waitcnt lgkmcnt(11)
  v_mfma_f32_32x32x16_bf16 v[96:111], v[44:47], v[156:159], v[96:111]
  ds_read_b64_tr_b16 v[28:29], v63 offset:8192
  ds_read_b64_tr_b16 v[30:31], v63 offset:8704
  ds_read_b64 v[118:119], v61 offset:29440
  s_waitcnt lgkmcnt(10)
  v_mfma_f32_32x32x16_bf16 v[96:111], v[16:19], v[160:163], v[96:111]
  ds_read_b64_tr_b16 v[32:33], v6 offset:54272
  ds_read_b64_tr_b16 v[34:35], v6 offset:54784
  ds_read_b64 v[120:121], v62 offset:512
  s_waitcnt lgkmcnt(10)
  v_mfma_f32_32x32x16_bf16 v[96:111], v[20:23], v[164:167], v[96:111]
  ds_read_b64_tr_b16 v[36:37], v0 offset:17408
  ds_read_b64_tr_b16 v[38:39], v0 offset:17920
  ds_read_b64 v[122:123], v62 offset:768
  s_waitcnt lgkmcnt(10)
  v_mfma_f32_32x32x16_bf16 v[96:111], v[24:27], v[168:171], v[96:111]
  ds_read_b64_tr_b16 v[40:41], v0 offset:46080
  ds_read_b64_tr_b16 v[42:43], v0 offset:46592
  ds_read_b64 v[124:125], v62 offset:29184
  s_waitcnt lgkmcnt(10)
  v_mfma_f32_32x32x16_bf16 v[96:111], v[28:31], v[172:175], v[96:111]
  ds_read_b64_tr_b16 v[44:45], v63 offset:9216
  ds_read_b64_tr_b16 v[46:47], v63 offset:9728
  ds_read_b64 v[126:127], v62 offset:29440
  s_waitcnt lgkmcnt(10)
  v_mfma_f32_32x32x16_bf16 v[96:111], v[32:35], v[176:179], v[96:111]
  ds_read_b64_tr_b16 v[16:17], v6 offset:55296
  ds_read_b64_tr_b16 v[18:19], v6 offset:55808
  buffer_store_dwordx4 a[128:131], v1, s[4:7], s41 offen sc1
  s_waitcnt lgkmcnt(9)
  v_mfma_f32_32x32x16_bf16 v[96:111], v[36:39], v[180:183], v[96:111]
  ds_read_b64_tr_b16 v[20:21], v0 offset:18432
  ds_read_b64_tr_b16 v[22:23], v0 offset:18944
  buffer_store_dwordx4 a[132:135], v1, s[4:7], s42 offen sc1
  s_waitcnt lgkmcnt(8)
  v_mfma_f32_32x32x16_bf16 v[96:111], v[40:43], v[184:187], v[96:111]
  ds_read_b64_tr_b16 v[24:25], v0 offset:47104
  ds_read_b64_tr_b16 v[26:27], v0 offset:47616
  buffer_store_dwordx4 a[136:139], v1, s[4:7], s43 offen sc1
  s_waitcnt lgkmcnt(7)
  v_mfma_f32_32x32x16_bf16 v[96:111], v[44:47], v[188:191], v[96:111]
  ds_read_b64_tr_b16 v[28:29], v63 offset:10240
  ds_read_b64_tr_b16 v[30:31], v63 offset:10752
  buffer_store_dwordx4 a[140:143], v1, s[4:7], s45 offen sc1
  s_waitcnt lgkmcnt(6)
  v_mfma_f32_32x32x16_bf16 v[96:111], v[16:19], v[192:195], v[96:111]
  ds_read_b64_tr_b16 v[32:33], v6 offset:56320
  ds_read_b64_tr_b16 v[34:35], v6 offset:56832
  v_add_f32 v112, v112, v114
  v_add_f32 v113, v113, v115
  v_add_f32 v116, v116, v118
  v_add_f32 v117, v117, v119
  v_add_f32 v120, v120, v122
  v_add_f32 v121, v121, v123
  v_add_f32 v124, v124, v126
  v_add_f32 v125, v125, v127
  v_add_f32 v112, v112, v116
  v_add_f32 v113, v113, v117
  v_add_f32 v120, v120, v124
  v_add_f32 v121, v121, v125
  v_add_f32 v112, v112, v120
  v_add_f32 v113, v113, v121
  s_waitcnt lgkmcnt(6)
  v_mfma_f32_32x32x16_bf16 v[96:111], v[20:23], v[196:199], v[96:111]
  ds_read_b64_tr_b16 v[36:37], v0 offset:19456
  ds_read_b64_tr_b16 v[38:39], v0 offset:19968
  v_cvt_pk_bf16_f32 v57, v112, v112
  v_and_b32 v57, 0xffff0000, v57
  v_sub_f32 v112, v112, v57
  v_cvt_pk_bf16_f32 v56, v57, v112
  v_mov_b32 v57, v56
  v_mov_b32 v58, 0
  v_mov_b32 v59, 0
  s_mov_b32 exec_lo, 0xf0000000
  v_mov_b32 v56, 0
  v_mov_b32 v57, 0
  s_mov_b32 exec_lo, -1
  s_waitcnt lgkmcnt(6)
  v_mfma_f32_32x32x16_bf16 v[96:111], v[24:27], v[200:203], v[96:111]
  ds_read_b64_tr_b16 v[40:41], v0 offset:48128
  ds_read_b64_tr_b16 v[42:43], v0 offset:48640
  s_and_b32 s31, s23, 3
  s_lshr_b32 s32, s23, 2
  s_lshl_b32 s30, s24, 11
  s_lshl_b32 s35, s31, 9
  s_add_u32 s30, s30, s35
  s_lshl_b32 s35, s32, 2
  s_add_u32 s30, s30, s35
  s_add_u32 s30, s30, 3751936
  s_cmp_lg_u32 s20, 0
  s_cselect_b32 s30, 0x40000000, s30
  v_lshlrev_b32 v7, 4, v2
  s_mov_b32 exec_hi, 0
  buffer_store_dword v113, v7, s[4:7], s30 offen sc1
  s_mov_b32 exec_hi, -1
  s_waitcnt lgkmcnt(6)
  v_mfma_f32_32x32x16_bf16 v[96:111], v[28:31], v[204:207], v[96:111]
  ds_read_b64_tr_b16 v[44:45], v63 offset:11264
  ds_read_b64_tr_b16 v[46:47], v63 offset:11776
  ds_read_b64_tr_b16 v[120:121], v250 offset:0
  ds_read_b64_tr_b16 v[122:123], v250 offset:512
  s_waitcnt lgkmcnt(8)
  v_mfma_f32_32x32x16_bf16 v[96:111], v[32:35], v[208:211], v[96:111]
  ds_read_b64_tr_b16 v[16:17], v6 offset:57344
  ds_read_b64_tr_b16 v[18:19], v6 offset:57856
  ds_read_b64_tr_b16 v[124:125], v251 offset:0
  ds_read_b64_tr_b16 v[126:127], v251 offset:512
  s_waitcnt lgkmcnt(10)
  v_mfma_f32_32x32x16_bf16 v[96:111], v[36:39], v[212:215], v[96:111]
  ds_read_b64_tr_b16 v[20:21], v0 offset:20480
  ds_read_b64_tr_b16 v[22:23], v0 offset:20992
  s_lshl_b32 s30, s24, 8
  s_add_u32 s30, s30, 3735552
  s_cmp_lg_u32 s20, 0
  s_cselect_b32 s30, 0x40000000, s30
  s_add_u32 s31, s30, 4096
  s_add_u32 s32, s30, 8192
  v_lshlrev_b32 v7, 3, v2
  s_mov_b32 exec_hi, 0
  buffer_store_dwordx2 v[48:49], v7, s[4:7], s31 offen sc1
  buffer_store_dwordx2 v[52:53], v7, s[4:7], s32 offen sc1
  buffer_store_dwordx2 v[56:57], v7, s[4:7], s30 offen sc1
  s_mov_b32 exec_hi, -1
  s_waitcnt lgkmcnt(10)
  v_mfma_f32_32x32x16_bf16 v[96:111], v[40:43], v[216:219], v[96:111]
  ds_read_b64_tr_b16 v[24:25], v0 offset:49152
  ds_read_b64_tr_b16 v[26:27], v0 offset:49664
  s_waitcnt lgkmcnt(4)
  s_mov_b32 exec_lo, 0xf0000000
  s_mov_b32 exec_hi, 0xf0000000
  v_mov_b32 v120, 0
  v_mov_b32 v121, 0
  v_mov_b32 v122, 0
  v_mov_b32 v123, 0
  v_mov_b32 v124, 0
  v_mov_b32 v125, 0
  v_mov_b32 v126, 0
  v_mov_b32 v127, 0
  s_mov_b64 exec, -1
  buffer_store_dwordx4 v[120:123], v1, s[4:7], s40 offen sc1
  buffer_store_dwordx4 v[124:127], v1, s[4:7], s40 offen offset:1024 sc1
  v_mfma_f32_32x32x16_bf16 v[96:111], v[44:47], v[220:223], v[96:111]
  ds_read_b64_tr_b16 v[28:29], v63 offset:12288
  ds_read_b64_tr_b16 v[30:31], v63 offset:12800
  v_mfma_f32_32x32x16_bf16 v[96:111], v[16:19], v[224:227], v[96:111]
  s_waitcnt lgkmcnt(4)
  v_mfma_f32_32x32x16_bf16 v[96:111], v[20:23], v[228:231], v[96:111]
  s_waitcnt lgkmcnt(2)
  v_mfma_f32_32x32x16_bf16 v[96:111], v[24:27], v[232:235], v[96:111]
  s_waitcnt lgkmcnt(0)
  v_mfma_f32_32x32x16_bf16 v[96:111], v[28:31], v[236:239], v[96:111]
  v_mfma_f32_32x32x16_bf16 v[96:111], v[56:59], v[244:247], v[96:111]
  v_mul_f32 v241, 0x3e8b97f6, v241
  v_mov_b32 v128, v64
  v_mov_b32 v136, v80
  v_mov_b32 v129, v65
  v_mov_b32 v137, v81
  v_mov_b32 v130, v66
  v_mov_b32 v138, v82
  v_mov_b32 v131, v67
  v_mov_b32 v139, v83
  v_mov_b32 v132, v68
  v_mov_b32 v140, v84
  v_mov_b32 v133, v69
  v_mov_b32 v141, v85
  v_mov_b32 v134, v70
  v_mov_b32 v142, v86
  v_mov_b32 v135, v71
  v_mov_b32 v143, v87
  s_waitcnt vmcnt(10)
  v_permlane32_swap_b32 v8, v10
  v_permlane32_swap_b32 v9, v11
  v_permlane32_swap_b32 v12, v14
  v_permlane32_swap_b32 v13, v15
  v_pk_mul_f32 v[96:97], v[96:97], v[240:241] op_sel:[0,1] op_sel_hi:[1,1]
  v_pk_mul_f32 v[98:99], v[98:99], v[240:241] op_sel:[0,1] op_sel_hi:[1,1]
  v_pk_mul_f32 v[100:101], v[100:101], v[240:241] op_sel:[0,1] op_sel_hi:[1,1]
  v_pk_mul_f32 v[102:103], v[102:103], v[240:241] op_sel:[0,1] op_sel_hi:[1,1]
  v_pk_mul_f32 v[104:105], v[104:105], v[240:241] op_sel:[0,1] op_sel_hi:[1,1]
  v_pk_mul_f32 v[106:107], v[106:107], v[240:241] op_sel:[0,1] op_sel_hi:[1,1]
  v_pk_mul_f32 v[108:109], v[108:109], v[240:241] op_sel:[0,1] op_sel_hi:[1,1]
  v_pk_mul_f32 v[110:111], v[110:111], v[240:241] op_sel:[0,1] op_sel_hi:[1,1]
  v_cvt_pk_bf16_f32 v96, v96, v97
  v_cvt_pk_bf16_f32 v97, v98, v99
  v_cvt_pk_bf16_f32 v98, v100, v101
  v_cvt_pk_bf16_f32 v99, v102, v103
  v_cvt_pk_bf16_f32 v100, v104, v105
  v_cvt_pk_bf16_f32 v101, v106, v107
  v_cvt_pk_bf16_f32 v102, v108, v109
  v_cvt_pk_bf16_f32 v103, v110, v111
  s_mov_b32 exec_lo, 0
  v_mov_b32 v102, 0
  v_mov_b32 v103, 0
  s_mov_b32 exec_lo, -1
  s_lshl_b32 s30, s20, 11
  s_add_u32 s30, s30, 155648
  v_add_u32 v4, s30, v1
  ds_write_b128 v4, v[96:99] offset:0
  ds_write_b128 v4, v[100:103] offset:1024
  s_waitcnt lgkmcnt(0)
  s_barrier
  s_xor_b32 s30, s20, 0
  s_lshl_b32 s30, s30, 11
  s_add_u32 s30, s30, 155648
  v_add_u32 v4, s30, v1
  ds_read_b128 a[224:227], v4 offset:0
  ds_read_b128 a[228:231], v4 offset:1024
  s_xor_b32 s30, s20, 1
  s_lshl_b32 s30, s30, 11
  s_add_u32 s30, s30, 155648
  v_add_u32 v4, s30, v1
  ds_read_b128 a[232:235], v4 offset:0
  ds_read_b128 a[236:239], v4 offset:1024
  s_xor_b32 s30, s20, 2
  s_lshl_b32 s30, s30, 11
  s_add_u32 s30, s30, 155648
  v_add_u32 v4, s30, v1
  ds_read_b128 a[240:243], v4 offset:0
  ds_read_b128 a[244:247], v4 offset:1024
  s_xor_b32 s30, s20, 3
  s_lshl_b32 s30, s30, 11
  s_add_u32 s30, s30, 155648
  v_add_u32 v4, s30, v1
  ds_read_b128 a[248:251], v4 offset:0
  ds_read_b128 a[252:255], v4 offset:1024
  v_lshrrev_b32 v58, 6, v1
  v_mul_u32_u24 v58, 3584, v58
  v_and_b32 v4, 48, v1
  v_add_u32 v58, v58, v4
  s_lshl_b32 s42, s24, 8
  s_mul_i32 s35, s20, 57344
  s_add_u32 s42, s42, s35
  s_lshl_b32 s44, s20, 10
  s_add_u32 m0, s44, 0
  s_add_u32 s43, s42, 0
  buffer_load_dwordx4 v58, s[60:63], s43 offen lds
  s_add_u32 m0, s44, 28672
  s_add_u32 s43, s42, 64
  buffer_load_dwordx4 v58, s[60:63], s43 offen lds
  s_add_u32 m0, s44, 4096
  s_add_u32 s43, s42, 229376
  buffer_load_dwordx4 v58, s[60:63], s43 offen lds
  s_add_u32 m0, s44, 32768
  s_add_u32 s43, s42, 229440
  buffer_load_dwordx4 v58, s[60:63], s43 offen lds
  s_add_u32 m0, s44, 8192
  s_add_u32 s43, s42, 458752
  buffer_load_dwordx4 v58, s[60:63], s43 offen lds
  s_add_u32 m0, s44, 36864
  s_add_u32 s43, s42, 458816
  buffer_load_dwordx4 v58, s[60:63], s43 offen lds
  s_add_u32 m0, s44, 12288
  s_add_u32 s43, s42, 688128
  buffer_load_dwordx4 v58, s[60:63], s43 offen lds
  s_add_u32 m0, s44, 40960
  s_add_u32 s43, s42, 688192
  buffer_load_dwordx4 v58, s[60:63], s43 offen lds
  s_xor_b32 s30, s20, 1
  s_mul_i32 s30, s30, 12288
  s_add_u32 s30, s30, 114688
  v_add_u32 v60, s30, v1
  s_xor_b32 s30, s20, 2
  s_mul_i32 s30, s30, 12288
  s_add_u32 s30, s30, 118784
  v_add_u32 v61, s30, v1
  s_xor_b32 s30, s20, 3
  s_mul_i32 s30, s30, 12288
  s_add_u32 s30, s30, 122880
  v_add_u32 v62, s30, v1
  s_mul_i32 s30, s20, 12288
  s_add_u32 s30, s30, 114688
  v_add_u32 v63, s30, v1
  s_lshl_b32 s30, s24, 11
  s_add_u32 s30, s30, s48
  v_xor_b32 v7, s23, v2
  v_lshlrev_b32 v7, 7, v7
  v_add_u32 v7, s30, v7
  v_mov_b32 v4, 0x7fffff00
  v_cmp_gt_u32 vcc, 256, v1
  s_nop 1
  v_cndmask_b32 v57, v4, v7, vcc
  s_mov_b32 s56, 0
  s_mov_b32 s46, s38
  s_lshl_b32 s30, s21, 8
  s_add_u32 s30, s30, 3784704
  v_lshlrev_b32 v4, 3, v2
  v_add_u32 v4, s30, v4
  v_cmp_eq_u32 vcc, 1, v3
  s_nop 1
  v_cndmask_b32 v7, v7, v4, vcc
  s_lshl_b32 s39, s24, 9
  s_lshl_b32 s35, s23, 5
  s_add_u32 s39, s39, s35
  s_lshl_b32 s35, s20, 3
  s_add_u32 s39, s39, s35
  s_add_u32 s39, s39, 3788800
  s_and_b32 s31, s24, 14
  s_lshl_b32 s30, s31, 9
  s_add_u32 s30, s30, 3788800
  v_add_u32 v56, s30, v1
  v_mul_u32_u24 v192, 15, v3
  v_add_u32 v192, 1, v192
  s_lshl_b32 s32, s28, 15
  s_lshl_b32 s35, s20, 13
  s_add_u32 s32, s32, s35
  s_add_u32 s32, s32, 1376256
  s_lshl_b32 s33, s29, 15
  s_lshl_b32 s35, s20, 13
  s_add_u32 s33, s33, s35
  s_add_u32 s33, s33, 1376256
  s_mul_i32 s38, s25, 114688
  s_lshl_b32 s35, s24, 11
  s_add_u32 s38, s38, s35
  s_add_u32 s38, s38, s18
  s_add_u32 s38, s38, 262144
  s_lshl_b32 s37, s25, 7
  s_lshl_b32 s35, s24, 3
  s_add_u32 s37, s37, s35
  s_add_u32 s37, s37, s57
  s_add_u32 s37, s37, 1246208
  s_mul_i32 s54, s22, 40960
  s_mul_i32 s35, s20, 10240
  s_add_u32 s54, s54, s35
  s_add_u32 s54, s54, s18
  s_add_u32 s55, s54, 2048
  v_lshlrev_b32 v59, 3, v1
  s_waitcnt lgkmcnt(0)
  v_mfma_f32_32x32x16_bf16 v[16:31], v[128:131], a[232:235], 0
  v_mfma_f32_32x32x16_bf16 v[16:31], v[132:135], a[236:239], v[16:31]
  s_barrier
  s_nop 10
  v_exp_f32 v16, v16
  v_exp_f32 v17, v17
  v_exp_f32 v18, v18
  v_exp_f32 v19, v19
  s_mov_b32 exec_lo, 0xe
  s_mov_b32 exec_hi, 0xffffffff
  s_mov_b32 s36, 0
mk_pl1:
  s_sleep 1
  buffer_load_dwordx2 v[4:5], v7, s[4:7], s56 offen sc1
  s_add_u32 s36, s36, 1
  s_cmp_ge_u32 s36, 0x40000
  s_cbranch_scc1 mk_end
  s_waitcnt vmcnt(0)
  v_xor_b32 v5, s59, v5
  v_cmp_ne_u32 s[34:35], s58, v4
  v_cmp_ge_u32 vcc, v5, v192
  s_nop 0
  s_or_b64 vcc, vcc, s[34:35]
  s_cbranch_vccnz mk_pl1
  s_mov_b64 exec, -1
  s_xor_b32 s40, s46, 16384
  buffer_load_dwordx4 v[144:147], v1, s[4:7], s40 offen sc1
  buffer_load_dwordx4 v[148:151], v1, s[4:7], s40 offen offset:1024 sc1
  buffer_load_dwordx4 v[152:155], v1, s[4:7], s40 offen offset:2048 sc1
  buffer_load_dwordx4 v[156:159], v1, s[4:7], s40 offen offset:3072 sc1
  v_cmp_ne_u32 vcc, s19, v5
  s_nop 0
  s_cmp_eq_u32 vcc_hi, 0
  s_cselect_b32 s17, 1, 0
  v_mov_b32 v4, s58
  v_mov_b32 v5, s59
  s_mov_b64 exec, 1
  buffer_store_dwordx2 v[4:5], v1, s[4:7], s39 offen sc1
  s_mov_b64 exec, -1
  v_exp_f32 v20, v20
  v_exp_f32 v21, v21
  v_exp_f32 v22, v22
  v_mfma_f32_32x32x16_bf16 v[32:47], v[128:131], a[240:243], 0
  s_xor_b32 s40, s46, 32768
  v_cvt_pk_bf16_f32 v48, v16, v17
  v_cvt_pk_bf16_f32 v49, v18, v19
  v_exp_f32 v23, v23
  v_exp_f32 v24, v24
  v_exp_f32 v25, v25
  v_exp_f32 v26, v26
  v_mfma_f32_32x32x16_bf16 v[32:47], v[132:135], a[244:247], v[32:47]
  buffer_load_dwordx4 v[160:163], v1, s[4:7], s40 offen sc1
  v_cvt_pk_bf16_f32 v50, v20, v21
  v_cvt_pk_bf16_f32 v51, v22, v23
  v_exp_f32 v27, v27
  v_exp_f32 v28, v28
  v_exp_f32 v29, v29
  v_exp_f32 v30, v30
  v_mfma_f32_32x32x16_bf16 v[80:95], v[136:139], v[48:51], 0
  buffer_load_dwordx4 v[164:167], v1, s[4:7], s40 offen offset:1024 sc1
  v_exp_f32 v31, v31
  v_cvt_pk_bf16_f32 v52, v24, v25
  v_cvt_pk_bf16_f32 v53, v26, v27
  v_cvt_pk_bf16_f32 v54, v28, v29
  v_cvt_pk_bf16_f32 v55, v30, v31
  v_exp_f32 v32, v32
  v_exp_f32 v33, v33
  v_exp_f32 v34, v34
  v_exp_f32 v35, v35
  v_mfma_f32_32x32x16_bf16 v[80:95], v[140:143], v[52:55], v[80:95]
  buffer_load_dwordx4 v[168:171], v1, s[4:7], s40 offen offset:2048 sc1
  v_exp_f32 v36, v36
  v_exp_f32 v37, v37
  v_exp_f32 v38, v38
  v_mfma_f32_32x32x16_bf16 v[16:31], v[128:131], a[248:251], 0
  buffer_load_dwordx4 v[172:175], v1, s[4:7], s40 offen offset:3072 sc1
  v_cvt_pk_bf16_f32 v48, v32, v33
  v_cvt_pk_bf16_f32 v49, v34, v35
  v_exp_f32 v39, v39
  v_exp_f32 v40, v40
  v_exp_f32 v41, v41
  v_exp_f32 v42, v42
  v_mfma_f32_32x32x16_bf16 v[16:31], v[132:135], a[252:255], v[16:31]
  buffer_load_dwordx2 v[4:5], v57, s[4:7], s56 offen sc1
  v_cvt_pk_bf16_f32 v50, v36, v37
  v_cvt_pk_bf16_f32 v51, v38, v39
  v_exp_f32 v43, v43
  v_exp_f32 v44, v44
  v_exp_f32 v45, v45
  v_exp_f32 v46, v46
  v_mfma_f32_32x32x16_bf16 v[96:111], v[136:139], v[48:51], 0
  s_xor_b32 s40, s46, 49152
  v_exp_f32 v47, v47
  v_cvt_pk_bf16_f32 v52, v40, v41
  v_cvt_pk_bf16_f32 v53, v42, v43
  v_cvt_pk_bf16_f32 v54, v44, v45
  v_cvt_pk_bf16_f32 v55, v46, v47
  v_exp_f32 v16, v16
  v_exp_f32 v17, v17
  v_exp_f32 v18, v18
  v_exp_f32 v19, v19
  v_mfma_f32_32x32x16_bf16 v[96:111], v[140:143], v[52:55], v[96:111]
  buffer_load_dwordx4 v[176:179], v1, s[4:7], s40 offen sc1
  v_exp_f32 v20, v20
  v_exp_f32 v21, v21
  v_exp_f32 v22, v22
  v_mfma_f32_32x32x16_bf16 v[32:47], v[128:131], a[224:227], 0
  buffer_load_dwordx4 v[180:183], v1, s[4:7], s40 offen offset:1024 sc1
  v_cvt_pk_bf16_f32 v48, v16, v17
  v_cvt_pk_bf16_f32 v49, v18, v19
  v_exp_f32 v23, v23
  v_exp_f32 v24, v24
  v_exp_f32 v25, v25
  v_exp_f32 v26, v26
  v_mfma_f32_32x32x16_bf16 v[32:47], v[132:135], a[228:231], v[32:47]
  buffer_load_dwordx4 v[184:187], v1, s[4:7], s40 offen offset:2048 sc1
  v_cvt_pk_bf16_f32 v50, v20, v21
  v_cvt_pk_bf16_f32 v51, v22, v23
  v_exp_f32 v27, v27
  v_exp_f32 v28, v28
  v_exp_f32 v29, v29
  v_exp_f32 v30, v30
  v_mfma_f32_32x32x16_bf16 v[112:127], v[136:139], v[48:51], 0
  buffer_load_dwordx4 v[188:191], v1, s[4:7], s40 offen offset:3072 sc1
  v_exp_f32 v31, v31
  v_cvt_pk_bf16_f32 v52, v24, v25
  v_cvt_pk_bf16_f32 v53, v26, v27
  v_cvt_pk_bf16_f32 v54, v28, v29
  v_cvt_pk_bf16_f32 v55, v30, v31
  v_exp_f32 v32, v32
  v_exp_f32 v33, v33
  v_exp_f32 v34, v34
  v_exp_f32 v35, v35
  v_mfma_f32_32x32x16_bf16 v[112:127], v[140:143], v[52:55], v[112:127]
  s_waitcnt vmcnt(10)
  v_exp_f32 v36, v36
  v_exp_f32 v37, v37
  v_exp_f32 v38, v38
  v_mfma_f32_32x32x16_bf16 v[16:31], v[144:147], a[232:235], 0
  v_cvt_pk_bf16_f32 v48, v32, v33
  v_cvt_pk_bf16_f32 v49, v34, v35
  v_exp_f32 v39, v39
  v_exp_f32 v40, v40
  v_exp_f32 v41, v41
  v_exp_f32 v42, v42
  v_mfma_f32_32x32x16_bf16 v[16:31], v[148:151], a[236:239], v[16:31]
  v_cvt_pk_bf16_f32 v50, v36, v37
  v_cvt_pk_bf16_f32 v51, v38, v39
  v_exp_f32 v43, v43
  v_exp_f32 v44, v44
  v_exp_f32 v45, v45
  v_exp_f32 v46, v46
  v_mfma_f32_32x32x16_bf16 v[64:79], v[136:139], v[48:51], 0
  v_exp_f32 v47, v47
  v_cvt_pk_bf16_f32 v52, v40, v41
  v_cvt_pk_bf16_f32 v53, v42, v43
  v_cvt_pk_bf16_f32 v54, v44, v45
  v_cvt_pk_bf16_f32 v55, v46, v47
  v_exp_f32 v16, v16
  v_exp_f32 v17, v17
  v_exp_f32 v18, v18
  v_exp_f32 v19, v19
  v_mfma_f32_32x32x16_bf16 v[64:79], v[140:143], v[52:55], v[64:79]
  v_exp_f32 v20, v20
  v_exp_f32 v21, v21
  v_exp_f32 v22, v22
  v_mfma_f32_32x32x16_bf16 v[32:47], v[144:147], a[240:243], 0
  s_add_u32 m0, s44, 16384
  v_cvt_pk_bf16_f32 v48, v16, v17
  v_cvt_pk_bf16_f32 v49, v18, v19
  v_exp_f32 v23, v23
  v_exp_f32 v24, v24
  v_exp_f32 v25, v25
  v_exp_f32 v26, v26
  v_mfma_f32_32x32x16_bf16 v[32:47], v[148:151], a[244:247], v[32:47]
  s_add_u32 s43, s42, 917504
  v_cvt_pk_bf16_f32 v50, v20, v21
  v_cvt_pk_bf16_f32 v51, v22, v23
  v_exp_f32 v27, v27
  v_exp_f32 v28, v28
  v_exp_f32 v29, v29
  v_exp_f32 v30, v30
  v_mfma_f32_32x32x16_bf16 v[80:95], v[152:155], v[48:51], v[80:95]
  buffer_load_dwordx4 v58, s[60:63], s43 offen lds
  v_exp_f32 v31, v31
  v_cvt_pk_bf16_f32 v52, v24, v25
  v_cvt_pk_bf16_f32 v53, v26, v27
  v_cvt_pk_bf16_f32 v54, v28, v29
  v_cvt_pk_bf16_f32 v55, v30, v31
  v_exp_f32 v32, v32
  v_exp_f32 v33, v33
  v_exp_f32 v34, v34
  v_exp_f32 v35, v35
  v_mfma_f32_32x32x16_bf16 v[80:95], v[156:159], v[52:55], v[80:95]
  v_exp_f32 v36, v36
  v_exp_f32 v37, v37
  v_exp_f32 v38, v38
  v_mfma_f32_32x32x16_bf16 v[16:31], v[144:147], a[248:251], 0
  s_add_u32 m0, s44, 45056
  v_cvt_pk_bf16_f32 v48, v32, v33
  v_cvt_pk_bf16_f32 v49, v34, v35
  v_exp_f32 v39, v39
  v_exp_f32 v40, v40
  v_exp_f32 v41, v41
  v_exp_f32 v42, v42
  v_mfma_f32_32x32x16_bf16 v[16:31], v[148:151], a[252:255], v[16:31]
  s_add_u32 s43, s42, 917568
  v_cvt_pk_bf16_f32 v50, v36, v37
  v_cvt_pk_bf16_f32 v51, v38, v39
  v_exp_f32 v43, v43
  v_exp_f32 v44, v44
  v_exp_f32 v45, v45
  v_exp_f32 v46, v46
  v_mfma_f32_32x32x16_bf16 v[96:111], v[152:155], v[48:51], v[96:111]
  buffer_load_dwordx4 v58, s[60:63], s43 offen lds
  v_exp_f32 v47, v47
  v_cvt_pk_bf16_f32 v52, v40, v41
  v_cvt_pk_bf16_f32 v53, v42, v43
  v_cvt_pk_bf16_f32 v54, v44, v45
  v_cvt_pk_bf16_f32 v55, v46, v47
  v_exp_f32 v16, v16
  v_exp_f32 v17, v17
  v_exp_f32 v18, v18
  v_exp_f32 v19, v19
  v_mfma_f32_32x32x16_bf16 v[96:111], v[156:159], v[52:55], v[96:111]
  v_exp_f32 v20, v20
  v_exp_f32 v21, v21
  v_exp_f32 v22, v22
  v_mfma_f32_32x32x16_bf16 v[32:47], v[144:147], a[224:227], 0
  s_add_u32 m0, s44, 20480
  v_cvt_pk_bf16_f32 v48, v16, v17
  v_cvt_pk_bf16_f32 v49, v18, v19
  v_exp_f32 v23, v23
  v_exp_f32 v24, v24
  v_exp_f32 v25, v25
  v_exp_f32 v26, v26
  v_mfma_f32_32x32x16_bf16 v[32:47], v[148:151], a[228:231], v[32:47]
  s_add_u32 s43, s42, 1146880
  v_cvt_pk_bf16_f32 v50, v20, v21
  v_cvt_pk_bf16_f32 v51, v22, v23
  v_exp_f32 v27, v27
  v_exp_f32 v28, v28
  v_exp_f32 v29, v29
  v_exp_f32 v30, v30
  v_mfma_f32_32x32x16_bf16 v[112:127], v[152:155], v[48:51], v[112:127]
  v_exp_f32 v31, v31
  v_cvt_pk_bf16_f32 v52, v24, v25
  v_cvt_pk_bf16_f32 v53, v26, v27
  v_cvt_pk_bf16_f32 v54, v28, v29
  v_cvt_pk_bf16_f32 v55, v30, v31
  v_exp_f32 v32, v32
  v_exp_f32 v33, v33
  v_exp_f32 v34, v34
  v_exp_f32 v35, v35
  v_mfma_f32_32x32x16_bf16 v[112:127], v[156:159], v[52:55], v[112:127]
  s_waitcnt vmcnt(7)
  v_exp_f32 v36, v36
  v_exp_f32 v37, v37
  v_exp_f32 v38, v38
  v_mfma_f32_32x32x16_bf16 v[16:31], v[160:163], a[232:235], 0
  buffer_load_dwordx4 v58, s[60:63], s43 offen lds
  v_cvt_pk_bf16_f32 v48, v32, v33
  v_cvt_pk_bf16_f32 v49, v34, v35
  v_exp_f32 v39, v39
  v_exp_f32 v40, v40
  v_exp_f32 v41, v41
  v_exp_f32 v42, v42
  v_mfma_f32_32x32x16_bf16 v[16:31], v[164:167], a[236:239], v[16:31]
  s_add_u32 m0, s44, 49152
  v_cvt_pk_bf16_f32 v50, v36, v37
  v_cvt_pk_bf16_f32 v51, v38, v39
  v_exp_f32 v43, v43
  v_exp_f32 v44, v44
  v_exp_f32 v45, v45
  v_exp_f32 v46, v46
  v_mfma_f32_32x32x16_bf16 v[64:79], v[152:155], v[48:51], v[64:79]
  s_add_u32 s43, s42, 1146944
  v_exp_f32 v47, v47
  v_cvt_pk_bf16_f32 v52, v40, v41
  v_cvt_pk_bf16_f32 v53, v42, v43
  v_cvt_pk_bf16_f32 v54, v44, v45
  v_cvt_pk_bf16_f32 v55, v46, v47
  v_exp_f32 v16, v16
  v_exp_f32 v17, v17
  v_exp_f32 v18, v18
  v_exp_f32 v19, v19
  v_mfma_f32_32x32x16_bf16 v[64:79], v[156:159], v[52:55], v[64:79]
  v_exp_f32 v20, v20
  v_exp_f32 v21, v21
  v_exp_f32 v22, v22
  v_mfma_f32_32x32x16_bf16 v[32:47], v[160:163], a[240:243], 0
  s_waitcnt vmcnt(7)
  v_cmp_ne_u64 vcc, s[58:59], v[4:5]
  s_nop 0
  s_and_b32 s34, vcc_lo, 0xf0
  s_cbranch_scc1 mk_fs3
mk_fr4:
  v_cvt_pk_bf16_f32 v48, v16, v17
  v_cvt_pk_bf16_f32 v49, v18, v19
  v_exp_f32 v23, v23
  v_exp_f32 v24, v24
  v_exp_f32 v25, v25
  v_exp_f32 v26, v26
  v_mfma_f32_32x32x16_bf16 v[32:47], v[164:167], a[244:247], v[32:47]
  s_xor_b32 s40, s46, 65536
  v_cvt_pk_bf16_f32 v50, v20, v21
  v_cvt_pk_bf16_f32 v51, v22, v23
  v_exp_f32 v27, v27
  v_exp_f32 v28, v28
  v_exp_f32 v29, v29
  v_exp_f32 v30, v30
  v_mfma_f32_32x32x16_bf16 v[80:95], v[168:171], v[48:51], v[80:95]
  buffer_load_dwordx4 v[128:131], v1, s[4:7], s40 offen sc1
  v_exp_f32 v31, v31
  v_cvt_pk_bf16_f32 v52, v24, v25
  v_cvt_pk_bf16_f32 v53, v26, v27
  v_cvt_pk_bf16_f32 v54, v28, v29
  v_cvt_pk_bf16_f32 v55, v30, v31
  v_exp_f32 v32, v32
  v_exp_f32 v33, v33
  v_exp_f32 v34, v34
  v_exp_f32 v35, v35
  v_mfma_f32_32x32x16_bf16 v[80:95], v[172:175], v[52:55], v[80:95]
  buffer_load_dwordx4 v[132:135], v1, s[4:7], s40 offen offset:1024 sc1
  v_exp_f32 v36, v36
  v_exp_f32 v37, v37
  v_exp_f32 v38, v38
  v_mfma_f32_32x32x16_bf16 v[16:31], v[160:163], a[248:251], 0
  buffer_load_dwordx4 v[136:139], v1, s[4:7], s40 offen offset:2048 sc1
  v_cvt_pk_bf16_f32 v48, v32, v33
  v_cvt_pk_bf16_f32 v49, v34, v35
  v_exp_f32 v39, v39
  v_exp_f32 v40, v40
  v_exp_f32 v41, v41
  v_exp_f32 v42, v42
  v_mfma_f32_32x32x16_bf16 v[16:31], v[164:167], a[252:255], v[16:31]
  buffer_load_dwordx4 v[140:143], v1, s[4:7], s40 offen offset:3072 sc1
  v_cvt_pk_bf16_f32 v50, v36, v37
  v_cvt_pk_bf16_f32 v51, v38, v39
  v_exp_f32 v43, v43
  v_exp_f32 v44, v44
  v_exp_f32 v45, v45
  v_exp_f32 v46, v46
  v_mfma_f32_32x32x16_bf16 v[96:111], v[168:171], v[48:51], v[96:111]
  s_xor_b32 s40, s46, 81920
  v_exp_f32 v47, v47
  v_cvt_pk_bf16_f32 v52, v40, v41
  v_cvt_pk_bf16_f32 v53, v42, v43
  v_cvt_pk_bf16_f32 v54, v44, v45
  v_cvt_pk_bf16_f32 v55, v46, v47
  v_exp_f32 v16, v16
  v_exp_f32 v17, v17
  v_exp_f32 v18, v18
  v_exp_f32 v19, v19
  v_mfma_f32_32x32x16_bf16 v[96:111], v[172:175], v[52:55], v[96:111]
  buffer_load_dwordx4 v[144:147], v1, s[4:7], s40 offen sc1
  v_exp_f32 v20, v20
  v_exp_f32 v21, v21
  v_exp_f32 v22, v22
  v_mfma_f32_32x32x16_bf16 v[32:47], v[160:163], a[224:227], 0
  buffer_load_dwordx4 v[148:151], v1, s[4:7], s40 offen offset:1024 sc1
  v_cvt_pk_bf16_f32 v48, v16, v17
  v_cvt_pk_bf16_f32 v49, v18, v19
  v_exp_f32 v23, v23
  v_exp_f32 v24, v24
  v_exp_f32 v25, v25
  v_exp_f32 v26, v26
  v_mfma_f32_32x32x16_bf16 v[32:47], v[164:167], a[228:231], v[32:47]
  buffer_load_dwordx4 v[152:155], v1, s[4:7], s40 offen offset:2048 sc1
  v_cvt_pk_bf16_f32 v50, v20, v21
  v_cvt_pk_bf16_f32 v51, v22, v23
  v_exp_f32 v27, v27
  v_exp_f32 v28, v28
  v_exp_f32 v29, v29
  v_exp_f32 v30, v30
  v_mfma_f32_32x32x16_bf16 v[112:127], v[168:171], v[48:51], v[112:127]
  buffer_load_dwordx4 v[156:159], v1, s[4:7], s40 offen offset:3072 sc1
  v_exp_f32 v31, v31
  v_cvt_pk_bf16_f32 v52, v24, v25
  v_cvt_pk_bf16_f32 v53, v26, v27
  v_cvt_pk_bf16_f32 v54, v28, v29
  v_cvt_pk_bf16_f32 v55, v30, v31
  v_exp_f32 v32, v32
  v_exp_f32 v33, v33
  v_exp_f32 v34, v34
  v_exp_f32 v35, v35
  v_mfma_f32_32x32x16_bf16 v[112:127], v[172:175], v[52:55], v[112:127]
  s_waitcnt vmcnt(11)
  v_exp_f32 v36, v36
  v_exp_f32 v37, v37
  v_exp_f32 v38, v38
  v_mfma_f32_32x32x16_bf16 v[16:31], v[176:179], a[232:235], 0
  buffer_load_dwordx4 v58, s[60:63], s43 offen lds
  v_cvt_pk_bf16_f32 v48, v32, v33
  v_cvt_pk_bf16_f32 v49, v34, v35
  v_exp_f32 v39, v39
  v_exp_f32 v40, v40
  v_exp_f32 v41, v41
  v_exp_f32 v42, v42
  v_mfma_f32_32x32x16_bf16 v[16:31], v[180:183], a[236:239], v[16:31]
  s_add_u32 m0, s44, 24576
  v_cvt_pk_bf16_f32 v50, v36, v37
  v_cvt_pk_bf16_f32 v51, v38, v39
  v_exp_f32 v43, v43
  v_exp_f32 v44, v44
  v_exp_f32 v45, v45
  v_exp_f32 v46, v46
  v_mfma_f32_32x32x16_bf16 v[64:79], v[168:171], v[48:51], v[64:79]
  s_add_u32 s43, s42, 1376256
  v_exp_f32 v47, v47
  v_cvt_pk_bf16_f32 v52, v40, v41
  v_cvt_pk_bf16_f32 v53, v42, v43
  v_cvt_pk_bf16_f32 v54, v44, v45
  v_cvt_pk_bf16_f32 v55, v46, v47
  v_exp_f32 v16, v16
  v_exp_f32 v17, v17
  v_exp_f32 v18, v18
  v_exp_f32 v19, v19
  v_mfma_f32_32x32x16_bf16 v[64:79], v[172:175], v[52:55], v[64:79]
  buffer_load_dwordx4 v58, s[60:63], s43 offen lds
  v_exp_f32 v20, v20
  v_exp_f32 v21, v21
  v_exp_f32 v22, v22
  v_mfma_f32_32x32x16_bf16 v[32:47], v[176:179], a[240:243], 0
  buffer_load_dwordx2 v[4:5], v57, s[4:7], s56 offen sc1
  v_cvt_pk_bf16_f32 v48, v16, v17
  v_cvt_pk_bf16_f32 v49, v18, v19
  v_exp_f32 v23, v23
  v_exp_f32 v24, v24
  v_exp_f32 v25, v25
  v_exp_f32 v26, v26
  v_mfma_f32_32x32x16_bf16 v[32:47], v[180:183], a[244:247], v[32:47]
  s_xor_b32 s40, s46, 98304
  v_cvt_pk_bf16_f32 v50, v20, v21
  v_cvt_pk_bf16_f32 v51, v22, v23
  v_exp_f32 v27, v27
  v_exp_f32 v28, v28
  v_exp_f32 v29, v29
  v_exp_f32 v30, v30
  v_mfma_f32_32x32x16_bf16 v[80:95], v[184:187], v[48:51], v[80:95]
  buffer_load_dwordx4 v[160:163], v1, s[4:7], s40 offen sc1
  v_exp_f32 v31, v31
  v_cvt_pk_bf16_f32 v52, v24, v25
  v_cvt_pk_bf16_f32 v53, v26, v27
  v_cvt_pk_bf16_f32 v54, v28, v29
  v_cvt_pk_bf16_f32 v55, v30, v31
  v_exp_f32 v32, v32
  v_exp_f32 v33, v33
  v_exp_f32 v34, v34
  v_exp_f32 v35, v35
  v_mfma_f32_32x32x16_bf16 v[80:95], v[188:191], v[52:55], v[80:95]
  buffer_load_dwordx4 v[164:167], v1, s[4:7], s40 offen offset:1024 sc1
  v_exp_f32 v36, v36
  v_exp_f32 v37, v37
  v_exp_f32 v38, v38
  v_mfma_f32_32x32x16_bf16 v[16:31], v[176:179], a[248:251], 0
  buffer_load_dwordx4 v[168:171], v1, s[4:7], s40 offen offset:2048 sc1
  v_cvt_pk_bf16_f32 v48, v32, v33
  v_cvt_pk_bf16_f32 v49, v34, v35
  v_exp_f32 v39, v39
  v_exp_f32 v40, v40
  v_exp_f32 v41, v41
  v_exp_f32 v42, v42
  v_mfma_f32_32x32x16_bf16 v[16:31], v[180:183], a[252:255], v[16:31]
  buffer_load_dwordx4 v[172:175], v1, s[4:7], s40 offen offset:3072 sc1
  v_cvt_pk_bf16_f32 v50, v36, v37
  v_cvt_pk_bf16_f32 v51, v38, v39
  v_exp_f32 v43, v43
  v_exp_f32 v44, v44
  v_exp_f32 v45, v45
  v_exp_f32 v46, v46
  v_mfma_f32_32x32x16_bf16 v[96:111], v[184:187], v[48:51], v[96:111]
  s_add_u32 m0, s44, 53248
  v_exp_f32 v47, v47
  v_cvt_pk_bf16_f32 v52, v40, v41
  v_cvt_pk_bf16_f32 v53, v42, v43
  v_cvt_pk_bf16_f32 v54, v44, v45
  v_cvt_pk_bf16_f32 v55, v46, v47
  v_exp_f32 v16, v16
  v_exp_f32 v17, v17
  v_exp_f32 v18, v18
  v_exp_f32 v19, v19
  v_mfma_f32_32x32x16_bf16 v[96:111], v[188:191], v[52:55], v[96:111]
  s_add_u32 s43, s42, 1376320
  v_exp_f32 v20, v20
  v_exp_f32 v21, v21
  v_exp_f32 v22, v22
  v_mfma_f32_32x32x16_bf16 v[32:47], v[176:179], a[224:227], 0
  buffer_load_dwordx4 v58, s[60:63], s43 offen lds
  v_cvt_pk_bf16_f32 v48, v16, v17
  v_cvt_pk_bf16_f32 v49, v18, v19
  v_exp_f32 v23, v23
  v_exp_f32 v24, v24
  v_exp_f32 v25, v25
  v_exp_f32 v26, v26
  v_mfma_f32_32x32x16_bf16 v[32:47], v[180:183], a[228:231], v[32:47]
  s_add_u32 m0, s44, 57344
  v_cvt_pk_bf16_f32 v50, v20, v21
  v_cvt_pk_bf16_f32 v51, v22, v23
  v_exp_f32 v27, v27
  v_exp_f32 v28, v28
  v_exp_f32 v29, v29
  v_exp_f32 v30, v30
  v_mfma_f32_32x32x16_bf16 v[112:127], v[184:187], v[48:51], v[112:127]
  s_add_u32 s43, s42, 128
  v_exp_f32 v31, v31
  v_cvt_pk_bf16_f32 v52, v24, v25
  v_cvt_pk_bf16_f32 v53, v26, v27
  v_cvt_pk_bf16_f32 v54, v28, v29
  v_cvt_pk_bf16_f32 v55, v30, v31
  v_exp_f32 v32, v32
  v_exp_f32 v33, v33
  v_exp_f32 v34, v34
  v_exp_f32 v35, v35
  v_mfma_f32_32x32x16_bf16 v[112:127], v[188:191], v[52:55], v[112:127]
  s_waitcnt vmcnt(12)
  v_exp_f32 v36, v36
  v_exp_f32 v37, v37
  v_exp_f32 v38, v38
  v_mfma_f32_32x32x16_bf16 v[16:31], v[128:131], a[232:235], 0
  buffer_load_dwordx4 v58, s[60:63], s43 offen lds
  v_cvt_pk_bf16_f32 v48, v32, v33
  v_cvt_pk_bf16_f32 v49, v34, v35
  v_exp_f32 v39, v39
  v_exp_f32 v40, v40
  v_exp_f32 v41, v41
  v_exp_f32 v42, v42
  v_mfma_f32_32x32x16_bf16 v[16:31], v[132:135], a[236:239], v[16:31]
  s_add_u32 m0, s44, 86016
  v_cvt_pk_bf16_f32 v50, v36, v37
  v_cvt_pk_bf16_f32 v51, v38, v39
  v_exp_f32 v43, v43
  v_exp_f32 v44, v44
  v_exp_f32 v45, v45
  v_exp_f32 v46, v46
  v_mfma_f32_32x32x16_bf16 v[64:79], v[184:187], v[48:51], v[64:79]
  s_add_u32 s43, s42, 192
  v_exp_f32 v47, v47
  v_cvt_pk_bf16_f32 v52, v40, v41
  v_cvt_pk_bf16_f32 v53, v42, v43
  v_cvt_pk_bf16_f32 v54, v44, v45
  v_cvt_pk_bf16_f32 v55, v46, v47
  v_exp_f32 v16, v16
  v_exp_f32 v17, v17
  v_exp_f32 v18, v18
  v_exp_f32 v19, v19
  v_mfma_f32_32x32x16_bf16 v[64:79], v[188:191], v[52:55], v[64:79]
  buffer_load_dwordx4 v58, s[60:63], s43 offen lds
  v_exp_f32 v20, v20
  v_exp_f32 v21, v21
  v_exp_f32 v22, v22
  v_mfma_f32_32x32x16_bf16 v[32:47], v[128:131], a[240:243], 0
  buffer_load_dwordx4 v[192:195], v56, s[4:7], s56 offen sc1
  v_cvt_pk_bf16_f32 v48, v16, v17
  v_cvt_pk_bf16_f32 v49, v18, v19
  v_exp_f32 v23, v23
  v_exp_f32 v24, v24
  v_exp_f32 v25, v25
  v_exp_f32 v26, v26
  v_mfma_f32_32x32x16_bf16 v[32:47], v[132:135], a[244:247], v[32:47]
  s_xor_b32 s40, s46, 114688
  v_cvt_pk_bf16_f32 v50, v20, v21
  v_cvt_pk_bf16_f32 v51, v22, v23
  v_exp_f32 v27, v27
  v_exp_f32 v28, v28
  v_exp_f32 v29, v29
  v_exp_f32 v30, v30
  v_mfma_f32_32x32x16_bf16 v[80:95], v[136:139], v[48:51], v[80:95]
  buffer_load_dwordx4 v[176:179], v1, s[4:7], s40 offen sc1
  v_exp_f32 v31, v31
  v_cvt_pk_bf16_f32 v52, v24, v25
  v_cvt_pk_bf16_f32 v53, v26, v27
  v_cvt_pk_bf16_f32 v54, v28, v29
  v_cvt_pk_bf16_f32 v55, v30, v31
  v_exp_f32 v32, v32
  v_exp_f32 v33, v33
  v_exp_f32 v34, v34
  v_exp_f32 v35, v35
  v_mfma_f32_32x32x16_bf16 v[80:95], v[140:143], v[52:55], v[80:95]
  buffer_load_dwordx4 v[180:183], v1, s[4:7], s40 offen offset:1024 sc1
  v_exp_f32 v36, v36
  v_exp_f32 v37, v37
  v_exp_f32 v38, v38
  v_mfma_f32_32x32x16_bf16 v[16:31], v[128:131], a[248:251], 0
  buffer_load_dwordx4 v[184:187], v1, s[4:7], s40 offen offset:2048 sc1
  v_cvt_pk_bf16_f32 v48, v32, v33
  v_cvt_pk_bf16_f32 v49, v34, v35
  v_exp_f32 v39, v39
  v_exp_f32 v40, v40
  v_exp_f32 v41, v41
  v_exp_f32 v42, v42
  v_mfma_f32_32x32x16_bf16 v[16:31], v[132:135], a[252:255], v[16:31]
  buffer_load_dwordx4 v[188:191], v1, s[4:7], s40 offen offset:3072 sc1
  v_cvt_pk_bf16_f32 v50, v36, v37
  v_cvt_pk_bf16_f32 v51, v38, v39
  v_exp_f32 v43, v43
  v_exp_f32 v44, v44
  v_exp_f32 v45, v45
  v_exp_f32 v46, v46
  v_mfma_f32_32x32x16_bf16 v[96:111], v[136:139], v[48:51], v[96:111]
  s_add_u32 m0, s44, 61440
  v_exp_f32 v47, v47
  v_cvt_pk_bf16_f32 v52, v40, v41
  v_cvt_pk_bf16_f32 v53, v42, v43
  v_cvt_pk_bf16_f32 v54, v44, v45
  v_cvt_pk_bf16_f32 v55, v46, v47
  v_exp_f32 v16, v16
  v_exp_f32 v17, v17
  v_exp_f32 v18, v18
  v_exp_f32 v19, v19
  v_mfma_f32_32x32x16_bf16 v[96:111], v[140:143], v[52:55], v[96:111]
  s_add_u32 s43, s42, 229504
  v_exp_f32 v20, v20
  v_exp_f32 v21, v21
  v_exp_f32 v22, v22
  v_mfma_f32_32x32x16_bf16 v[32:47], v[128:131], a[224:227], 0
  buffer_load_dwordx4 v58, s[60:63], s43 offen lds
  v_cvt_pk_bf16_f32 v48, v16, v17
  v_cvt_pk_bf16_f32 v49, v18, v19
  v_exp_f32 v23, v23
  v_exp_f32 v24, v24
  v_exp_f32 v25, v25
  v_exp_f32 v26, v26
  v_mfma_f32_32x32x16_bf16 v[32:47], v[132:135], a[228:231], v[32:47]
  s_add_u32 m0, s44, 90112
  v_cvt_pk_bf16_f32 v50, v20, v21
  v_cvt_pk_bf16_f32 v51, v22, v23
  v_exp_f32 v27, v27
  v_exp_f32 v28, v28
  v_exp_f32 v29, v29
  v_exp_f32 v30, v30
  v_mfma_f32_32x32x16_bf16 v[112:127], v[136:139], v[48:51], v[112:127]
  s_add_u32 s43, s42, 229568
  v_exp_f32 v31, v31
  v_cvt_pk_bf16_f32 v52, v24, v25
  v_cvt_pk_bf16_f32 v53, v26, v27
  v_cvt_pk_bf16_f32 v54, v28, v29
  v_cvt_pk_bf16_f32 v55, v30, v31
  v_exp_f32 v32, v32
  v_exp_f32 v33, v33
  v_exp_f32 v34, v34
  v_exp_f32 v35, v35
  v_mfma_f32_32x32x16_bf16 v[112:127], v[140:143], v[52:55], v[112:127]
  s_waitcnt vmcnt(16)
  v_exp_f32 v36, v36
  v_exp_f32 v37, v37
  v_exp_f32 v38, v38
  v_mfma_f32_32x32x16_bf16 v[16:31], v[144:147], a[232:235], 0
  buffer_load_dwordx4 v58, s[60:63], s43 offen lds
  v_cvt_pk_bf16_f32 v48, v32, v33
  v_cvt_pk_bf16_f32 v49, v34, v35
  v_exp_f32 v39, v39
  v_exp_f32 v40, v40
  v_exp_f32 v41, v41
  v_exp_f32 v42, v42
  v_mfma_f32_32x32x16_bf16 v[16:31], v[148:151], a[236:239], v[16:31]
  s_add_u32 m0, s44, 65536
  v_cvt_pk_bf16_f32 v50, v36, v37
  v_cvt_pk_bf16_f32 v51, v38, v39
  v_exp_f32 v43, v43
  v_exp_f32 v44, v44
  v_exp_f32 v45, v45
  v_exp_f32 v46, v46
  v_mfma_f32_32x32x16_bf16 v[64:79], v[136:139], v[48:51], v[64:79]
  s_add_u32 s43, s42, 458880
  v_exp_f32 v47, v47
  v_cvt_pk_bf16_f32 v52, v40, v41
  v_cvt_pk_bf16_f32 v53, v42, v43
  v_cvt_pk_bf16_f32 v54, v44, v45
  v_cvt_pk_bf16_f32 v55, v46, v47
  v_exp_f32 v16, v16
  v_exp_f32 v17, v17
  v_exp_f32 v18, v18
  v_exp_f32 v19, v19
  v_mfma_f32_32x32x16_bf16 v[64:79], v[140:143], v[52:55], v[64:79]
  buffer_load_dwordx4 v58, s[60:63], s43 offen lds
  v_exp_f32 v20, v20
  v_exp_f32 v21, v21
  v_exp_f32 v22, v22
  v_mfma_f32_32x32x16_bf16 v[32:47], v[144:147], a[240:243], 0
  s_waitcnt vmcnt(15)
  v_cmp_ne_u64 vcc, s[58:59], v[4:5]
  s_nop 0
  s_and_b32 s34, vcc_lo, 0xff00
  s_cbranch_scc1 mk_fs5
mk_fr6:
  v_cvt_pk_bf16_f32 v48, v16, v17
  v_cvt_pk_bf16_f32 v49, v18, v19
  v_exp_f32 v23, v23
  v_exp_f32 v24, v24
  v_exp_f32 v25, v25
  v_exp_f32 v26, v26
  v_mfma_f32_32x32x16_bf16 v[32:47], v[148:151], a[244:247], v[32:47]
  s_xor_b32 s40, s46, 131072
  v_cvt_pk_bf16_f32 v50, v20, v21
  v_cvt_pk_bf16_f32 v51, v22, v23
  v_exp_f32 v27, v27
  v_exp_f32 v28, v28
  v_exp_f32 v29, v29
  v_exp_f32 v30, v30
  v_mfma_f32_32x32x16_bf16 v[80:95], v[152:155], v[48:51], v[80:95]
  buffer_load_dwordx4 v[128:131], v1, s[4:7], s40 offen sc1
  v_exp_f32 v31, v31
  v_cvt_pk_bf16_f32 v52, v24, v25
  v_cvt_pk_bf16_f32 v53, v26, v27
  v_cvt_pk_bf16_f32 v54, v28, v29
  v_cvt_pk_bf16_f32 v55, v30, v31
  v_exp_f32 v32, v32
  v_exp_f32 v33, v33
  v_exp_f32 v34, v34
  v_exp_f32 v35, v35
  v_mfma_f32_32x32x16_bf16 v[80:95], v[156:159], v[52:55], v[80:95]
  buffer_load_dwordx4 v[132:135], v1, s[4:7], s40 offen offset:1024 sc1
  v_exp_f32 v36, v36
  v_exp_f32 v37, v37
  v_exp_f32 v38, v38
  v_mfma_f32_32x32x16_bf16 v[16:31], v[144:147], a[248:251], 0
  buffer_load_dwordx4 v[136:139], v1, s[4:7], s40 offen offset:2048 sc1
  v_cvt_pk_bf16_f32 v48, v32, v33
  v_cvt_pk_bf16_f32 v49, v34, v35
  v_exp_f32 v39, v39
  v_exp_f32 v40, v40
  v_exp_f32 v41, v41
  v_exp_f32 v42, v42
  v_mfma_f32_32x32x16_bf16 v[16:31], v[148:151], a[252:255], v[16:31]
  buffer_load_dwordx4 v[140:143], v1, s[4:7], s40 offen offset:3072 sc1
  v_cvt_pk_bf16_f32 v50, v36, v37
  v_cvt_pk_bf16_f32 v51, v38, v39
  v_exp_f32 v43, v43
  v_exp_f32 v44, v44
  v_exp_f32 v45, v45
  v_exp_f32 v46, v46
  v_mfma_f32_32x32x16_bf16 v[96:111], v[152:155], v[48:51], v[96:111]
  s_add_u32 m0, s44, 94208
  v_exp_f32 v47, v47
  v_cvt_pk_bf16_f32 v52, v40, v41
  v_cvt_pk_bf16_f32 v53, v42, v43
  v_cvt_pk_bf16_f32 v54, v44, v45
  v_cvt_pk_bf16_f32 v55, v46, v47
  v_exp_f32 v16, v16
  v_exp_f32 v17, v17
  v_exp_f32 v18, v18
  v_exp_f32 v19, v19
  v_mfma_f32_32x32x16_bf16 v[96:111], v[156:159], v[52:55], v[96:111]
  s_add_u32 s43, s42, 458944
  v_exp_f32 v20, v20
  v_exp_f32 v21, v21
  v_exp_f32 v22, v22
  v_mfma_f32_32x32x16_bf16 v[32:47], v[144:147], a[224:227], 0
  buffer_load_dwordx4 v58, s[60:63], s43 offen lds
  v_cvt_pk_bf16_f32 v48, v16, v17
  v_cvt_pk_bf16_f32 v49, v18, v19
  v_exp_f32 v23, v23
  v_exp_f32 v24, v24
  v_exp_f32 v25, v25
  v_exp_f32 v26, v26
  v_mfma_f32_32x32x16_bf16 v[32:47], v[148:151], a[228:231], v[32:47]
  s_add_u32 m0, s44, 69632
  v_cvt_pk_bf16_f32 v50, v20, v21
  v_cvt_pk_bf16_f32 v51, v22, v23
  v_exp_f32 v27, v27
  v_exp_f32 v28, v28
  v_exp_f32 v29, v29
  v_exp_f32 v30, v30
  v_mfma_f32_32x32x16_bf16 v[112:127], v[152:155], v[48:51], v[112:127]
  s_add_u32 s43, s42, 688256
  v_exp_f32 v31, v31
  v_cvt_pk_bf16_f32 v52, v24, v25
  v_cvt_pk_bf16_f32 v53, v26, v27
  v_cvt_pk_bf16_f32 v54, v28, v29
  v_cvt_pk_bf16_f32 v55, v30, v31
  v_exp_f32 v32, v32
  v_exp_f32 v33, v33
  v_exp_f32 v34, v34
  v_exp_f32 v35, v35
  v_mfma_f32_32x32x16_bf16 v[112:127], v[156:159], v[52:55], v[112:127]
  s_waitcnt vmcnt(16)
  v_exp_f32 v36, v36
  v_exp_f32 v37, v37
  v_exp_f32 v38, v38
  v_mfma_f32_32x32x16_bf16 v[16:31], v[160:163], a[232:235], 0
  buffer_load_dwordx4 v58, s[60:63], s43 offen lds
  v_cvt_pk_bf16_f32 v48, v32, v33
  v_cvt_pk_bf16_f32 v49, v34, v35
  v_exp_f32 v39, v39
  v_exp_f32 v40, v40
  v_exp_f32 v41, v41
  v_exp_f32 v42, v42
  v_mfma_f32_32x32x16_bf16 v[16:31], v[164:167], a[236:239], v[16:31]
  s_add_u32 m0, s44, 98304
  v_cvt_pk_bf16_f32 v50, v36, v37
  v_cvt_pk_bf16_f32 v51, v38, v39
  v_exp_f32 v43, v43
  v_exp_f32 v44, v44
  v_exp_f32 v45, v45
  v_exp_f32 v46, v46
  v_mfma_f32_32x32x16_bf16 v[64:79], v[152:155], v[48:51], v[64:79]
  s_add_u32 s43, s42, 688320
  v_exp_f32 v47, v47
  v_cvt_pk_bf16_f32 v52, v40, v41
  v_cvt_pk_bf16_f32 v53, v42, v43
  v_cvt_pk_bf16_f32 v54, v44, v45
  v_cvt_pk_bf16_f32 v55, v46, v47
  v_exp_f32 v16, v16
  v_exp_f32 v17, v17
  v_exp_f32 v18, v18
  v_exp_f32 v19, v19
  v_mfma_f32_32x32x16_bf16 v[64:79], v[156:159], v[52:55], v[64:79]
  buffer_load_dwordx4 v58, s[60:63], s43 offen lds
  v_exp_f32 v20, v20
  v_exp_f32 v21, v21
  v_exp_f32 v22, v22
  v_mfma_f32_32x32x16_bf16 v[32:47], v[160:163], a[240:243], 0
  s_waitcnt vmcnt(14)
  v_cmp_ne_u64 vcc, s[58:59], v[192:193]
  v_cmp_ne_u64 s[34:35], s[58:59], v[194:195]
  s_nop 0
  s_or_b64 vcc, vcc, s[34:35]
  s_cbranch_scc1 mk_fss
mk_fsr:
  v_cvt_pk_bf16_f32 v48, v16, v17
  v_cvt_pk_bf16_f32 v49, v18, v19
  v_exp_f32 v23, v23
  v_exp_f32 v24, v24
  v_exp_f32 v25, v25
  v_exp_f32 v26, v26
  v_mfma_f32_32x32x16_bf16 v[32:47], v[164:167], a[244:247], v[32:47]
  s_xor_b32 s40, s46, 147456
  v_cvt_pk_bf16_f32 v50, v20, v21
  v_cvt_pk_bf16_f32 v51, v22, v23
  v_exp_f32 v27, v27
  v_exp_f32 v28, v28
  v_exp_f32 v29, v29
  v_exp_f32 v30, v30
  v_mfma_f32_32x32x16_bf16 v[80:95], v[168:171], v[48:51], v[80:95]
  buffer_load_dwordx4 v[144:147], v1, s[4:7], s40 offen sc1
  v_exp_f32 v31, v31
  v_cvt_pk_bf16_f32 v52, v24, v25
  v_cvt_pk_bf16_f32 v53, v26, v27
  v_cvt_pk_bf16_f32 v54, v28, v29
  v_cvt_pk_bf16_f32 v55, v30, v31
  v_exp_f32 v32, v32
  v_exp_f32 v33, v33
  v_exp_f32 v34, v34
  v_exp_f32 v35, v35
  v_mfma_f32_32x32x16_bf16 v[80:95], v[172:175], v[52:55], v[80:95]
  buffer_load_dwordx4 v[148:151], v1, s[4:7], s40 offen offset:1024 sc1
  v_exp_f32 v36, v36
  v_exp_f32 v37, v37
  v_exp_f32 v38, v38
  v_mfma_f32_32x32x16_bf16 v[16:31], v[160:163], a[248:251], 0
  buffer_load_dwordx4 v[152:155], v1, s[4:7], s40 offen offset:2048 sc1
  v_cvt_pk_bf16_f32 v48, v32, v33
  v_cvt_pk_bf16_f32 v49, v34, v35
  v_exp_f32 v39, v39
  v_exp_f32 v40, v40
  v_exp_f32 v41, v41
  v_exp_f32 v42, v42
  v_mfma_f32_32x32x16_bf16 v[16:31], v[164:167], a[252:255], v[16:31]
  buffer_load_dwordx4 v[156:159], v1, s[4:7], s40 offen offset:3072 sc1
  v_cvt_pk_bf16_f32 v50, v36, v37
  v_cvt_pk_bf16_f32 v51, v38, v39
  v_exp_f32 v43, v43
  v_exp_f32 v44, v44
  v_exp_f32 v45, v45
  v_exp_f32 v46, v46
  v_mfma_f32_32x32x16_bf16 v[96:111], v[168:171], v[48:51], v[96:111]
  s_add_u32 m0, s44, 73728
  v_exp_f32 v47, v47
  v_cvt_pk_bf16_f32 v52, v40, v41
  v_cvt_pk_bf16_f32 v53, v42, v43
  v_cvt_pk_bf16_f32 v54, v44, v45
  v_cvt_pk_bf16_f32 v55, v46, v47
  v_exp_f32 v16, v16
  v_exp_f32 v17, v17
  v_exp_f32 v18, v18
  v_exp_f32 v19, v19
  v_mfma_f32_32x32x16_bf16 v[96:111], v[172:175], v[52:55], v[96:111]
  s_add_u32 s43, s42, 917632
  v_exp_f32 v20, v20
  v_exp_f32 v21, v21
  v_exp_f32 v22, v22
  v_mfma_f32_32x32x16_bf16 v[32:47], v[160:163], a[224:227], 0
  buffer_load_dwordx4 v58, s[60:63], s43 offen lds
  v_cvt_pk_bf16_f32 v48, v16, v17
  v_cvt_pk_bf16_f32 v49, v18, v19
  v_exp_f32 v23, v23
  v_exp_f32 v24, v24
  v_exp_f32 v25, v25
  v_exp_f32 v26, v26
  v_mfma_f32_32x32x16_bf16 v[32:47], v[164:167], a[228:231], v[32:47]
  s_add_u32 m0, s44, 102400
  v_cvt_pk_bf16_f32 v50, v20, v21
  v_cvt_pk_bf16_f32 v51, v22, v23
  v_exp_f32 v27, v27
  v_exp_f32 v28, v28
  v_exp_f32 v29, v29
  v_exp_f32 v30, v30
  v_mfma_f32_32x32x16_bf16 v[112:127], v[168:171], v[48:51], v[112:127]
  s_add_u32 s43, s42, 917696
  v_exp_f32 v31, v31
  v_cvt_pk_bf16_f32 v52, v24, v25
  v_cvt_pk_bf16_f32 v53, v26, v27
  v_cvt_pk_bf16_f32 v54, v28, v29
  v_cvt_pk_bf16_f32 v55, v30, v31
  v_exp_f32 v32, v32
  v_exp_f32 v33, v33
  v_exp_f32 v34, v34
  v_exp_f32 v35, v35
  v_mfma_f32_32x32x16_bf16 v[112:127], v[172:175], v[52:55], v[112:127]
  s_waitcnt vmcnt(15)
  v_exp_f32 v36, v36
  v_exp_f32 v37, v37
  v_exp_f32 v38, v38
  v_mfma_f32_32x32x16_bf16 v[16:31], v[176:179], a[232:235], 0
  buffer_load_dwordx4 v58, s[60:63], s43 offen lds
  v_cvt_pk_bf16_f32 v48, v32, v33
  v_cvt_pk_bf16_f32 v49, v34, v35
  v_exp_f32 v39, v39
  v_exp_f32 v40, v40
  v_exp_f32 v41, v41
  v_exp_f32 v42, v42
  v_mfma_f32_32x32x16_bf16 v[16:31], v[180:183], a[236:239], v[16:31]
  s_add_u32 m0, s44, 77824
  v_cvt_pk_bf16_f32 v50, v36, v37
  v_cvt_pk_bf16_f32 v51, v38, v39
  v_exp_f32 v43, v43
  v_exp_f32 v44, v44
  v_exp_f32 v45, v45
  v_exp_f32 v46, v46
  v_mfma_f32_32x32x16_bf16 v[64:79], v[168:171], v[48:51], v[64:79]
  s_add_u32 s43, s42, 1147008
  v_exp_f32 v47, v47
  v_cvt_pk_bf16_f32 v52, v40, v41
  v_cvt_pk_bf16_f32 v53, v42, v43
  v_cvt_pk_bf16_f32 v54, v44, v45
  v_cvt_pk_bf16_f32 v55, v46, v47
  v_exp_f32 v16, v16
  v_exp_f32 v17, v17
  v_exp_f32 v18, v18
  v_exp_f32 v19, v19
  v_mfma_f32_32x32x16_bf16 v[64:79], v[172:175], v[52:55], v[64:79]
  buffer_load_dwordx4 v58, s[60:63], s43 offen lds
  v_exp_f32 v20, v20
  v_exp_f32 v21, v21
  v_exp_f32 v22, v22
  v_mfma_f32_32x32x16_bf16 v[32:47], v[176:179], a[240:243], 0
  s_xor_b32 s40, s46, 163840
  v_cvt_pk_bf16_f32 v48, v16, v17
  v_cvt_pk_bf16_f32 v49, v18, v19
  v_exp_f32 v23, v23
  v_exp_f32 v24, v24
  v_exp_f32 v25, v25
  v_exp_f32 v26, v26
  v_mfma_f32_32x32x16_bf16 v[32:47], v[180:183], a[244:247], v[32:47]
  buffer_load_dwordx4 v[160:163], v1, s[4:7], s40 offen sc1
  v_cvt_pk_bf16_f32 v50, v20, v21
  v_cvt_pk_bf16_f32 v51, v22, v23
  v_exp_f32 v27, v27
  v_exp_f32 v28, v28
  v_exp_f32 v29, v29
  v_exp_f32 v30, v30
  v_mfma_f32_32x32x16_bf16 v[80:95], v[184:187], v[48:51], v[80:95]
  buffer_load_dwordx4 v[164:167], v1, s[4:7], s40 offen offset:1024 sc1
  v_exp_f32 v31, v31
  v_cvt_pk_bf16_f32 v52, v24, v25
  v_cvt_pk_bf16_f32 v53, v26, v27
  v_cvt_pk_bf16_f32 v54, v28, v29
  v_cvt_pk_bf16_f32 v55, v30, v31
  v_exp_f32 v32, v32
  v_exp_f32 v33, v33
  v_exp_f32 v34, v34
  v_exp_f32 v35, v35
  v_mfma_f32_32x32x16_bf16 v[80:95], v[188:191], v[52:55], v[80:95]
  buffer_load_dwordx4 v[168:171], v1, s[4:7], s40 offen offset:2048 sc1
  v_exp_f32 v36, v36
  v_exp_f32 v37, v37
  v_exp_f32 v38, v38
  v_mfma_f32_32x32x16_bf16 v[16:31], v[176:179], a[248:251], 0
  buffer_load_dwordx4 v[172:175], v1, s[4:7], s40 offen offset:3072 sc1
  v_cvt_pk_bf16_f32 v48, v32, v33
  v_cvt_pk_bf16_f32 v49, v34, v35
  v_exp_f32 v39, v39
  v_exp_f32 v40, v40
  v_exp_f32 v41, v41
  v_exp_f32 v42, v42
  v_mfma_f32_32x32x16_bf16 v[16:31], v[180:183], a[252:255], v[16:31]
  s_add_u32 m0, s44, 106496
  v_cvt_pk_bf16_f32 v50, v36, v37
  v_cvt_pk_bf16_f32 v51, v38, v39
  v_exp_f32 v43, v43
  v_exp_f32 v44, v44
  v_exp_f32 v45, v45
  v_exp_f32 v46, v46
  v_mfma_f32_32x32x16_bf16 v[96:111], v[184:187], v[48:51], v[96:111]
  s_add_u32 s43, s42, 1147072
  v_exp_f32 v47, v47
  v_cvt_pk_bf16_f32 v52, v40, v41
  v_cvt_pk_bf16_f32 v53, v42, v43
  v_cvt_pk_bf16_f32 v54, v44, v45
  v_cvt_pk_bf16_f32 v55, v46, v47
  v_exp_f32 v16, v16
  v_exp_f32 v17, v17
  v_exp_f32 v18, v18
  v_exp_f32 v19, v19
  v_mfma_f32_32x32x16_bf16 v[96:111], v[188:191], v[52:55], v[96:111]
  buffer_load_dwordx4 v58, s[60:63], s43 offen lds
  v_exp_f32 v20, v20
  v_exp_f32 v21, v21
  v_exp_f32 v22, v22
  v_mfma_f32_32x32x16_bf16 v[32:47], v[176:179], a[224:227], 0
  s_add_u32 m0, s44, 81920
  v_cvt_pk_bf16_f32 v48, v16, v17
  v_cvt_pk_bf16_f32 v49, v18, v19
  v_exp_f32 v23, v23
  v_exp_f32 v24, v24
  v_exp_f32 v25, v25
  v_exp_f32 v26, v26
  v_mfma_f32_32x32x16_bf16 v[32:47], v[180:183], a[228:231], v[32:47]
  s_add_u32 s43, s42, 1376384
  v_cvt_pk_bf16_f32 v50, v20, v21
  v_cvt_pk_bf16_f32 v51, v22, v23
  v_exp_f32 v27, v27
  v_exp_f32 v28, v28
  v_exp_f32 v29, v29
  v_exp_f32 v30, v30
  v_mfma_f32_32x32x16_bf16 v[112:127], v[184:187], v[48:51], v[112:127]
  buffer_load_dwordx4 v58, s[60:63], s43 offen lds
  v_exp_f32 v31, v31
  v_cvt_pk_bf16_f32 v52, v24, v25
  v_cvt_pk_bf16_f32 v53, v26, v27
  v_cvt_pk_bf16_f32 v54, v28, v29
  v_cvt_pk_bf16_f32 v55, v30, v31
  v_exp_f32 v32, v32
  v_exp_f32 v33, v33
  v_exp_f32 v34, v34
  v_exp_f32 v35, v35
  v_mfma_f32_32x32x16_bf16 v[112:127], v[188:191], v[52:55], v[112:127]
  s_waitcnt vmcnt(16)
  v_exp_f32 v36, v36
  v_exp_f32 v37, v37
  v_exp_f32 v38, v38
  v_mfma_f32_32x32x16_bf16 v[16:31], v[128:131], a[232:235], 0
  s_add_u32 m0, s44, 110592
  v_cvt_pk_bf16_f32 v48, v32, v33
  v_cvt_pk_bf16_f32 v49, v34, v35
  v_exp_f32 v39, v39
  v_exp_f32 v40, v40
  v_exp_f32 v41, v41
  v_exp_f32 v42, v42
  v_mfma_f32_32x32x16_bf16 v[16:31], v[132:135], a[236:239], v[16:31]
  s_add_u32 s43, s42, 1376448
  v_cvt_pk_bf16_f32 v50, v36, v37
  v_cvt_pk_bf16_f32 v51, v38, v39
  v_exp_f32 v43, v43
  v_exp_f32 v44, v44
  v_exp_f32 v45, v45
  v_exp_f32 v46, v46
  v_mfma_f32_32x32x16_bf16 v[64:79], v[184:187], v[48:51], v[64:79]
  buffer_load_dwordx4 v58, s[60:63], s43 offen lds
  v_exp_f32 v47, v47
  v_cvt_pk_bf16_f32 v52, v40, v41
  v_cvt_pk_bf16_f32 v53, v42, v43
  v_cvt_pk_bf16_f32 v54, v44, v45
  v_cvt_pk_bf16_f32 v55, v46, v47
  v_exp_f32 v16, v16
  v_exp_f32 v17, v17
  v_exp_f32 v18, v18
  v_exp_f32 v19, v19
  v_mfma_f32_32x32x16_bf16 v[64:79], v[188:191], v[52:55], v[64:79]
  buffer_load_dwordx4 v[192:195], v1, s[4:7], s32 offen sc1
  v_exp_f32 v20, v20
  v_exp_f32 v21, v21
  v_exp_f32 v22, v22
  v_mfma_f32_32x32x16_bf16 v[32:47], v[128:131], a[240:243], 0
  s_xor_b32 s40, s46, 180224
  v_cvt_pk_bf16_f32 v48, v16, v17
  v_cvt_pk_bf16_f32 v49, v18, v19
  v_exp_f32 v23, v23
  v_exp_f32 v24, v24
  v_exp_f32 v25, v25
  v_exp_f32 v26, v26
  v_mfma_f32_32x32x16_bf16 v[32:47], v[132:135], a[244:247], v[32:47]
  buffer_load_dwordx4 v[176:179], v1, s[4:7], s40 offen sc1
  v_cvt_pk_bf16_f32 v50, v20, v21
  v_cvt_pk_bf16_f32 v51, v22, v23
  v_exp_f32 v27, v27
  v_exp_f32 v28, v28
  v_exp_f32 v29, v29
  v_exp_f32 v30, v30
  v_mfma_f32_32x32x16_bf16 v[80:95], v[136:139], v[48:51], v[80:95]
  buffer_load_dwordx4 v[180:183], v1, s[4:7], s40 offen offset:1024 sc1
  v_exp_f32 v31, v31
  v_cvt_pk_bf16_f32 v52, v24, v25
  v_cvt_pk_bf16_f32 v53, v26, v27
  v_cvt_pk_bf16_f32 v54, v28, v29
  v_cvt_pk_bf16_f32 v55, v30, v31
  v_exp_f32 v32, v32
  v_exp_f32 v33, v33
  v_exp_f32 v34, v34
  v_exp_f32 v35, v35
  v_mfma_f32_32x32x16_bf16 v[80:95], v[140:143], v[52:55], v[80:95]
  buffer_load_dwordx4 v[184:187], v1, s[4:7], s40 offen offset:2048 sc1
  v_exp_f32 v36, v36
  v_exp_f32 v37, v37
  v_exp_f32 v38, v38
  v_mfma_f32_32x32x16_bf16 v[16:31], v[128:131], a[248:251], 0
  buffer_load_dwordx4 v[188:191], v1, s[4:7], s40 offen offset:3072 sc1
  v_cvt_pk_bf16_f32 v48, v32, v33
  v_cvt_pk_bf16_f32 v49, v34, v35
  v_exp_f32 v39, v39
  v_exp_f32 v40, v40
  v_exp_f32 v41, v41
  v_exp_f32 v42, v42
  v_mfma_f32_32x32x16_bf16 v[16:31], v[132:135], a[252:255], v[16:31]
  buffer_load_dwordx4 a[0:3], v1, s[4:7], s49 offen sc1
  v_cvt_pk_bf16_f32 v50, v36, v37
  v_cvt_pk_bf16_f32 v51, v38, v39
  v_exp_f32 v43, v43
  v_exp_f32 v44, v44
  v_exp_f32 v45, v45
  v_exp_f32 v46, v46
  v_mfma_f32_32x32x16_bf16 v[96:111], v[136:139], v[48:51], v[96:111]
  buffer_load_dwordx4 a[4:7], v1, s[4:7], s50 offen sc1
  v_exp_f32 v47, v47
  v_cvt_pk_bf16_f32 v52, v40, v41
  v_cvt_pk_bf16_f32 v53, v42, v43
  v_cvt_pk_bf16_f32 v54, v44, v45
  v_cvt_pk_bf16_f32 v55, v46, v47
  v_exp_f32 v16, v16
  v_exp_f32 v17, v17
  v_exp_f32 v18, v18
  v_exp_f32 v19, v19
  v_mfma_f32_32x32x16_bf16 v[96:111], v[140:143], v[52:55], v[96:111]
  buffer_load_dwordx4 a[8:11], v1, s[4:7], s49 offen offset:1024 sc1
  v_exp_f32 v20, v20
  v_exp_f32 v21, v21
  v_exp_f32 v22, v22
  v_mfma_f32_32x32x16_bf16 v[32:47], v[128:131], a[224:227], 0
  buffer_load_dwordx4 v[196:199], v1, s[4:7], s33 offen sc1
  v_cvt_pk_bf16_f32 v48, v16, v17
  v_cvt_pk_bf16_f32 v49, v18, v19
  v_exp_f32 v23, v23
  v_exp_f32 v24, v24
  v_exp_f32 v25, v25
  v_exp_f32 v26, v26
  v_mfma_f32_32x32x16_bf16 v[32:47], v[132:135], a[228:231], v[32:47]
  buffer_load_dwordx4 a[12:15], v1, s[4:7], s50 offen offset:1024 sc1
  v_cvt_pk_bf16_f32 v50, v20, v21
  v_cvt_pk_bf16_f32 v51, v22, v23
  v_exp_f32 v27, v27
  v_exp_f32 v28, v28
  v_exp_f32 v29, v29
  v_exp_f32 v30, v30
  v_mfma_f32_32x32x16_bf16 v[112:127], v[136:139], v[48:51], v[112:127]
  buffer_load_dwordx4 a[16:19], v1, s[4:7], s49 offen offset:2048 sc1
  v_exp_f32 v31, v31
  v_cvt_pk_bf16_f32 v52, v24, v25
  v_cvt_pk_bf16_f32 v53, v26, v27
  v_cvt_pk_bf16_f32 v54, v28, v29
  v_cvt_pk_bf16_f32 v55, v30, v31
  v_exp_f32 v32, v32
  v_exp_f32 v33, v33
  v_exp_f32 v34, v34
  v_exp_f32 v35, v35
  v_mfma_f32_32x32x16_bf16 v[112:127], v[140:143], v[52:55], v[112:127]
  s_waitcnt vmcnt(21)
  v_exp_f32 v36, v36
  v_exp_f32 v37, v37
  v_exp_f32 v38, v38
  v_mfma_f32_32x32x16_bf16 v[16:31], v[144:147], a[232:235], 0
  buffer_load_dwordx4 v[200:203], v1, s[4:7], s32 offen offset:1024 sc1
  v_cvt_pk_bf16_f32 v48, v32, v33
  v_cvt_pk_bf16_f32 v49, v34, v35
  v_exp_f32 v39, v39
  v_exp_f32 v40, v40
  v_exp_f32 v41, v41
  v_exp_f32 v42, v42
  v_mfma_f32_32x32x16_bf16 v[16:31], v[148:151], a[236:239], v[16:31]
  buffer_load_dwordx4 a[20:23], v1, s[4:7], s50 offen offset:2048 sc1
  v_cvt_pk_bf16_f32 v50, v36, v37
  v_cvt_pk_bf16_f32 v51, v38, v39
  v_exp_f32 v43, v43
  v_exp_f32 v44, v44
  v_exp_f32 v45, v45
  v_exp_f32 v46, v46
  v_mfma_f32_32x32x16_bf16 v[64:79], v[136:139], v[48:51], v[64:79]
  buffer_load_dwordx4 a[24:27], v1, s[4:7], s49 offen offset:3072 sc1
  v_exp_f32 v47, v47
  v_cvt_pk_bf16_f32 v52, v40, v41
  v_cvt_pk_bf16_f32 v53, v42, v43
  v_cvt_pk_bf16_f32 v54, v44, v45
  v_cvt_pk_bf16_f32 v55, v46, v47
  v_exp_f32 v16, v16
  v_exp_f32 v17, v17
  v_exp_f32 v18, v18
  v_exp_f32 v19, v19
  v_mfma_f32_32x32x16_bf16 v[64:79], v[140:143], v[52:55], v[64:79]
  buffer_load_dwordx4 a[28:31], v1, s[4:7], s50 offen offset:3072 sc1
  v_exp_f32 v20, v20
  v_exp_f32 v21, v21
  v_exp_f32 v22, v22
  v_mfma_f32_32x32x16_bf16 v[32:47], v[144:147], a[240:243], 0
  s_xor_b32 s40, s46, 196608
  v_cvt_pk_bf16_f32 v48, v16, v17
  v_cvt_pk_bf16_f32 v49, v18, v19
  v_exp_f32 v23, v23
  v_exp_f32 v24, v24
  v_exp_f32 v25, v25
  v_exp_f32 v26, v26
  v_mfma_f32_32x32x16_bf16 v[32:47], v[148:151], a[244:247], v[32:47]
  buffer_load_dwordx4 v[128:131], v1, s[4:7], s40 offen sc1
  v_cvt_pk_bf16_f32 v50, v20, v21
  v_cvt_pk_bf16_f32 v51, v22, v23
  v_exp_f32 v27, v27
  v_exp_f32 v28, v28
  v_exp_f32 v29, v29
  v_exp_f32 v30, v30
  v_mfma_f32_32x32x16_bf16 v[80:95], v[152:155], v[48:51], v[80:95]
  buffer_load_dwordx4 v[132:135], v1, s[4:7], s40 offen offset:1024 sc1
  v_exp_f32 v31, v31
  v_cvt_pk_bf16_f32 v52, v24, v25
  v_cvt_pk_bf16_f32 v53, v26, v27
  v_cvt_pk_bf16_f32 v54, v28, v29
  v_cvt_pk_bf16_f32 v55, v30, v31
  v_exp_f32 v32, v32
  v_exp_f32 v33, v33
  v_exp_f32 v34, v34
  v_exp_f32 v35, v35
  v_mfma_f32_32x32x16_bf16 v[80:95], v[156:159], v[52:55], v[80:95]
  buffer_load_dwordx4 v[136:139], v1, s[4:7], s40 offen offset:2048 sc1
  v_exp_f32 v36, v36
  v_exp_f32 v37, v37
  v_exp_f32 v38, v38
  v_mfma_f32_32x32x16_bf16 v[16:31], v[144:147], a[248:251], 0
  buffer_load_dwordx4 v[140:143], v1, s[4:7], s40 offen offset:3072 sc1
  v_cvt_pk_bf16_f32 v48, v32, v33
  v_cvt_pk_bf16_f32 v49, v34, v35
  v_exp_f32 v39, v39
  v_exp_f32 v40, v40
  v_exp_f32 v41, v41
  v_exp_f32 v42, v42
  v_mfma_f32_32x32x16_bf16 v[16:31], v[148:151], a[252:255], v[16:31]
  buffer_load_dwordx4 v[204:207], v1, s[4:7], s33 offen offset:1024 sc1
  v_cvt_pk_bf16_f32 v50, v36, v37
  v_cvt_pk_bf16_f32 v51, v38, v39
  v_exp_f32 v43, v43
  v_exp_f32 v44, v44
  v_exp_f32 v45, v45
  v_exp_f32 v46, v46
  v_mfma_f32_32x32x16_bf16 v[96:111], v[152:155], v[48:51], v[96:111]
  s_add_u32 s49, s49, 4096
  v_exp_f32 v47, v47
  v_cvt_pk_bf16_f32 v52, v40, v41
  v_cvt_pk_bf16_f32 v53, v42, v43
  v_cvt_pk_bf16_f32 v54, v44, v45
  v_cvt_pk_bf16_f32 v55, v46, v47
  v_exp_f32 v16, v16
  v_exp_f32 v17, v17
  v_exp_f32 v18, v18
  v_exp_f32 v19, v19
  v_mfma_f32_32x32x16_bf16 v[96:111], v[156:159], v[52:55], v[96:111]
  buffer_load_dwordx4 a[32:35], v1, s[4:7], s49 offen sc1
  v_exp_f32 v20, v20
  v_exp_f32 v21, v21
  v_exp_f32 v22, v22
  v_mfma_f32_32x32x16_bf16 v[32:47], v[144:147], a[224:227], 0
  s_add_u32 s50, s50, 4096
  v_cvt_pk_bf16_f32 v48, v16, v17
  v_cvt_pk_bf16_f32 v49, v18, v19
  v_exp_f32 v23, v23
  v_exp_f32 v24, v24
  v_exp_f32 v25, v25
  v_exp_f32 v26, v26
  v_mfma_f32_32x32x16_bf16 v[32:47], v[148:151], a[228:231], v[32:47]
  buffer_load_dwordx4 a[36:39], v1, s[4:7], s50 offen sc1
  v_cvt_pk_bf16_f32 v50, v20, v21
  v_cvt_pk_bf16_f32 v51, v22, v23
  v_exp_f32 v27, v27
  v_exp_f32 v28, v28
  v_exp_f32 v29, v29
  v_exp_f32 v30, v30
  v_mfma_f32_32x32x16_bf16 v[112:127], v[152:155], v[48:51], v[112:127]
  buffer_load_dwordx4 v[208:211], v1, s[4:7], s32 offen offset:2048 sc1
  v_exp_f32 v31, v31
  v_cvt_pk_bf16_f32 v52, v24, v25
  v_cvt_pk_bf16_f32 v53, v26, v27
  v_cvt_pk_bf16_f32 v54, v28, v29
  v_cvt_pk_bf16_f32 v55, v30, v31
  v_exp_f32 v32, v32
  v_exp_f32 v33, v33
  v_exp_f32 v34, v34
  v_exp_f32 v35, v35
  v_mfma_f32_32x32x16_bf16 v[112:127], v[156:159], v[52:55], v[112:127]
  s_waitcnt vmcnt(26)
  v_exp_f32 v36, v36
  v_exp_f32 v37, v37
  v_exp_f32 v38, v38
  v_mfma_f32_32x32x16_bf16 v[16:31], v[160:163], a[232:235], 0
  buffer_load_dwordx4 a[40:43], v1, s[4:7], s49 offen offset:1024 sc1
  v_cvt_pk_bf16_f32 v48, v32, v33
  v_cvt_pk_bf16_f32 v49, v34, v35
  v_exp_f32 v39, v39
  v_exp_f32 v40, v40
  v_exp_f32 v41, v41
  v_exp_f32 v42, v42
  v_mfma_f32_32x32x16_bf16 v[16:31], v[164:167], a[236:239], v[16:31]
  buffer_load_dwordx4 a[44:47], v1, s[4:7], s50 offen offset:1024 sc1
  v_cvt_pk_bf16_f32 v50, v36, v37
  v_cvt_pk_bf16_f32 v51, v38, v39
  v_exp_f32 v43, v43
  v_exp_f32 v44, v44
  v_exp_f32 v45, v45
  v_exp_f32 v46, v46
  v_mfma_f32_32x32x16_bf16 v[64:79], v[152:155], v[48:51], v[64:79]
  buffer_load_dwordx4 v[212:215], v1, s[4:7], s33 offen offset:2048 sc1
  v_exp_f32 v47, v47
  v_cvt_pk_bf16_f32 v52, v40, v41
  v_cvt_pk_bf16_f32 v53, v42, v43
  v_cvt_pk_bf16_f32 v54, v44, v45
  v_cvt_pk_bf16_f32 v55, v46, v47
  v_exp_f32 v16, v16
  v_exp_f32 v17, v17
  v_exp_f32 v18, v18
  v_exp_f32 v19, v19
  v_mfma_f32_32x32x16_bf16 v[64:79], v[156:159], v[52:55], v[64:79]
  buffer_load_dwordx4 a[48:51], v1, s[4:7], s49 offen offset:2048 sc1
  v_exp_f32 v20, v20
  v_exp_f32 v21, v21
  v_exp_f32 v22, v22
  v_mfma_f32_32x32x16_bf16 v[32:47], v[160:163], a[240:243], 0
  s_xor_b32 s40, s46, 212992
  v_cvt_pk_bf16_f32 v48, v16, v17
  v_cvt_pk_bf16_f32 v49, v18, v19
  v_exp_f32 v23, v23
  v_exp_f32 v24, v24
  v_exp_f32 v25, v25
  v_exp_f32 v26, v26
  v_mfma_f32_32x32x16_bf16 v[32:47], v[164:167], a[244:247], v[32:47]
  buffer_load_dwordx4 v[144:147], v1, s[4:7], s40 offen sc1
  v_cvt_pk_bf16_f32 v50, v20, v21
  v_cvt_pk_bf16_f32 v51, v22, v23
  v_exp_f32 v27, v27
  v_exp_f32 v28, v28
  v_exp_f32 v29, v29
  v_exp_f32 v30, v30
  v_mfma_f32_32x32x16_bf16 v[80:95], v[168:171], v[48:51], v[80:95]
  buffer_load_dwordx4 v[148:151], v1, s[4:7], s40 offen offset:1024 sc1
  v_exp_f32 v31, v31
  v_cvt_pk_bf16_f32 v52, v24, v25
  v_cvt_pk_bf16_f32 v53, v26, v27
  v_cvt_pk_bf16_f32 v54, v28, v29
  v_cvt_pk_bf16_f32 v55, v30, v31
  v_exp_f32 v32, v32
  v_exp_f32 v33, v33
  v_exp_f32 v34, v34
  v_exp_f32 v35, v35
  v_mfma_f32_32x32x16_bf16 v[80:95], v[172:175], v[52:55], v[80:95]
  buffer_load_dwordx4 v[152:155], v1, s[4:7], s40 offen offset:2048 sc1
  v_exp_f32 v36, v36
  v_exp_f32 v37, v37
  v_exp_f32 v38, v38
  v_mfma_f32_32x32x16_bf16 v[16:31], v[160:163], a[248:251], 0
  buffer_load_dwordx4 v[156:159], v1, s[4:7], s40 offen offset:3072 sc1
  v_cvt_pk_bf16_f32 v48, v32, v33
  v_cvt_pk_bf16_f32 v49, v34, v35
  v_exp_f32 v39, v39
  v_exp_f32 v40, v40
  v_exp_f32 v41, v41
  v_exp_f32 v42, v42
  v_mfma_f32_32x32x16_bf16 v[16:31], v[164:167], a[252:255], v[16:31]
  buffer_load_dwordx4 a[52:55], v1, s[4:7], s50 offen offset:2048 sc1
  v_cvt_pk_bf16_f32 v50, v36, v37
  v_cvt_pk_bf16_f32 v51, v38, v39
  v_exp_f32 v43, v43
  v_exp_f32 v44, v44
  v_exp_f32 v45, v45
  v_exp_f32 v46, v46
  v_mfma_f32_32x32x16_bf16 v[96:111], v[168:171], v[48:51], v[96:111]
  buffer_load_dwordx4 a[56:59], v1, s[4:7], s49 offen offset:3072 sc1
  v_exp_f32 v47, v47
  v_cvt_pk_bf16_f32 v52, v40, v41
  v_cvt_pk_bf16_f32 v53, v42, v43
  v_cvt_pk_bf16_f32 v54, v44, v45
  v_cvt_pk_bf16_f32 v55, v46, v47
  v_exp_f32 v16, v16
  v_exp_f32 v17, v17
  v_exp_f32 v18, v18
  v_exp_f32 v19, v19
  v_mfma_f32_32x32x16_bf16 v[96:111], v[172:175], v[52:55], v[96:111]
  buffer_load_dwordx4 v[216:219], v1, s[4:7], s32 offen offset:3072 sc1
  v_exp_f32 v20, v20
  v_exp_f32 v21, v21
  v_exp_f32 v22, v22
  v_mfma_f32_32x32x16_bf16 v[32:47], v[160:163], a[224:227], 0
  buffer_load_dwordx4 a[60:63], v1, s[4:7], s50 offen offset:3072 sc1
  v_cvt_pk_bf16_f32 v48, v16, v17
  v_cvt_pk_bf16_f32 v49, v18, v19
  v_exp_f32 v23, v23
  v_exp_f32 v24, v24
  v_exp_f32 v25, v25
  v_exp_f32 v26, v26
  v_mfma_f32_32x32x16_bf16 v[32:47], v[164:167], a[228:231], v[32:47]
  s_add_u32 s49, s49, 4096
  v_cvt_pk_bf16_f32 v50, v20, v21
  v_cvt_pk_bf16_f32 v51, v22, v23
  v_exp_f32 v27, v27
  v_exp_f32 v28, v28
  v_exp_f32 v29, v29
  v_exp_f32 v30, v30
  v_mfma_f32_32x32x16_bf16 v[112:127], v[168:171], v[48:51], v[112:127]
  buffer_load_dwordx4 a[64:67], v1, s[4:7], s49 offen sc1
  v_exp_f32 v31, v31
  v_cvt_pk_bf16_f32 v52, v24, v25
  v_cvt_pk_bf16_f32 v53, v26, v27
  v_cvt_pk_bf16_f32 v54, v28, v29
  v_cvt_pk_bf16_f32 v55, v30, v31
  v_exp_f32 v32, v32
  v_exp_f32 v33, v33
  v_exp_f32 v34, v34
  v_exp_f32 v35, v35
  v_mfma_f32_32x32x16_bf16 v[112:127], v[172:175], v[52:55], v[112:127]
  s_waitcnt vmcnt(31)
  v_exp_f32 v36, v36
  v_exp_f32 v37, v37
  v_exp_f32 v38, v38
  v_mfma_f32_32x32x16_bf16 v[16:31], v[176:179], a[232:235], 0
  buffer_load_dwordx4 v[220:223], v1, s[4:7], s33 offen offset:3072 sc1
  v_cvt_pk_bf16_f32 v48, v32, v33
  v_cvt_pk_bf16_f32 v49, v34, v35
  v_exp_f32 v39, v39
  v_exp_f32 v40, v40
  v_exp_f32 v41, v41
  v_exp_f32 v42, v42
  v_mfma_f32_32x32x16_bf16 v[16:31], v[180:183], a[236:239], v[16:31]
  s_add_u32 s50, s50, 4096
  v_cvt_pk_bf16_f32 v50, v36, v37
  v_cvt_pk_bf16_f32 v51, v38, v39
  v_exp_f32 v43, v43
  v_exp_f32 v44, v44
  v_exp_f32 v45, v45
  v_exp_f32 v46, v46
  v_mfma_f32_32x32x16_bf16 v[64:79], v[168:171], v[48:51], v[64:79]
  buffer_load_dwordx4 a[68:71], v1, s[4:7], s50 offen sc1
  v_exp_f32 v47, v47
  v_cvt_pk_bf16_f32 v52, v40, v41
  v_cvt_pk_bf16_f32 v53, v42, v43
  v_cvt_pk_bf16_f32 v54, v44, v45
  v_cvt_pk_bf16_f32 v55, v46, v47
  v_exp_f32 v16, v16
  v_exp_f32 v17, v17
  v_exp_f32 v18, v18
  v_exp_f32 v19, v19
  v_mfma_f32_32x32x16_bf16 v[64:79], v[172:175], v[52:55], v[64:79]
  buffer_load_dwordx4 a[72:75], v1, s[4:7], s49 offen offset:1024 sc1
  v_exp_f32 v20, v20
  v_exp_f32 v21, v21
  v_exp_f32 v22, v22
  v_mfma_f32_32x32x16_bf16 v[32:47], v[176:179], a[240:243], 0
  s_xor_b32 s40, s46, 229376
  v_cvt_pk_bf16_f32 v48, v16, v17
  v_cvt_pk_bf16_f32 v49, v18, v19
  v_exp_f32 v23, v23
  v_exp_f32 v24, v24
  v_exp_f32 v25, v25
  v_exp_f32 v26, v26
  v_mfma_f32_32x32x16_bf16 v[32:47], v[180:183], a[244:247], v[32:47]
  buffer_load_dwordx4 v[160:163], v1, s[4:7], s40 offen sc1
  v_cvt_pk_bf16_f32 v50, v20, v21
  v_cvt_pk_bf16_f32 v51, v22, v23
  v_exp_f32 v27, v27
  v_exp_f32 v28, v28
  v_exp_f32 v29, v29
  v_exp_f32 v30, v30
  v_mfma_f32_32x32x16_bf16 v[80:95], v[184:187], v[48:51], v[80:95]
  buffer_load_dwordx4 v[164:167], v1, s[4:7], s40 offen offset:1024 sc1
  v_exp_f32 v31, v31
  v_cvt_pk_bf16_f32 v52, v24, v25
  v_cvt_pk_bf16_f32 v53, v26, v27
  v_cvt_pk_bf16_f32 v54, v28, v29
  v_cvt_pk_bf16_f32 v55, v30, v31
  v_exp_f32 v32, v32
  v_exp_f32 v33, v33
  v_exp_f32 v34, v34
  v_exp_f32 v35, v35
  v_mfma_f32_32x32x16_bf16 v[80:95], v[188:191], v[52:55], v[80:95]
  buffer_load_dwordx4 v[168:171], v1, s[4:7], s40 offen offset:2048 sc1
  v_exp_f32 v36, v36
  v_exp_f32 v37, v37
  v_exp_f32 v38, v38
  v_mfma_f32_32x32x16_bf16 v[16:31], v[176:179], a[248:251], 0
  buffer_load_dwordx4 v[172:175], v1, s[4:7], s40 offen offset:3072 sc1
  v_cvt_pk_bf16_f32 v48, v32, v33
  v_cvt_pk_bf16_f32 v49, v34, v35
  v_exp_f32 v39, v39
  v_exp_f32 v40, v40
  v_exp_f32 v41, v41
  v_exp_f32 v42, v42
  v_mfma_f32_32x32x16_bf16 v[16:31], v[180:183], a[252:255], v[16:31]
  s_add_u32 s32, s32, 4096
  v_cvt_pk_bf16_f32 v50, v36, v37
  v_cvt_pk_bf16_f32 v51, v38, v39
  v_exp_f32 v43, v43
  v_exp_f32 v44, v44
  v_exp_f32 v45, v45
  v_exp_f32 v46, v46
  v_mfma_f32_32x32x16_bf16 v[96:111], v[184:187], v[48:51], v[96:111]
  buffer_load_dwordx4 v[224:227], v1, s[4:7], s32 offen sc1
  v_exp_f32 v47, v47
  v_cvt_pk_bf16_f32 v52, v40, v41
  v_cvt_pk_bf16_f32 v53, v42, v43
  v_cvt_pk_bf16_f32 v54, v44, v45
  v_cvt_pk_bf16_f32 v55, v46, v47
  v_exp_f32 v16, v16
  v_exp_f32 v17, v17
  v_exp_f32 v18, v18
  v_exp_f32 v19, v19
  v_mfma_f32_32x32x16_bf16 v[96:111], v[188:191], v[52:55], v[96:111]
  buffer_load_dwordx4 a[76:79], v1, s[4:7], s50 offen offset:1024 sc1
  v_exp_f32 v20, v20
  v_exp_f32 v21, v21
  v_exp_f32 v22, v22
  v_mfma_f32_32x32x16_bf16 v[32:47], v[176:179], a[224:227], 0
  buffer_load_dwordx4 a[80:83], v1, s[4:7], s49 offen offset:2048 sc1
  v_cvt_pk_bf16_f32 v48, v16, v17
  v_cvt_pk_bf16_f32 v49, v18, v19
  v_exp_f32 v23, v23
  v_exp_f32 v24, v24
  v_exp_f32 v25, v25
  v_exp_f32 v26, v26
  v_mfma_f32_32x32x16_bf16 v[32:47], v[180:183], a[228:231], v[32:47]
  buffer_load_dwordx4 a[84:87], v1, s[4:7], s50 offen offset:2048 sc1
  v_cvt_pk_bf16_f32 v50, v20, v21
  v_cvt_pk_bf16_f32 v51, v22, v23
  v_exp_f32 v27, v27
  v_exp_f32 v28, v28
  v_exp_f32 v29, v29
  v_exp_f32 v30, v30
  v_mfma_f32_32x32x16_bf16 v[112:127], v[184:187], v[48:51], v[112:127]
  s_add_u32 s33, s33, 4096
  v_exp_f32 v31, v31
  v_cvt_pk_bf16_f32 v52, v24, v25
  v_cvt_pk_bf16_f32 v53, v26, v27
  v_cvt_pk_bf16_f32 v54, v28, v29
  v_cvt_pk_bf16_f32 v55, v30, v31
  v_exp_f32 v32, v32
  v_exp_f32 v33, v33
  v_exp_f32 v34, v34
  v_exp_f32 v35, v35
  v_mfma_f32_32x32x16_bf16 v[112:127], v[188:191], v[52:55], v[112:127]
  s_waitcnt vmcnt(28)
  v_exp_f32 v36, v36
  v_exp_f32 v37, v37
  v_exp_f32 v38, v38
  v_mfma_f32_32x32x16_bf16 v[16:31], v[128:131], a[232:235], 0
  buffer_load_dwordx4 v[228:231], v1, s[4:7], s33 offen sc1
  v_cvt_pk_bf16_f32 v48, v32, v33
  v_cvt_pk_bf16_f32 v49, v34, v35
  v_exp_f32 v39, v39
  v_exp_f32 v40, v40
  v_exp_f32 v41, v41
  v_exp_f32 v42, v42
  v_mfma_f32_32x32x16_bf16 v[16:31], v[132:135], a[236:239], v[16:31]
  buffer_load_dwordx4 a[88:91], v1, s[4:7], s49 offen offset:3072 sc1
  v_cvt_pk_bf16_f32 v50, v36, v37
  v_cvt_pk_bf16_f32 v51, v38, v39
  v_exp_f32 v43, v43
  v_exp_f32 v44, v44
  v_exp_f32 v45, v45
  v_exp_f32 v46, v46
  v_mfma_f32_32x32x16_bf16 v[64:79], v[184:187], v[48:51], v[64:79]
  buffer_load_dwordx4 a[92:95], v1, s[4:7], s50 offen offset:3072 sc1
  v_exp_f32 v47, v47
  v_cvt_pk_bf16_f32 v52, v40, v41
  v_cvt_pk_bf16_f32 v53, v42, v43
  v_cvt_pk_bf16_f32 v54, v44, v45
  v_cvt_pk_bf16_f32 v55, v46, v47
  v_exp_f32 v16, v16
  v_exp_f32 v17, v17
  v_exp_f32 v18, v18
  v_exp_f32 v19, v19
  v_mfma_f32_32x32x16_bf16 v[64:79], v[188:191], v[52:55], v[64:79]
  buffer_load_dwordx4 v[232:235], v1, s[4:7], s32 offen offset:1024 sc1
  v_exp_f32 v20, v20
  v_exp_f32 v21, v21
  v_exp_f32 v22, v22
  v_mfma_f32_32x32x16_bf16 v[32:47], v[128:131], a[240:243], 0
  s_xor_b32 s40, s46, 245760
  v_cvt_pk_bf16_f32 v48, v16, v17
  v_cvt_pk_bf16_f32 v49, v18, v19
  v_exp_f32 v23, v23
  v_exp_f32 v24, v24
  v_exp_f32 v25, v25
  v_exp_f32 v26, v26
  v_mfma_f32_32x32x16_bf16 v[32:47], v[132:135], a[244:247], v[32:47]
  buffer_load_dwordx4 v[176:179], v1, s[4:7], s40 offen sc1
  v_cvt_pk_bf16_f32 v50, v20, v21
  v_cvt_pk_bf16_f32 v51, v22, v23
  v_exp_f32 v27, v27
  v_exp_f32 v28, v28
  v_exp_f32 v29, v29
  v_exp_f32 v30, v30
  v_mfma_f32_32x32x16_bf16 v[80:95], v[136:139], v[48:51], v[80:95]
  buffer_load_dwordx4 v[180:183], v1, s[4:7], s40 offen offset:1024 sc1
  v_exp_f32 v31, v31
  v_cvt_pk_bf16_f32 v52, v24, v25
  v_cvt_pk_bf16_f32 v53, v26, v27
  v_cvt_pk_bf16_f32 v54, v28, v29
  v_cvt_pk_bf16_f32 v55, v30, v31
  v_exp_f32 v32, v32
  v_exp_f32 v33, v33
  v_exp_f32 v34, v34
  v_exp_f32 v35, v35
  v_mfma_f32_32x32x16_bf16 v[80:95], v[140:143], v[52:55], v[80:95]
  buffer_load_dwordx4 v[184:187], v1, s[4:7], s40 offen offset:2048 sc1
  v_exp_f32 v36, v36
  v_exp_f32 v37, v37
  v_exp_f32 v38, v38
  v_mfma_f32_32x32x16_bf16 v[16:31], v[128:131], a[248:251], 0
  buffer_load_dwordx4 v[188:191], v1, s[4:7], s40 offen offset:3072 sc1
  v_cvt_pk_bf16_f32 v48, v32, v33
  v_cvt_pk_bf16_f32 v49, v34, v35
  v_exp_f32 v39, v39
  v_exp_f32 v40, v40
  v_exp_f32 v41, v41
  v_exp_f32 v42, v42
  v_mfma_f32_32x32x16_bf16 v[16:31], v[132:135], a[252:255], v[16:31]
  s_add_u32 s49, s49, 4096
  v_cvt_pk_bf16_f32 v50, v36, v37
  v_cvt_pk_bf16_f32 v51, v38, v39
  v_exp_f32 v43, v43
  v_exp_f32 v44, v44
  v_exp_f32 v45, v45
  v_exp_f32 v46, v46
  v_mfma_f32_32x32x16_bf16 v[96:111], v[136:139], v[48:51], v[96:111]
  buffer_load_dwordx4 a[96:99], v1, s[4:7], s49 offen sc1
  v_exp_f32 v47, v47
  v_cvt_pk_bf16_f32 v52, v40, v41
  v_cvt_pk_bf16_f32 v53, v42, v43
  v_cvt_pk_bf16_f32 v54, v44, v45
  v_cvt_pk_bf16_f32 v55, v46, v47
  v_exp_f32 v16, v16
  v_exp_f32 v17, v17
  v_exp_f32 v18, v18
  v_exp_f32 v19, v19
  v_mfma_f32_32x32x16_bf16 v[96:111], v[140:143], v[52:55], v[96:111]
  s_add_u32 s50, s50, 4096
  v_exp_f32 v20, v20
  v_exp_f32 v21, v21
  v_exp_f32 v22, v22
  v_mfma_f32_32x32x16_bf16 v[32:47], v[128:131], a[224:227], 0
  buffer_load_dwordx4 a[100:103], v1, s[4:7], s50 offen sc1
  v_cvt_pk_bf16_f32 v48, v16, v17
  v_cvt_pk_bf16_f32 v49, v18, v19
  v_exp_f32 v23, v23
  v_exp_f32 v24, v24
  v_exp_f32 v25, v25
  v_exp_f32 v26, v26
  v_mfma_f32_32x32x16_bf16 v[32:47], v[132:135], a[228:231], v[32:47]
  buffer_load_dwordx4 a[104:107], v1, s[4:7], s49 offen offset:1024 sc1
  v_cvt_pk_bf16_f32 v50, v20, v21
  v_cvt_pk_bf16_f32 v51, v22, v23
  v_exp_f32 v27, v27
  v_exp_f32 v28, v28
  v_exp_f32 v29, v29
  v_exp_f32 v30, v30
  v_mfma_f32_32x32x16_bf16 v[112:127], v[136:139], v[48:51], v[112:127]
  buffer_load_dwordx4 v[236:239], v1, s[4:7], s33 offen offset:1024 sc1
  v_exp_f32 v31, v31
  v_cvt_pk_bf16_f32 v52, v24, v25
  v_cvt_pk_bf16_f32 v53, v26, v27
  v_cvt_pk_bf16_f32 v54, v28, v29
  v_cvt_pk_bf16_f32 v55, v30, v31
  v_exp_f32 v32, v32
  v_exp_f32 v33, v33
  v_exp_f32 v34, v34
  v_exp_f32 v35, v35
  v_mfma_f32_32x32x16_bf16 v[112:127], v[140:143], v[52:55], v[112:127]
  s_waitcnt vmcnt(28)
  v_exp_f32 v36, v36
  v_exp_f32 v37, v37
  v_exp_f32 v38, v38
  v_mfma_f32_32x32x16_bf16 v[16:31], v[144:147], a[232:235], 0
  buffer_load_dwordx4 a[108:111], v1, s[4:7], s50 offen offset:1024 sc1
  v_cvt_pk_bf16_f32 v48, v32, v33
  v_cvt_pk_bf16_f32 v49, v34, v35
  v_exp_f32 v39, v39
  v_exp_f32 v40, v40
  v_exp_f32 v41, v41
  v_exp_f32 v42, v42
  v_mfma_f32_32x32x16_bf16 v[16:31], v[148:151], a[236:239], v[16:31]
  buffer_load_dwordx4 a[112:115], v1, s[4:7], s49 offen offset:2048 sc1
  v_cvt_pk_bf16_f32 v50, v36, v37
  v_cvt_pk_bf16_f32 v51, v38, v39
  v_exp_f32 v43, v43
  v_exp_f32 v44, v44
  v_exp_f32 v45, v45
  v_exp_f32 v46, v46
  v_mfma_f32_32x32x16_bf16 v[64:79], v[136:139], v[48:51], v[64:79]
  buffer_load_dwordx4 v[240:243], v1, s[4:7], s32 offen offset:2048 sc1
  v_exp_f32 v47, v47
  v_cvt_pk_bf16_f32 v52, v40, v41
  v_cvt_pk_bf16_f32 v53, v42, v43
  v_cvt_pk_bf16_f32 v54, v44, v45
  v_cvt_pk_bf16_f32 v55, v46, v47
  v_exp_f32 v16, v16
  v_exp_f32 v17, v17
  v_exp_f32 v18, v18
  v_exp_f32 v19, v19
  v_mfma_f32_32x32x16_bf16 v[64:79], v[140:143], v[52:55], v[64:79]
  buffer_load_dwordx4 a[116:119], v1, s[4:7], s50 offen offset:2048 sc1
  v_exp_f32 v20, v20
  v_exp_f32 v21, v21
  v_exp_f32 v22, v22
  v_mfma_f32_32x32x16_bf16 v[32:47], v[144:147], a[240:243], 0
  buffer_load_dwordx4 a[120:123], v1, s[4:7], s49 offen offset:3072 sc1
  v_cvt_pk_bf16_f32 v48, v16, v17
  v_cvt_pk_bf16_f32 v49, v18, v19
  v_exp_f32 v23, v23
  v_exp_f32 v24, v24
  v_exp_f32 v25, v25
  v_exp_f32 v26, v26
  v_mfma_f32_32x32x16_bf16 v[32:47], v[148:151], a[244:247], v[32:47]
  buffer_load_dwordx4 v[244:247], v1, s[4:7], s33 offen offset:2048 sc1
  v_cvt_pk_bf16_f32 v50, v20, v21
  v_cvt_pk_bf16_f32 v51, v22, v23
  v_exp_f32 v27, v27
  v_exp_f32 v28, v28
  v_exp_f32 v29, v29
  v_exp_f32 v30, v30
  v_mfma_f32_32x32x16_bf16 v[80:95], v[152:155], v[48:51], v[80:95]
  buffer_load_dwordx4 a[124:127], v1, s[4:7], s50 offen offset:3072 sc1
  v_exp_f32 v31, v31
  v_cvt_pk_bf16_f32 v52, v24, v25
  v_cvt_pk_bf16_f32 v53, v26, v27
  v_cvt_pk_bf16_f32 v54, v28, v29
  v_cvt_pk_bf16_f32 v55, v30, v31
  v_exp_f32 v32, v32
  v_exp_f32 v33, v33
  v_exp_f32 v34, v34
  v_exp_f32 v35, v35
  v_mfma_f32_32x32x16_bf16 v[80:95], v[156:159], v[52:55], v[80:95]
  s_add_u32 s49, s49, 4096
  v_exp_f32 v36, v36
  v_exp_f32 v37, v37
  v_exp_f32 v38, v38
  v_mfma_f32_32x32x16_bf16 v[16:31], v[144:147], a[248:251], 0
  buffer_load_dwordx4 a[128:131], v1, s[4:7], s49 offen sc1
  v_cvt_pk_bf16_f32 v48, v32, v33
  v_cvt_pk_bf16_f32 v49, v34, v35
  v_exp_f32 v39, v39
  v_exp_f32 v40, v40
  v_exp_f32 v41, v41
  v_exp_f32 v42, v42
  v_mfma_f32_32x32x16_bf16 v[16:31], v[148:151], a[252:255], v[16:31]
  s_add_u32 s50, s50, 4096
  v_cvt_pk_bf16_f32 v50, v36, v37
  v_cvt_pk_bf16_f32 v51, v38, v39
  v_exp_f32 v43, v43
  v_exp_f32 v44, v44
  v_exp_f32 v45, v45
  v_exp_f32 v46, v46
  v_mfma_f32_32x32x16_bf16 v[96:111], v[152:155], v[48:51], v[96:111]
  buffer_load_dwordx4 a[132:135], v1, s[4:7], s50 offen sc1
  v_exp_f32 v47, v47
  v_cvt_pk_bf16_f32 v52, v40, v41
  v_cvt_pk_bf16_f32 v53, v42, v43
  v_cvt_pk_bf16_f32 v54, v44, v45
  v_cvt_pk_bf16_f32 v55, v46, v47
  v_exp_f32 v16, v16
  v_exp_f32 v17, v17
  v_exp_f32 v18, v18
  v_exp_f32 v19, v19
  v_mfma_f32_32x32x16_bf16 v[96:111], v[156:159], v[52:55], v[96:111]
  buffer_load_dwordx4 v[248:251], v1, s[4:7], s32 offen offset:3072 sc1
  v_exp_f32 v20, v20
  v_exp_f32 v21, v21
  v_exp_f32 v22, v22
  v_mfma_f32_32x32x16_bf16 v[32:47], v[144:147], a[224:227], 0
  buffer_load_dwordx4 a[136:139], v1, s[4:7], s49 offen offset:1024 sc1
  v_cvt_pk_bf16_f32 v48, v16, v17
  v_cvt_pk_bf16_f32 v49, v18, v19
  v_exp_f32 v23, v23
  v_exp_f32 v24, v24
  v_exp_f32 v25, v25
  v_exp_f32 v26, v26
  v_mfma_f32_32x32x16_bf16 v[32:47], v[148:151], a[228:231], v[32:47]
  buffer_load_dwordx4 a[140:143], v1, s[4:7], s50 offen offset:1024 sc1
  v_cvt_pk_bf16_f32 v50, v20, v21
  v_cvt_pk_bf16_f32 v51, v22, v23
  v_exp_f32 v27, v27
  v_exp_f32 v28, v28
  v_exp_f32 v29, v29
  v_exp_f32 v30, v30
  v_mfma_f32_32x32x16_bf16 v[112:127], v[152:155], v[48:51], v[112:127]
  buffer_load_dwordx4 v[252:255], v1, s[4:7], s33 offen offset:3072 sc1
  v_exp_f32 v31, v31
  v_cvt_pk_bf16_f32 v52, v24, v25
  v_cvt_pk_bf16_f32 v53, v26, v27
  v_cvt_pk_bf16_f32 v54, v28, v29
  v_cvt_pk_bf16_f32 v55, v30, v31
  v_exp_f32 v32, v32
  v_exp_f32 v33, v33
  v_exp_f32 v34, v34
  v_exp_f32 v35, v35
  v_mfma_f32_32x32x16_bf16 v[112:127], v[156:159], v[52:55], v[112:127]
  s_waitcnt vmcnt(29)
  v_exp_f32 v36, v36
  v_exp_f32 v37, v37
  v_exp_f32 v38, v38
  v_mfma_f32_32x32x16_bf16 v[16:31], v[160:163], a[232:235], 0
  buffer_load_dwordx4 a[144:147], v1, s[4:7], s49 offen offset:2048 sc1
  v_cvt_pk_bf16_f32 v48, v32, v33
  v_cvt_pk_bf16_f32 v49, v34, v35
  v_exp_f32 v39, v39
  v_exp_f32 v40, v40
  v_exp_f32 v41, v41
  v_exp_f32 v42, v42
  v_mfma_f32_32x32x16_bf16 v[16:31], v[164:167], a[236:239], v[16:31]
  buffer_load_dwordx4 a[148:151], v1, s[4:7], s50 offen offset:2048 sc1
  v_cvt_pk_bf16_f32 v50, v36, v37
  v_cvt_pk_bf16_f32 v51, v38, v39
  v_exp_f32 v43, v43
  v_exp_f32 v44, v44
  v_exp_f32 v45, v45
  v_exp_f32 v46, v46
  v_mfma_f32_32x32x16_bf16 v[64:79], v[152:155], v[48:51], v[64:79]
  buffer_load_dword v57, v59, s[4:7], s54 offen sc1
  v_exp_f32 v47, v47
  v_cvt_pk_bf16_f32 v52, v40, v41
  v_cvt_pk_bf16_f32 v53, v42, v43
  v_cvt_pk_bf16_f32 v54, v44, v45
  v_cvt_pk_bf16_f32 v55, v46, v47
  v_exp_f32 v16, v16
  v_exp_f32 v17, v17
  v_exp_f32 v18, v18
  v_exp_f32 v19, v19
  v_mfma_f32_32x32x16_bf16 v[64:79], v[156:159], v[52:55], v[64:79]
  s_waitcnt vmcnt(20)
  v_exp_f32 v20, v20
  v_exp_f32 v21, v21
  v_exp_f32 v22, v22
  v_mfma_f32_32x32x16_bf16 v[32:47], v[176:179], a[232:235], 0
  buffer_load_dword v59, v59, s[4:7], s55 offen sc1
  v_cvt_pk_bf16_f32 v48, v16, v17
  v_cvt_pk_bf16_f32 v49, v18, v19
  v_exp_f32 v23, v23
  v_exp_f32 v24, v24
  v_exp_f32 v25, v25
  v_exp_f32 v26, v26
  v_mfma_f32_32x32x16_bf16 v[32:47], v[180:183], a[236:239], v[32:47]
  v_cvt_pk_bf16_f32 v50, v20, v21
  v_cvt_pk_bf16_f32 v51, v22, v23
  v_exp_f32 v27, v27
  v_exp_f32 v28, v28
  v_exp_f32 v29, v29
  v_exp_f32 v30, v30
  v_mfma_f32_32x32x16_bf16 v[80:95], v[168:171], v[48:51], v[80:95]
  v_exp_f32 v31, v31
  v_cvt_pk_bf16_f32 v52, v24, v25
  v_cvt_pk_bf16_f32 v53, v26, v27
  v_cvt_pk_bf16_f32 v54, v28, v29
  v_cvt_pk_bf16_f32 v55, v30, v31
  v_exp_f32 v32, v32
  v_exp_f32 v33, v33
  v_exp_f32 v34, v34
  v_exp_f32 v35, v35
  v_mfma_f32_32x32x16_bf16 v[80:95], v[172:175], v[52:55], v[80:95]
  v_exp_f32 v36, v36
  v_exp_f32 v37, v37
  v_exp_f32 v38, v38
  v_mfma_f32_32x32x16_bf16 v[16:31], v[160:163], a[240:243], 0
  v_cvt_pk_bf16_f32 v48, v32, v33
  v_cvt_pk_bf16_f32 v49, v34, v35
  v_exp_f32 v39, v39
  v_exp_f32 v40, v40
  v_exp_f32 v41, v41
  v_exp_f32 v42, v42
  v_mfma_f32_32x32x16_bf16 v[16:31], v[164:167], a[244:247], v[16:31]
  v_cvt_pk_bf16_f32 v50, v36, v37
  v_cvt_pk_bf16_f32 v51, v38, v39
  v_exp_f32 v43, v43
  v_exp_f32 v44, v44
  v_exp_f32 v45, v45
  v_exp_f32 v46, v46
  v_mfma_f32_32x32x16_bf16 v[80:95], v[184:187], v[48:51], v[80:95]
  v_exp_f32 v47, v47
  v_cvt_pk_bf16_f32 v52, v40, v41
  v_cvt_pk_bf16_f32 v53, v42, v43
  v_cvt_pk_bf16_f32 v54, v44, v45
  v_cvt_pk_bf16_f32 v55, v46, v47
  v_exp_f32 v16, v16
  v_exp_f32 v17, v17
  v_exp_f32 v18, v18
  v_exp_f32 v19, v19
  v_mfma_f32_32x32x16_bf16 v[80:95], v[188:191], v[52:55], v[80:95]
  v_exp_f32 v20, v20
  v_exp_f32 v21, v21
  v_exp_f32 v22, v22
  v_mfma_f32_32x32x16_bf16 v[32:47], v[176:179], a[240:243], 0
  v_cvt_pk_bf16_f32 v48, v16, v17
  v_cvt_pk_bf16_f32 v49, v18, v19
  v_exp_f32 v23, v23
  v_exp_f32 v24, v24
  v_exp_f32 v25, v25
  v_exp_f32 v26, v26
  v_mfma_f32_32x32x16_bf16 v[32:47], v[180:183], a[244:247], v[32:47]
  s_nop 0
  ds_write_b128 v60, v[80:83] offset:0
  v_cvt_pk_bf16_f32 v50, v20, v21
  v_cvt_pk_bf16_f32 v51, v22, v23
  v_exp_f32 v27, v27
  v_exp_f32 v28, v28
  v_exp_f32 v29, v29
  v_exp_f32 v30, v30
  v_mfma_f32_32x32x16_bf16 v[96:111], v[168:171], v[48:51], v[96:111]
  ds_write_b128 v60, v[84:87] offset:1024
  v_exp_f32 v31, v31
  v_cvt_pk_bf16_f32 v52, v24, v25
  v_cvt_pk_bf16_f32 v53, v26, v27
  v_cvt_pk_bf16_f32 v54, v28, v29
  v_cvt_pk_bf16_f32 v55, v30, v31
  v_exp_f32 v32, v32
  v_exp_f32 v33, v33
  v_exp_f32 v34, v34
  v_exp_f32 v35, v35
  v_mfma_f32_32x32x16_bf16 v[96:111], v[172:175], v[52:55], v[96:111]
  ds_write_b128 v60, v[88:91] offset:2048
  v_exp_f32 v36, v36
  v_exp_f32 v37, v37
  v_exp_f32 v38, v38
  v_mfma_f32_32x32x16_bf16 v[16:31], v[160:163], a[248:251], 0
  ds_write_b128 v60, v[92:95] offset:3072
  v_cvt_pk_bf16_f32 v48, v32, v33
  v_cvt_pk_bf16_f32 v49, v34, v35
  v_exp_f32 v39, v39
  v_exp_f32 v40, v40
  v_exp_f32 v41, v41
  v_exp_f32 v42, v42
  v_mfma_f32_32x32x16_bf16 v[16:31], v[164:167], a[252:255], v[16:31]
  v_cvt_pk_bf16_f32 v50, v36, v37
  v_cvt_pk_bf16_f32 v51, v38, v39
  v_exp_f32 v43, v43
  v_exp_f32 v44, v44
  v_exp_f32 v45, v45
  v_exp_f32 v46, v46
  v_mfma_f32_32x32x16_bf16 v[96:111], v[184:187], v[48:51], v[96:111]
  v_exp_f32 v47, v47
  v_cvt_pk_bf16_f32 v52, v40, v41
  v_cvt_pk_bf16_f32 v53, v42, v43
  v_cvt_pk_bf16_f32 v54, v44, v45
  v_cvt_pk_bf16_f32 v55, v46, v47
  v_exp_f32 v16, v16
  v_exp_f32 v17, v17
  v_exp_f32 v18, v18
  v_exp_f32 v19, v19
  v_mfma_f32_32x32x16_bf16 v[96:111], v[188:191], v[52:55], v[96:111]
  v_exp_f32 v20, v20
  v_exp_f32 v21, v21
  v_exp_f32 v22, v22
  v_mfma_f32_32x32x16_bf16 v[32:47], v[176:179], a[248:251], 0
  v_cvt_pk_bf16_f32 v48, v16, v17
  v_cvt_pk_bf16_f32 v49, v18, v19
  v_exp_f32 v23, v23
  v_exp_f32 v24, v24
  v_exp_f32 v25, v25
  v_exp_f32 v26, v26
  v_mfma_f32_32x32x16_bf16 v[32:47], v[180:183], a[252:255], v[32:47]
  s_nop 0
  ds_write_b128 v61, v[96:99] offset:0
  v_cvt_pk_bf16_f32 v50, v20, v21
  v_cvt_pk_bf16_f32 v51, v22, v23
  v_exp_f32 v27, v27
  v_exp_f32 v28, v28
  v_exp_f32 v29, v29
  v_exp_f32 v30, v30
  v_mfma_f32_32x32x16_bf16 v[112:127], v[168:171], v[48:51], v[112:127]
  ds_write_b128 v61, v[100:103] offset:1024
  v_exp_f32 v31, v31
  v_cvt_pk_bf16_f32 v52, v24, v25
  v_cvt_pk_bf16_f32 v53, v26, v27
  v_cvt_pk_bf16_f32 v54, v28, v29
  v_cvt_pk_bf16_f32 v55, v30, v31
  v_exp_f32 v32, v32
  v_exp_f32 v33, v33
  v_exp_f32 v34, v34
  v_exp_f32 v35, v35
  v_mfma_f32_32x32x16_bf16 v[112:127], v[172:175], v[52:55], v[112:127]
  ds_write_b128 v61, v[104:107] offset:2048
  v_exp_f32 v36, v36
  v_exp_f32 v37, v37
  v_exp_f32 v38, v38
  v_mfma_f32_32x32x16_bf16 v[16:31], v[160:163], a[224:227], 0
  ds_write_b128 v61, v[108:111] offset:3072
  v_cvt_pk_bf16_f32 v48, v32, v33
  v_cvt_pk_bf16_f32 v49, v34, v35
  v_exp_f32 v39, v39
  v_exp_f32 v40, v40
  v_exp_f32 v41, v41
  v_exp_f32 v42, v42
  v_mfma_f32_32x32x16_bf16 v[16:31], v[164:167], a[228:231], v[16:31]
  v_cvt_pk_bf16_f32 v50, v36, v37
  v_cvt_pk_bf16_f32 v51, v38, v39
  v_exp_f32 v43, v43
  v_exp_f32 v44, v44
  v_exp_f32 v45, v45
  v_exp_f32 v46, v46
  v_mfma_f32_32x32x16_bf16 v[112:127], v[184:187], v[48:51], v[112:127]
  v_exp_f32 v47, v47
  v_cvt_pk_bf16_f32 v52, v40, v41
  v_cvt_pk_bf16_f32 v53, v42, v43
  v_cvt_pk_bf16_f32 v54, v44, v45
  v_cvt_pk_bf16_f32 v55, v46, v47
  v_exp_f32 v16, v16
  v_exp_f32 v17, v17
  v_exp_f32 v18, v18
  v_exp_f32 v19, v19
  v_mfma_f32_32x32x16_bf16 v[112:127], v[188:191], v[52:55], v[112:127]
  v_exp_f32 v20, v20
  v_exp_f32 v21, v21
  v_exp_f32 v22, v22
  v_mfma_f32_32x32x16_bf16 v[32:47], v[176:179], a[224:227], 0
  v_cvt_pk_bf16_f32 v48, v16, v17
  v_cvt_pk_bf16_f32 v49, v18, v19
  v_exp_f32 v23, v23
  v_exp_f32 v24, v24
  v_exp_f32 v25, v25
  v_exp_f32 v26, v26
  v_mfma_f32_32x32x16_bf16 v[32:47], v[180:183], a[228:231], v[32:47]
  s_nop 0
  ds_write_b128 v62, v[112:115] offset:0
  ds_write_b128 v62, v[116:119] offset:1024
  v_cvt_pk_bf16_f32 v50, v20, v21
  v_cvt_pk_bf16_f32 v51, v22, v23
  v_exp_f32 v27, v27
  v_exp_f32 v28, v28
  v_exp_f32 v29, v29
  v_exp_f32 v30, v30
  v_mfma_f32_32x32x16_bf16 v[64:79], v[168:171], v[48:51], v[64:79]
  ds_write_b128 v62, v[120:123] offset:2048
  ds_write_b128 v62, v[124:127] offset:3072
  v_exp_f32 v31, v31
  v_cvt_pk_bf16_f32 v52, v24, v25
  v_cvt_pk_bf16_f32 v53, v26, v27
  v_cvt_pk_bf16_f32 v54, v28, v29
  v_cvt_pk_bf16_f32 v55, v30, v31
  v_exp_f32 v32, v32
  v_exp_f32 v33, v33
  v_exp_f32 v34, v34
  v_exp_f32 v35, v35
  v_mfma_f32_32x32x16_bf16 v[64:79], v[172:175], v[52:55], v[64:79]
  v_exp_f32 v36, v36
  v_exp_f32 v37, v37
  v_exp_f32 v38, v38
  s_waitcnt lgkmcnt(0)
  s_barrier
  ds_read_b128 v[128:131], v63 offset:0
  ds_read_b128 v[132:135], v63 offset:1024
  ds_read_b128 v[136:139], v63 offset:2048
  ds_read_b128 v[140:143], v63 offset:3072
  ds_read_b128 v[144:147], v63 offset:4096
  ds_read_b128 v[148:151], v63 offset:5120
  ds_read_b128 v[152:155], v63 offset:6144
  ds_read_b128 v[156:159], v63 offset:7168
  ds_read_b128 v[80:83], v63 offset:8192
  ds_read_b128 v[84:87], v63 offset:9216
  ds_read_b128 v[88:91], v63 offset:10240
  ds_read_b128 v[92:95], v63 offset:11264
  v_cvt_pk_bf16_f32 v48, v32, v33
  v_cvt_pk_bf16_f32 v49, v34, v35
  v_exp_f32 v39, v39
  v_exp_f32 v40, v40
  v_exp_f32 v41, v41
  v_exp_f32 v42, v42
  v_cvt_pk_bf16_f32 v50, v36, v37
  v_cvt_pk_bf16_f32 v51, v38, v39
  v_exp_f32 v43, v43
  v_exp_f32 v44, v44
  v_exp_f32 v45, v45
  v_exp_f32 v46, v46
  v_mfma_f32_32x32x16_bf16 v[64:79], v[184:187], v[48:51], v[64:79]
  v_exp_f32 v47, v47
  v_cvt_pk_bf16_f32 v52, v40, v41
  v_cvt_pk_bf16_f32 v53, v42, v43
  v_cvt_pk_bf16_f32 v54, v44, v45
  v_cvt_pk_bf16_f32 v55, v46, v47
  s_nop 1
  v_mfma_f32_32x32x16_bf16 v[64:79], v[188:191], v[52:55], v[64:79]
  v_mov_b32 v20, 0x1f8
  v_mov_b32 v18, 0x21800000
  v_mov_b32 v19, 0x71800000
  s_waitcnt lgkmcnt(0)
  v_pk_add_f32 v[128:129], v[128:129], v[144:145]
  v_pk_add_f32 v[130:131], v[130:131], v[146:147]
  v_pk_add_f32 v[132:133], v[132:133], v[148:149]
  v_pk_add_f32 v[134:135], v[134:135], v[150:151]
  v_pk_add_f32 v[136:137], v[136:137], v[152:153]
  v_pk_add_f32 v[138:139], v[138:139], v[154:155]
  v_pk_add_f32 v[140:141], v[140:141], v[156:157]
  v_pk_add_f32 v[142:143], v[142:143], v[158:159]
  v_pk_add_f32 v[128:129], v[128:129], v[80:81]
  v_pk_add_f32 v[130:131], v[130:131], v[82:83]
  v_pk_add_f32 v[132:133], v[132:133], v[84:85]
  v_pk_add_f32 v[134:135], v[134:135], v[86:87]
  v_pk_add_f32 v[136:137], v[136:137], v[88:89]
  v_pk_add_f32 v[138:139], v[138:139], v[90:91]
  v_pk_add_f32 v[140:141], v[140:141], v[92:93]
  v_pk_add_f32 v[142:143], v[142:143], v[94:95]
  v_pk_add_f32 v[64:65], v[64:65], v[128:129]
  v_pk_add_f32 v[66:67], v[66:67], v[130:131]
  v_pk_add_f32 v[68:69], v[68:69], v[132:133]
  v_pk_add_f32 v[70:71], v[70:71], v[134:135]
  v_pk_add_f32 v[72:73], v[72:73], v[136:137]
  v_pk_add_f32 v[74:75], v[74:75], v[138:139]
  v_pk_add_f32 v[76:77], v[76:77], v[140:141]
  v_pk_add_f32 v[78:79], v[78:79], v[142:143]
  v_mov_b32 v4, v76
  v_mov_b32 v5, v76
  s_nop 1
  v_permlane32_swap_b32 v4, v5
  v_pk_add_f32 v[16:17], v[64:65], v[66:67]
  v_pk_add_f32 v[22:23], v[68:69], v[70:71]
  v_pk_add_f32 v[16:17], v[16:17], v[72:73]
  v_pk_add_f32 v[22:23], v[22:23], v[74:75]
  v_pk_add_f32 v[16:17], v[16:17], v[76:77]
  v_pk_add_f32 v[22:23], v[22:23], v[78:79]
  v_pk_add_f32 v[16:17], v[16:17], v[22:23]
  v_cmp_le_f32 s[32:33], v18, v5
  v_cmp_ge_f32 s[34:35], v19, v5
  v_add_f32 v16, v16, v17
  v_cmp_class_f32 vcc, v16, v20
  s_and_b64 s[32:33], s[32:33], s[34:35]
  s_and_b64 vcc, vcc, s[32:33]
  s_cmp_eq_u64 vcc, -1
  s_cbranch_scc0 mk_fbk8
mk_ok7:
  v_rcp_f32 v5, v5
  s_nop 0
  v_pk_mul_f32 v[64:65], v[64:65], v[4:5] op_sel:[0,1] op_sel_hi:[1,1]
  v_pk_mul_f32 v[66:67], v[66:67], v[4:5] op_sel:[0,1] op_sel_hi:[1,1]
  v_pk_mul_f32 v[68:69], v[68:69], v[4:5] op_sel:[0,1] op_sel_hi:[1,1]
  v_pk_mul_f32 v[70:71], v[70:71], v[4:5] op_sel:[0,1] op_sel_hi:[1,1]
  v_pk_mul_f32 v[72:73], v[72:73], v[4:5] op_sel:[0,1] op_sel_hi:[1,1]
  v_pk_mul_f32 v[74:75], v[74:75], v[4:5] op_sel:[0,1] op_sel_hi:[1,1]
  v_pk_mul_f32 v[76:77], v[76:77], v[4:5] op_sel:[0,1] op_sel_hi:[1,1]
  v_pk_mul_f32 v[78:79], v[78:79], v[4:5] op_sel:[0,1] op_sel_hi:[1,1]
  v_cvt_pk_bf16_f32 v48, v64, v65
  v_cvt_pk_bf16_f32 v49, v66, v67
  v_cvt_pk_bf16_f32 v50, v68, v69
  v_cvt_pk_bf16_f32 v51, v70, v71
  v_cvt_pk_bf16_f32 v52, v72, v73
  v_cvt_pk_bf16_f32 v53, v74, v75
  v_cvt_pk_bf16_f32 v54, v76, v77
  v_cvt_pk_bf16_f32 v55, v78, v79
  s_cmp_eq_u32 s17, 0
  s_cbranch_scc1 mk_sg9
  buffer_store_dwordx4 v[48:51], v1, s[4:7], s38 offen
  buffer_store_dwordx4 v[52:55], v1, s[4:7], s38 offen offset:1024
mk_sd10:
  s_mov_b32 s51, s37
  v_lshlrev_b32 v64, 16, v8
  v_and_b32 v65, 0xffff0000, v8
  v_lshlrev_b32 v66, 16, v9
  v_and_b32 v67, 0xffff0000, v9
  v_lshlrev_b32 v68, 16, v10
  v_and_b32 v69, 0xffff0000, v10
  v_lshlrev_b32 v70, 16, v11
  v_and_b32 v71, 0xffff0000, v11
  v_lshlrev_b32 v72, 16, v12
  v_and_b32 v73, 0xffff0000, v12
  v_lshlrev_b32 v74, 16, v13
  v_and_b32 v75, 0xffff0000, v13
  v_lshlrev_b32 v76, 16, v14
  v_and_b32 v77, 0xffff0000, v14
  v_lshlrev_b32 v78, 16, v15
  v_and_b32 v79, 0xffff0000, v15
  s_mul_i32 s38, s26, 28672
  s_lshl_b32 s35, s28, 11
  s_add_u32 s38, s38, s35
  s_add_u32 s38, s38, s18
  s_lshr_b32 s30, s28, 1
  s_and_b32 s31, s28, 1
  s_lshl_b32 s39, s30, 12
  s_lshl_b32 s35, s26, 9
  s_add_u32 s39, s39, s35
  s_lshl_b32 s35, s31, 3
  s_add_u32 s39, s39, s35
  s_add_u32 s39, s39, s18
  s_add_u32 s39, s39, 1212416
  s_lshl_b32 s37, s26, 7
  s_lshl_b32 s35, s28, 3
  s_add_u32 s37, s37, s35
  s_add_u32 s37, s37, s57
  s_add_u32 s37, s37, 1247232
  s_mul_i32 s40, s26, 114688
  s_lshl_b32 s35, s20, 13
  s_add_u32 s40, s40, s35
  s_add_u32 s40, s40, s18
  s_add_u32 s40, s40, 262144
  s_mul_i32 s41, s27, 114688
  s_lshl_b32 s35, s20, 13
  s_add_u32 s41, s41, s35
  s_add_u32 s41, s41, s18
  s_add_u32 s41, s41, 262144
  s_lshl_b32 s30, s26, 7
  s_lshl_b32 s31, s27, 7
  v_and_b32 v7, 15, v2
  v_lshlrev_b32 v7, 3, v7
  v_add_u32 v4, s30, v7
  v_add_u32 v7, s31, v7
  v_cmp_gt_u32 vcc, 16, v2
  s_nop 1
  v_cndmask_b32 v7, v7, v4, vcc
  s_lshl_b32 s56, s20, 5
  s_add_u32 s56, s56, s57
  s_add_u32 s56, s56, 1246208
  v_mov_b32 v4, s58
  v_mov_b32 v5, s59
  s_mov_b64 exec, 1
  s_waitcnt vmcnt(0)
  s_cmp_eq_u32 s17, 0
  s_cbranch_scc1 mk_sg11
  buffer_store_dwordx2 v[4:5], v1, s[4:7], s51 offen
mk_sd12:
  s_mov_b64 exec, -1
  s_barrier
  s_cmp_ge_u32 s22, 28
  s_cbranch_scc1 mk_idle
  s_mov_b32 exec_lo, 0xf000f
  s_mov_b32 exec_hi, 0x0
  s_mov_b32 s36, 0
mk_pl13:
  buffer_load_dwordx2 v[4:5], v7, s[4:7], s56 offen sc1
  s_add_u32 s36, s36, 1
  s_cmp_ge_u32 s36, 0x40000
  s_cbranch_scc1 mk_end
  s_waitcnt vmcnt(0)
  v_cmp_ne_u64 vcc, s[58:59], v[4:5]
  s_cbranch_vccnz mk_pl13
  s_mov_b64 exec, -1
  buffer_load_dwordx4 v[128:131], v1, s[4:7], s41 offen sc1
  buffer_load_dwordx4 v[132:135], v1, s[4:7], s41 offen offset:1024 sc1
  buffer_load_dwordx4 v[136:139], v1, s[4:7], s41 offen offset:2048 sc1
  buffer_load_dwordx4 v[140:143], v1, s[4:7], s41 offen offset:3072 sc1
  s_add_u32 s41, s41, 4096
  buffer_load_dwordx4 v[144:147], v1, s[4:7], s41 offen sc1
  buffer_load_dwordx4 v[148:151], v1, s[4:7], s41 offen offset:1024 sc1
  buffer_load_dwordx4 v[152:155], v1, s[4:7], s41 offen offset:2048 sc1
  buffer_load_dwordx4 v[156:159], v1, s[4:7], s41 offen offset:3072 sc1
  s_waitcnt vmcnt(7)
  v_mfma_f32_32x32x16_bf16 v[96:111], v[192:195], v[128:131], 0
  buffer_load_dwordx4 v[160:163], v1, s[4:7], s40 offen sc1
  v_mfma_f32_32x32x16_bf16 v[112:127], v[196:199], v[128:131], 0
  s_waitcnt vmcnt(7)
  v_mfma_f32_32x32x16_bf16 v[96:111], v[200:203], v[132:135], v[96:111]
  buffer_load_dwordx4 v[164:167], v1, s[4:7], s40 offen offset:1024 sc1
  v_mfma_f32_32x32x16_bf16 v[112:127], v[204:207], v[132:135], v[112:127]
  s_waitcnt vmcnt(7)
  v_mfma_f32_32x32x16_bf16 v[96:111], v[208:211], v[136:139], v[96:111]
  buffer_load_dwordx4 v[168:171], v1, s[4:7], s40 offen offset:2048 sc1
  v_mfma_f32_32x32x16_bf16 v[112:127], v[212:215], v[136:139], v[112:127]
  s_waitcnt vmcnt(7)
  v_mfma_f32_32x32x16_bf16 v[96:111], v[216:219], v[140:143], v[96:111]
  buffer_load_dwordx4 v[172:175], v1, s[4:7], s40 offen offset:3072 sc1
  v_mfma_f32_32x32x16_bf16 v[112:127], v[220:223], v[140:143], v[112:127]
  s_waitcnt vmcnt(7)
  v_mfma_f32_32x32x16_bf16 v[96:111], v[224:227], v[144:147], v[96:111]
  s_add_u32 s40, s40, 4096
  buffer_load_dwordx4 v[176:179], v1, s[4:7], s40 offen sc1
  v_mfma_f32_32x32x16_bf16 v[112:127], v[228:231], v[144:147], v[112:127]
  s_waitcnt vmcnt(7)
  v_mfma_f32_32x32x16_bf16 v[96:111], v[232:235], v[148:151], v[96:111]
  buffer_load_dwordx4 v[180:183], v1, s[4:7], s40 offen offset:1024 sc1
  v_mfma_f32_32x32x16_bf16 v[112:127], v[236:239], v[148:151], v[112:127]
  s_waitcnt vmcnt(7)
  v_mfma_f32_32x32x16_bf16 v[96:111], v[240:243], v[152:155], v[96:111]
  buffer_load_dwordx4 v[184:187], v1, s[4:7], s40 offen offset:2048 sc1
  v_mfma_f32_32x32x16_bf16 v[112:127], v[244:247], v[152:155], v[112:127]
  s_waitcnt vmcnt(7)
  v_mfma_f32_32x32x16_bf16 v[96:111], v[248:251], v[156:159], v[96:111]
  buffer_load_dwordx4 v[188:191], v1, s[4:7], s40 offen offset:3072 sc1
  v_mfma_f32_32x32x16_bf16 v[112:127], v[252:255], v[156:159], v[112:127]
  s_waitcnt vmcnt(7)
  v_mfma_f32_32x32x16_bf16 v[80:95], v[196:199], v[160:163], 0
  v_lshlrev_b32 v16, 4, v2
  v_mov_b32 v4, 0x7fffff00
  v_cmp_eq_u32 vcc, 1, v3
  s_nop 1
  v_cndmask_b32 v16, v16, v4, vcc
  s_lshl_b32 s31, s24, 11
  s_add_u32 s31, s31, 3751936
  v_mfma_f32_32x32x16_bf16 v[64:79], v[192:195], v[160:163], v[64:79]
  s_waitcnt vmcnt(6)
  v_mfma_f32_32x32x16_bf16 v[80:95], v[204:207], v[164:167], v[80:95]
  buffer_load_dwordx4 v[32:35], v16, s[4:7], s31 offen sc1
  ds_write_b128 v61, v[96:99] offset:0
  v_mfma_f32_32x32x16_bf16 v[64:79], v[200:203], v[164:167], v[64:79]
  ds_write_b128 v61, v[100:103] offset:1024
  s_waitcnt vmcnt(6)
  v_mfma_f32_32x32x16_bf16 v[80:95], v[212:215], v[168:171], v[80:95]
  buffer_load_dwordx4 v[36:39], v16, s[4:7], s31 offen offset:512 sc1
  ds_write_b128 v61, v[104:107] offset:2048
  v_mfma_f32_32x32x16_bf16 v[64:79], v[208:211], v[168:171], v[64:79]
  ds_write_b128 v61, v[108:111] offset:3072
  s_waitcnt vmcnt(6)
  v_mfma_f32_32x32x16_bf16 v[80:95], v[220:223], v[172:175], v[80:95]
  buffer_load_dwordx4 v[40:43], v16, s[4:7], s31 offen offset:1024 sc1
  ds_write_b128 v62, v[112:115] offset:0
  v_mfma_f32_32x32x16_bf16 v[64:79], v[216:219], v[172:175], v[64:79]
  ds_write_b128 v62, v[116:119] offset:1024
  s_waitcnt vmcnt(6)
  v_mfma_f32_32x32x16_bf16 v[80:95], v[228:231], v[176:179], v[80:95]
  buffer_load_dwordx4 v[44:47], v16, s[4:7], s31 offen offset:1536 sc1
  ds_write_b128 v62, v[120:123] offset:2048
  s_waitcnt vmcnt(6)
  v_mfma_f32_32x32x16_bf16 v[80:95], v[236:239], v[180:183], v[80:95]
  ds_write_b128 v62, v[124:127] offset:3072
  s_waitcnt vmcnt(5)
  v_mfma_f32_32x32x16_bf16 v[80:95], v[244:247], v[184:187], v[80:95]
  s_waitcnt vmcnt(4)
  v_mfma_f32_32x32x16_bf16 v[80:95], v[252:255], v[188:191], v[80:95]
  v_mfma_f32_32x32x16_bf16 v[64:79], v[224:227], v[176:179], v[64:79]
  v_mov_b32 v20, 0
  v_mov_b32 v21, 0
  v_mov_b32 v22, 0
  v_mov_b32 v23, 0
  v_mov_b32 v26, 0x3f803f80
  v_lshlrev_b32 v7, 4, v2
  v_mfma_f32_32x32x16_bf16 v[64:79], v[232:235], v[180:183], v[64:79]
  s_nop 3
  ds_write_b128 v60, v[80:83] offset:0
  v_mfma_f32_32x32x16_bf16 v[64:79], v[240:243], v[184:187], v[64:79]
  ds_write_b128 v60, v[84:87] offset:1024
  ds_write_b128 v60, v[88:91] offset:2048
  v_mfma_f32_32x32x16_bf16 v[64:79], v[248:251], v[188:191], v[64:79]
  ds_write_b128 v60, v[92:95] offset:3072
  s_waitcnt lgkmcnt(0)
  s_barrier
  ds_read_b128 v[144:147], v63 offset:4096
  ds_read_b128 v[148:151], v63 offset:5120
  ds_read_b128 v[152:155], v63 offset:6144
  ds_read_b128 v[156:159], v63 offset:7168
  ds_read_b128 v[160:163], v63 offset:8192
  ds_read_b128 v[164:167], v63 offset:9216
  ds_read_b128 v[168:171], v63 offset:10240
  ds_read_b128 v[172:175], v63 offset:11264
  ds_read_b128 v[128:131], v63 offset:0
  ds_read_b128 v[132:135], v63 offset:1024
  ds_read_b128 v[136:139], v63 offset:2048
  ds_read_b128 v[140:143], v63 offset:3072
  s_waitcnt lgkmcnt(8)
  v_pk_add_f32 v[64:65], v[64:65], v[144:145]
  v_pk_add_f32 v[66:67], v[66:67], v[146:147]
  v_pk_add_f32 v[68:69], v[68:69], v[148:149]
  v_pk_add_f32 v[70:71], v[70:71], v[150:151]
  v_pk_add_f32 v[72:73], v[72:73], v[152:153]
  v_pk_add_f32 v[74:75], v[74:75], v[154:155]
  v_pk_add_f32 v[76:77], v[76:77], v[156:157]
  v_pk_add_f32 v[78:79], v[78:79], v[158:159]
  s_waitcnt lgkmcnt(4)
  v_pk_add_f32 v[64:65], v[64:65], v[160:161]
  v_pk_add_f32 v[66:67], v[66:67], v[162:163]
  v_pk_add_f32 v[68:69], v[68:69], v[164:165]
  v_pk_add_f32 v[70:71], v[70:71], v[166:167]
  v_pk_add_f32 v[72:73], v[72:73], v[168:169]
  v_pk_add_f32 v[74:75], v[74:75], v[170:171]
  v_pk_add_f32 v[76:77], v[76:77], v[172:173]
  v_pk_add_f32 v[78:79], v[78:79], v[174:175]
  s_waitcnt lgkmcnt(0)
  v_pk_add_f32 v[64:65], v[64:65], v[128:129]
  v_pk_add_f32 v[66:67], v[66:67], v[130:131]
  v_pk_add_f32 v[68:69], v[68:69], v[132:133]
  v_pk_add_f32 v[70:71], v[70:71], v[134:135]
  v_pk_add_f32 v[72:73], v[72:73], v[136:137]
  v_pk_add_f32 v[74:75], v[74:75], v[138:139]
  v_pk_add_f32 v[76:77], v[76:77], v[140:141]
  v_pk_add_f32 v[78:79], v[78:79], v[142:143]
  v_cvt_pk_bf16_f32 v8, v64, v65
  v_cvt_pk_bf16_f32 v9, v66, v67
  v_cvt_pk_bf16_f32 v10, v68, v69
  v_cvt_pk_bf16_f32 v11, v70, v71
  v_cvt_pk_bf16_f32 v12, v72, v73
  v_cvt_pk_bf16_f32 v13, v74, v75
  v_cvt_pk_bf16_f32 v14, v76, v77
  v_cvt_pk_bf16_f32 v15, v78, v79
  s_cmp_eq_u32 s17, 0
  s_cbranch_scc1 mk_sg15
  buffer_store_dwordx4 v[8:11], v1, s[4:7], s38 offen
  buffer_store_dwordx4 v[12:15], v1, s[4:7], s38 offen offset:1024
mk_sd16:
  v_dot2c_f32_bf16 v20, v8, v26
  v_dot2c_f32_bf16 v21, v8, v8
  v_dot2c_f32_bf16 v22, v9, v26
  v_dot2c_f32_bf16 v23, v9, v9
  v_dot2c_f32_bf16 v20, v10, v26
  v_dot2c_f32_bf16 v21, v10, v10
  v_dot2c_f32_bf16 v22, v11, v26
  v_dot2c_f32_bf16 v23, v11, v11
  v_dot2c_f32_bf16 v20, v12, v26
  v_dot2c_f32_bf16 v21, v12, v12
  v_dot2c_f32_bf16 v22, v13, v26
  v_dot2c_f32_bf16 v23, v13, v13
  v_dot2c_f32_bf16 v20, v14, v26
  v_dot2c_f32_bf16 v21, v14, v14
  v_dot2c_f32_bf16 v22, v15, v26
  v_dot2c_f32_bf16 v23, v15, v15
  s_nop 2
  v_pk_add_f32 v[20:21], v[20:21], v[22:23]
  v_mov_b32 v24, v20
  v_mov_b32 v25, v21
  s_nop 0
  v_permlane32_swap_b32 v20, v24
  v_permlane32_swap_b32 v21, v25
  v_pk_add_f32 v[20:21], v[20:21], v[24:25]
  s_mov_b32 exec_hi, 0
  s_cmp_eq_u32 s17, 0
  s_cbranch_scc1 mk_sg17
  buffer_store_dwordx2 v[20:21], v7, s[4:7], s39 offen
mk_sd18:
  s_mov_b32 exec_hi, -1
  s_mov_b32 s51, s37
  s_mul_i32 s40, s25, 28672
  s_add_u32 s40, s40, s18
  s_lshl_b32 s45, s25, 9
  s_add_u32 s45, s45, s18
  s_add_u32 s45, s45, 1212416
  s_mul_i32 s38, s25, 114688
  s_lshl_b32 s35, s24, 13
  s_add_u32 s38, s38, s35
  s_add_u32 s38, s38, s18
  s_add_u32 s38, s38, 262144
  s_add_u32 s39, s38, 4096
  s_lshl_b32 s37, s25, 7
  s_lshl_b32 s35, s24, 3
  s_add_u32 s37, s37, s35
  s_add_u32 s37, s37, s57
  s_add_u32 s37, s37, 1248256
  v_lshrrev_b32 v7, 1, v1
  s_lshl_b32 s56, s25, 7
  s_add_u32 s56, s56, s57
  s_add_u32 s56, s56, 1247232
  s_waitcnt vmcnt(3)
  v_pk_add_f32 v[32:33], v[32:33], v[34:35]
  v_add_f32 v32, v32, v33
  v_cvt_pk_bf16_f32 v49, v32, v32
  v_and_b32 v49, 0xffff0000, v49
  v_sub_f32 v32, v32, v49
  v_cvt_pk_bf16_f32 v48, v49, v32
  v_mov_b32 v49, v48
  v_mov_b32 v50, 0
  v_mov_b32 v51, 0
  v_pk_add_f32 v[36:37], v[36:37], v[38:39]
  v_add_f32 v36, v36, v37
  v_cvt_pk_bf16_f32 v53, v36, v36
  v_and_b32 v53, 0xffff0000, v53
  v_sub_f32 v36, v36, v53
  v_cvt_pk_bf16_f32 v52, v53, v36
  v_mov_b32 v53, v52
  v_mov_b32 v54, 0
  v_mov_b32 v55, 0
  v_pk_add_f32 v[40:41], v[40:41], v[42:43]
  v_add_f32 v40, v40, v41
  v_cvt_pk_bf16_f32 v57, v40, v40
  v_and_b32 v57, 0xffff0000, v57
  v_sub_f32 v40, v40, v57
  v_cvt_pk_bf16_f32 v56, v57, v40
  v_mov_b32 v57, v56
  v_mov_b32 v58, 0
  v_mov_b32 v59, 0
  v_pk_add_f32 v[44:45], v[44:45], v[46:47]
  v_add_f32 v44, v44, v45
  v_cvt_pk_bf16_f32 v61, v44, v44
  v_and_b32 v61, 0xffff0000, v61
  v_sub_f32 v44, v44, v61
  v_cvt_pk_bf16_f32 v60, v61, v44
  v_mov_b32 v61, v60
  v_mov_b32 v62, 0
  v_mov_b32 v63, 0
  v_mov_b32 v4, s58
  v_mov_b32 v5, s59
  s_mov_b64 exec, 1
  s_waitcnt vmcnt(0)
  s_cmp_eq_u32 s17, 0
  s_cbranch_scc1 mk_sg19
  buffer_store_dwordx2 v[4:5], v1, s[4:7], s51 offen
mk_sd20:
  s_mov_b64 exec, -1
  s_barrier
  ds_read_b64_tr_b16 v[16:17], v6 offset:0
  ds_read_b64_tr_b16 v[18:19], v6 offset:512
  ds_read_b64_tr_b16 v[20:21], v6 offset:28672
  ds_read_b64_tr_b16 v[22:23], v6 offset:29184
  ds_read_b64_tr_b16 v[24:25], v6 offset:57344
  ds_read_b64_tr_b16 v[26:27], v6 offset:57856
  ds_read_b64_tr_b16 v[28:29], v0 offset:20480
  ds_read_b64_tr_b16 v[30:31], v0 offset:20992
  ds_read_b64_tr_b16 v[32:33], v6 offset:1024
  ds_read_b64_tr_b16 v[34:35], v6 offset:1536
  ds_read_b64_tr_b16 v[36:37], v6 offset:29696
  ds_read_b64_tr_b16 v[38:39], v6 offset:30208
  s_mov_b32 exec_lo, 0x3fff
  s_mov_b32 exec_hi, 0x0
  s_mov_b32 s36, 0
mk_pl21:
  buffer_load_dwordx2 v[4:5], v7, s[4:7], s56 offen sc1
  s_add_u32 s36, s36, 1
  s_cmp_ge_u32 s36, 0x40000
  s_cbranch_scc1 mk_end
  s_waitcnt vmcnt(0)
  v_cmp_ne_u64 vcc, s[58:59], v[4:5]
  s_cbranch_vccnz mk_pl21
  s_mov_b64 exec, -1
  buffer_load_dwordx4 v[128:131], v1, s[4:7], s40 offen sc1
  buffer_load_dwordx4 v[132:135], v1, s[4:7], s40 offen offset:1024 sc1
  buffer_load_dwordx4 v[136:139], v1, s[4:7], s40 offen offset:2048 sc1
  buffer_load_dwordx4 v[140:143], v1, s[4:7], s40 offen offset:3072 sc1
  s_add_u32 s40, s40, 4096
  buffer_load_dwordx4 v[144:147], v1, s[4:7], s40 offen sc1
  v_lshlrev_b32 v7, 4, v2
  v_lshlrev_b32 v4, 14, v3
  v_add_u32 v7, v7, v4
  v_mov_b32 v4, 0x7fffff00
  v_cmp_eq_u32 vcc, 1, v3
  s_nop 1
  v_cndmask_b32 v5, v7, v4, vcc
  s_waitcnt vmcnt(4)
  s_waitcnt lgkmcnt(8)
  v_mfma_f32_32x32x16_bf16 v[64:79], v[16:19], v[128:131], 0
  buffer_load_dwordx4 v[148:151], v1, s[4:7], s40 offen offset:1024 sc1
  ds_read_b64_tr_b16 v[40:41], v6 offset:58368
  ds_read_b64_tr_b16 v[42:43], v6 offset:58880
  v_mfma_f32_32x32x16_bf16 v[80:95], v[20:23], v[128:131], 0
  ds_read_b64_tr_b16 v[44:45], v0 offset:21504
  ds_read_b64_tr_b16 v[46:47], v0 offset:22016
  s_waitcnt lgkmcnt(8)
  v_mfma_f32_32x32x16_bf16 v[96:111], v[24:27], v[128:131], 0
  buffer_load_dwordx4 v[240:243], v7, s[4:7], s45 offen sc1
  s_add_u32 s45, s45, 4096
  ds_read_b64_tr_b16 v[16:17], v6 offset:2048
  ds_read_b64_tr_b16 v[18:19], v6 offset:2560
  v_mfma_f32_32x32x16_bf16 v[112:127], v[28:31], v[128:131], 0
  ds_read_b64_tr_b16 v[20:21], v6 offset:30720
  ds_read_b64_tr_b16 v[22:23], v6 offset:31232
  s_waitcnt vmcnt(5)
  s_waitcnt lgkmcnt(8)
  v_mfma_f32_32x32x16_bf16 v[64:79], v[32:35], v[132:135], v[64:79]
  buffer_load_dwordx4 v[152:155], v1, s[4:7], s40 offen offset:2048 sc1
  ds_read_b64_tr_b16 v[24:25], v6 offset:59392
  ds_read_b64_tr_b16 v[26:27], v6 offset:59904
  v_mfma_f32_32x32x16_bf16 v[80:95], v[36:39], v[132:135], v[80:95]
  ds_read_b64_tr_b16 v[28:29], v0 offset:22528
  ds_read_b64_tr_b16 v[30:31], v0 offset:23040
  s_waitcnt lgkmcnt(8)
  v_mfma_f32_32x32x16_bf16 v[96:111], v[40:43], v[132:135], v[96:111]
  buffer_load_dwordx4 v[244:247], v7, s[4:7], s45 offen sc1
  s_add_u32 s45, s45, 4096
  ds_read_b64_tr_b16 v[32:33], v6 offset:3072
  ds_read_b64_tr_b16 v[34:35], v6 offset:3584
  v_mfma_f32_32x32x16_bf16 v[112:127], v[44:47], v[132:135], v[112:127]
  ds_read_b64_tr_b16 v[36:37], v6 offset:31744
  ds_read_b64_tr_b16 v[38:39], v6 offset:32256
  s_waitcnt vmcnt(6)
  s_waitcnt lgkmcnt(8)
  v_mfma_f32_32x32x16_bf16 v[64:79], v[16:19], v[136:139], v[64:79]
  buffer_load_dwordx4 v[156:159], v1, s[4:7], s40 offen offset:3072 sc1
  ds_read_b64_tr_b16 v[40:41], v6 offset:60416
  ds_read_b64_tr_b16 v[42:43], v6 offset:60928
  v_mfma_f32_32x32x16_bf16 v[80:95], v[20:23], v[136:139], v[80:95]
  ds_read_b64_tr_b16 v[44:45], v0 offset:23552
  ds_read_b64_tr_b16 v[46:47], v0 offset:24064
  s_waitcnt lgkmcnt(8)
  v_mfma_f32_32x32x16_bf16 v[96:111], v[24:27], v[136:139], v[96:111]
  buffer_load_dwordx4 v[248:251], v7, s[4:7], s45 offen sc1
  s_add_u32 s45, s45, 4096
  ds_read_b64_tr_b16 v[16:17], v6 offset:4096
  ds_read_b64_tr_b16 v[18:19], v6 offset:4608
  v_mfma_f32_32x32x16_bf16 v[112:127], v[28:31], v[136:139], v[112:127]
  ds_read_b64_tr_b16 v[20:21], v6 offset:32768
  ds_read_b64_tr_b16 v[22:23], v6 offset:33280
  s_waitcnt vmcnt(7)
  s_waitcnt lgkmcnt(8)
  v_mfma_f32_32x32x16_bf16 v[64:79], v[32:35], v[140:143], v[64:79]
  s_add_u32 s40, s40, 4096
  buffer_load_dwordx4 v[160:163], v1, s[4:7], s40 offen sc1
  ds_read_b64_tr_b16 v[24:25], v6 offset:61440
  ds_read_b64_tr_b16 v[26:27], v6 offset:61952
  v_mfma_f32_32x32x16_bf16 v[80:95], v[36:39], v[140:143], v[80:95]
  ds_read_b64_tr_b16 v[28:29], v0 offset:24576
  ds_read_b64_tr_b16 v[30:31], v0 offset:25088
  s_waitcnt lgkmcnt(8)
  v_mfma_f32_32x32x16_bf16 v[96:111], v[40:43], v[140:143], v[96:111]
  buffer_load_dwordx4 v[252:255], v5, s[4:7], s45 offen sc1
  ds_read_b64_tr_b16 v[32:33], v6 offset:5120
  ds_read_b64_tr_b16 v[34:35], v6 offset:5632
  v_mfma_f32_32x32x16_bf16 v[112:127], v[44:47], v[140:143], v[112:127]
  ds_read_b64_tr_b16 v[36:37], v6 offset:33792
  ds_read_b64_tr_b16 v[38:39], v6 offset:34304
  s_waitcnt vmcnt(8)
  s_waitcnt lgkmcnt(8)
  v_mfma_f32_32x32x16_bf16 v[64:79], v[16:19], v[144:147], v[64:79]
  buffer_load_dwordx4 v[164:167], v1, s[4:7], s40 offen offset:1024 sc1
  ds_read_b64_tr_b16 v[40:41], v6 offset:62464
  ds_read_b64_tr_b16 v[42:43], v6 offset:62976
  v_mfma_f32_32x32x16_bf16 v[80:95], v[20:23], v[144:147], v[80:95]
  ds_read_b64_tr_b16 v[44:45], v0 offset:25600
  ds_read_b64_tr_b16 v[46:47], v0 offset:26112
  s_waitcnt lgkmcnt(8)
  v_mfma_f32_32x32x16_bf16 v[96:111], v[24:27], v[144:147], v[96:111]
  buffer_load_dwordx4 v[168:171], v1, s[4:7], s40 offen offset:2048 sc1
  ds_read_b64_tr_b16 v[16:17], v6 offset:6144
  ds_read_b64_tr_b16 v[18:19], v6 offset:6656
  v_mfma_f32_32x32x16_bf16 v[112:127], v[28:31], v[144:147], v[112:127]
  ds_read_b64_tr_b16 v[20:21], v6 offset:34816
  ds_read_b64_tr_b16 v[22:23], v6 offset:35328
  s_waitcnt vmcnt(9)
  s_waitcnt lgkmcnt(8)
  v_mfma_f32_32x32x16_bf16 v[64:79], v[32:35], v[148:151], v[64:79]
  buffer_load_dwordx4 v[172:175], v1, s[4:7], s40 offen offset:3072 sc1
  ds_read_b64_tr_b16 v[24:25], v6 offset:63488
  ds_read_b64_tr_b16 v[26:27], v6 offset:64000
  v_mfma_f32_32x32x16_bf16 v[80:95], v[36:39], v[148:151], v[80:95]
  ds_read_b64_tr_b16 v[28:29], v0 offset:26624
  ds_read_b64_tr_b16 v[30:31], v0 offset:27136
  s_waitcnt lgkmcnt(8)
  v_mfma_f32_32x32x16_bf16 v[96:111], v[40:43], v[148:151], v[96:111]
  s_add_u32 s40, s40, 4096
  buffer_load_dwordx4 v[176:179], v1, s[4:7], s40 offen sc1
  ds_read_b64_tr_b16 v[32:33], v6 offset:7168
  ds_read_b64_tr_b16 v[34:35], v6 offset:7680
  v_mfma_f32_32x32x16_bf16 v[112:127], v[44:47], v[148:151], v[112:127]
  ds_read_b64_tr_b16 v[36:37], v6 offset:35840
  ds_read_b64_tr_b16 v[38:39], v6 offset:36352
  s_waitcnt vmcnt(9)
  s_waitcnt lgkmcnt(8)
  v_mfma_f32_32x32x16_bf16 v[64:79], v[16:19], v[152:155], v[64:79]
  buffer_load_dwordx4 v[180:183], v1, s[4:7], s40 offen offset:1024 sc1
  ds_read_b64_tr_b16 v[40:41], v6 offset:64512
  ds_read_b64_tr_b16 v[42:43], v6 offset:65024
  v_mfma_f32_32x32x16_bf16 v[80:95], v[20:23], v[152:155], v[80:95]
  ds_read_b64_tr_b16 v[44:45], v0 offset:27648
  ds_read_b64_tr_b16 v[46:47], v0 offset:28160
  s_waitcnt lgkmcnt(8)
  v_mfma_f32_32x32x16_bf16 v[96:111], v[24:27], v[152:155], v[96:111]
  buffer_load_dwordx4 v[184:187], v1, s[4:7], s40 offen offset:2048 sc1
  ds_read_b64_tr_b16 v[16:17], v6 offset:8192
  ds_read_b64_tr_b16 v[18:19], v6 offset:8704
  v_mfma_f32_32x32x16_bf16 v[112:127], v[28:31], v[152:155], v[112:127]
  ds_read_b64_tr_b16 v[20:21], v6 offset:36864
  ds_read_b64_tr_b16 v[22:23], v6 offset:37376
  s_waitcnt vmcnt(9)
  s_waitcnt lgkmcnt(8)
  v_mfma_f32_32x32x16_bf16 v[64:79], v[32:35], v[156:159], v[64:79]
  buffer_load_dwordx4 v[188:191], v1, s[4:7], s40 offen offset:3072 sc1
  ds_read_b64_tr_b16 v[24:25], v0 offset:0
  ds_read_b64_tr_b16 v[26:27], v0 offset:512
  v_mfma_f32_32x32x16_bf16 v[80:95], v[36:39], v[156:159], v[80:95]
  ds_read_b64_tr_b16 v[28:29], v0 offset:28672
  ds_read_b64_tr_b16 v[30:31], v0 offset:29184
  s_waitcnt lgkmcnt(8)
  v_mfma_f32_32x32x16_bf16 v[96:111], v[40:43], v[156:159], v[96:111]
  s_add_u32 s40, s40, 4096
  buffer_load_dwordx4 v[192:195], v1, s[4:7], s40 offen sc1
  ds_read_b64_tr_b16 v[32:33], v6 offset:9216
  ds_read_b64_tr_b16 v[34:35], v6 offset:9728
  v_mfma_f32_32x32x16_bf16 v[112:127], v[44:47], v[156:159], v[112:127]
  ds_read_b64_tr_b16 v[36:37], v6 offset:37888
  ds_read_b64_tr_b16 v[38:39], v6 offset:38400
  s_waitcnt vmcnt(9)
  s_waitcnt lgkmcnt(8)
  v_mfma_f32_32x32x16_bf16 v[64:79], v[16:19], v[160:163], v[64:79]
  buffer_load_dwordx4 v[196:199], v1, s[4:7], s40 offen offset:1024 sc1
  ds_read_b64_tr_b16 v[40:41], v0 offset:1024
  ds_read_b64_tr_b16 v[42:43], v0 offset:1536
  s_waitcnt vmcnt(9)
  v_add_f32 v240, v240, v242
  v_add_f32 v241, v241, v243
  v_mfma_f32_32x32x16_bf16 v[80:95], v[20:23], v[160:163], v[80:95]
  ds_read_b64_tr_b16 v[44:45], v0 offset:29696
  ds_read_b64_tr_b16 v[46:47], v0 offset:30208
  v_add_f32 v244, v244, v246
  v_add_f32 v245, v245, v247
  s_waitcnt lgkmcnt(8)
  v_mfma_f32_32x32x16_bf16 v[96:111], v[24:27], v[160:163], v[96:111]
  buffer_load_dwordx4 v[200:203], v1, s[4:7], s40 offen offset:2048 sc1
  ds_read_b64_tr_b16 v[16:17], v6 offset:10240
  ds_read_b64_tr_b16 v[18:19], v6 offset:10752
  v_add_f32 v248, v248, v250
  v_add_f32 v249, v249, v251
  v_mfma_f32_32x32x16_bf16 v[112:127], v[28:31], v[160:163], v[112:127]
  ds_read_b64_tr_b16 v[20:21], v6 offset:38912
  ds_read_b64_tr_b16 v[22:23], v6 offset:39424
  v_add_f32 v252, v252, v254
  v_add_f32 v253, v253, v255
  s_waitcnt vmcnt(9)
  s_waitcnt lgkmcnt(8)
  v_mfma_f32_32x32x16_bf16 v[64:79], v[32:35], v[164:167], v[64:79]
  buffer_load_dwordx4 v[204:207], v1, s[4:7], s40 offen offset:3072 sc1
  ds_read_b64_tr_b16 v[24:25], v0 offset:2048
  ds_read_b64_tr_b16 v[26:27], v0 offset:2560
  v_add_f32 v240, v240, v244
  v_add_f32 v241, v241, v245
  v_mfma_f32_32x32x16_bf16 v[80:95], v[36:39], v[164:167], v[80:95]
  ds_read_b64_tr_b16 v[28:29], v0 offset:30720
  ds_read_b64_tr_b16 v[30:31], v0 offset:31232
  v_add_f32 v248, v248, v252
  v_add_f32 v249, v249, v253
  s_waitcnt lgkmcnt(8)
  v_mfma_f32_32x32x16_bf16 v[96:111], v[40:43], v[164:167], v[96:111]
  s_add_u32 s40, s40, 4096
  buffer_load_dwordx4 v[208:211], v1, s[4:7], s40 offen sc1
  ds_read_b64_tr_b16 v[32:33], v6 offset:11264
  ds_read_b64_tr_b16 v[34:35], v6 offset:11776
  v_add_f32 v240, v240, v248
  v_add_f32 v241, v241, v249
  v_mfma_f32_32x32x16_bf16 v[112:127], v[44:47], v[164:167], v[112:127]
  ds_read_b64_tr_b16 v[36:37], v6 offset:39936
  ds_read_b64_tr_b16 v[38:39], v6 offset:40448
  v_mov_b32 v242, v240
  v_mov_b32 v243, v241
  s_waitcnt vmcnt(10)
  s_waitcnt lgkmcnt(8)
  v_mfma_f32_32x32x16_bf16 v[64:79], v[16:19], v[168:171], v[64:79]
  buffer_load_dwordx4 v[212:215], v1, s[4:7], s40 offen offset:1024 sc1
  ds_read_b64_tr_b16 v[40:41], v0 offset:3072
  ds_read_b64_tr_b16 v[42:43], v0 offset:3584
  v_mov_b32 v246, 0
  v_mov_b32 v247, 0
  v_mfma_f32_32x32x16_bf16 v[80:95], v[20:23], v[168:171], v[80:95]
  ds_read_b64_tr_b16 v[44:45], v0 offset:31744
  ds_read_b64_tr_b16 v[46:47], v0 offset:32256
  v_permlane32_swap_b32 v240, v242
  v_permlane32_swap_b32 v241, v243
  s_waitcnt lgkmcnt(8)
  v_mfma_f32_32x32x16_bf16 v[96:111], v[24:27], v[168:171], v[96:111]
  buffer_load_dwordx4 v[216:219], v1, s[4:7], s40 offen offset:2048 sc1
  ds_read_b64_tr_b16 v[16:17], v6 offset:12288
  ds_read_b64_tr_b16 v[18:19], v6 offset:12800
  v_add_f32 v240, v240, v242
  v_add_f32 v241, v241, v243
  v_mfma_f32_32x32x16_bf16 v[112:127], v[28:31], v[168:171], v[112:127]
  ds_read_b64_tr_b16 v[20:21], v6 offset:40960
  ds_read_b64_tr_b16 v[22:23], v6 offset:41472
  v_mul_f32 v240, 0xbb124925, v240
  v_mul_f32 v241, 0x3b124925, v241
  s_waitcnt vmcnt(11)
  s_waitcnt lgkmcnt(8)
  v_mfma_f32_32x32x16_bf16 v[64:79], v[32:35], v[172:175], v[64:79]
  buffer_load_dwordx4 v[220:223], v1, s[4:7], s40 offen offset:3072 sc1
  ds_read_b64_tr_b16 v[24:25], v0 offset:4096
  ds_read_b64_tr_b16 v[26:27], v0 offset:4608
  v_fma_f32 v241, -v240, v240, v241
  v_max_f32 v241, 0, v241
  v_mfma_f32_32x32x16_bf16 v[80:95], v[36:39], v[172:175], v[80:95]
  ds_read_b64_tr_b16 v[28:29], v0 offset:32768
  ds_read_b64_tr_b16 v[30:31], v0 offset:33280
  v_add_f32 v241, 0x3727c5ac, v241
  v_rsq_f32 v241, v241
  s_waitcnt lgkmcnt(8)
  v_mfma_f32_32x32x16_bf16 v[96:111], v[40:43], v[172:175], v[96:111]
  s_add_u32 s40, s40, 4096
  buffer_load_dwordx4 v[224:227], v1, s[4:7], s40 offen sc1
  ds_read_b64_tr_b16 v[32:33], v6 offset:13312
  ds_read_b64_tr_b16 v[34:35], v6 offset:13824
  v_cvt_pk_bf16_f32 v244, v240, v240
  v_and_b32 v245, 0xffff0000, v244
  v_mfma_f32_32x32x16_bf16 v[112:127], v[44:47], v[172:175], v[112:127]
  ds_read_b64_tr_b16 v[36:37], v6 offset:41984
  ds_read_b64_tr_b16 v[38:39], v6 offset:42496
  v_sub_f32 v245, v240, v245
  v_cvt_pk_bf16_f32 v245, v245, v245
  s_waitcnt vmcnt(12)
  s_waitcnt lgkmcnt(8)
  v_mfma_f32_32x32x16_bf16 v[64:79], v[16:19], v[176:179], v[64:79]
  buffer_load_dwordx4 v[228:231], v1, s[4:7], s40 offen offset:1024 sc1
  ds_read_b64_tr_b16 v[40:41], v0 offset:5120
  ds_read_b64_tr_b16 v[42:43], v0 offset:5632
  s_lshl_b32 s30, s20, 7
  s_add_u32 s30, s30, 114688
  v_mfma_f32_32x32x16_bf16 v[80:95], v[20:23], v[176:179], v[80:95]
  ds_read_b64_tr_b16 v[44:45], v0 offset:33792
  ds_read_b64_tr_b16 v[46:47], v0 offset:34304
  v_lshlrev_b32 v4, 2, v2
  v_add_u32 v4, s30, v4
  s_waitcnt lgkmcnt(8)
  v_mfma_f32_32x32x16_bf16 v[96:111], v[24:27], v[176:179], v[96:111]
  buffer_load_dwordx4 v[232:235], v1, s[4:7], s40 offen offset:2048 sc1
  ds_read_b64_tr_b16 v[16:17], v6 offset:14336
  ds_read_b64_tr_b16 v[18:19], v6 offset:14848
  v_mfma_f32_32x32x16_bf16 v[112:127], v[28:31], v[176:179], v[112:127]
  ds_read_b64_tr_b16 v[20:21], v6 offset:43008
  ds_read_b64_tr_b16 v[22:23], v6 offset:43520
  s_waitcnt vmcnt(13)
  s_waitcnt lgkmcnt(8)
  v_mfma_f32_32x32x16_bf16 v[64:79], v[32:35], v[180:183], v[64:79]
  buffer_load_dwordx4 v[236:239], v1, s[4:7], s40 offen offset:3072 sc1
  ds_read_b64_tr_b16 v[24:25], v0 offset:6144
  ds_read_b64_tr_b16 v[26:27], v0 offset:6656
  v_mfma_f32_32x32x16_bf16 v[80:95], v[36:39], v[180:183], v[80:95]
  ds_read_b64_tr_b16 v[28:29], v0 offset:34816
  ds_read_b64_tr_b16 v[30:31], v0 offset:35328
  s_waitcnt lgkmcnt(8)
  v_mfma_f32_32x32x16_bf16 v[96:111], v[40:43], v[180:183], v[96:111]
  buffer_load_dwordx4 a[152:155], v1, s[4:7], s49 offen offset:3072 sc1
  ds_read_b64_tr_b16 v[32:33], v6 offset:15360
  ds_read_b64_tr_b16 v[34:35], v6 offset:15872
  v_mfma_f32_32x32x16_bf16 v[112:127], v[44:47], v[180:183], v[112:127]
  ds_read_b64_tr_b16 v[36:37], v6 offset:44032
  ds_read_b64_tr_b16 v[38:39], v6 offset:44544
  s_waitcnt vmcnt(14)
  s_waitcnt lgkmcnt(8)
  v_mfma_f32_32x32x16_bf16 v[64:79], v[16:19], v[184:187], v[64:79]
  buffer_load_dwordx4 a[156:159], v1, s[4:7], s50 offen offset:3072 sc1
  ds_read_b64_tr_b16 v[40:41], v0 offset:7168
  ds_read_b64_tr_b16 v[42:43], v0 offset:7680
  v_mfma_f32_32x32x16_bf16 v[64:79], v[48:51], v[244:247], v[64:79]
  v_mfma_f32_32x32x16_bf16 v[80:95], v[20:23], v[184:187], v[80:95]
  ds_read_b64_tr_b16 v[44:45], v0 offset:35840
  ds_read_b64_tr_b16 v[46:47], v0 offset:36352
  v_mfma_f32_32x32x16_bf16 v[80:95], v[52:55], v[244:247], v[80:95]
  s_waitcnt lgkmcnt(8)
  v_mfma_f32_32x32x16_bf16 v[96:111], v[24:27], v[184:187], v[96:111]
  s_add_u32 s49, s49, 4096
  buffer_load_dwordx4 a[160:163], v1, s[4:7], s49 offen sc1
  ds_read_b64_tr_b16 v[16:17], v6 offset:16384
  ds_read_b64_tr_b16 v[18:19], v6 offset:16896
  v_mfma_f32_32x32x16_bf16 v[96:111], v[56:59], v[244:247], v[96:111]
  v_mfma_f32_32x32x16_bf16 v[112:127], v[28:31], v[184:187], v[112:127]
  ds_read_b64_tr_b16 v[20:21], v6 offset:45056
  ds_read_b64_tr_b16 v[22:23], v6 offset:45568
  v_mfma_f32_32x32x16_bf16 v[112:127], v[60:63], v[244:247], v[112:127]
  ds_write_b32 v4, v241 offset:0
  s_waitcnt vmcnt(15)
  s_waitcnt lgkmcnt(9)
  v_mfma_f32_32x32x16_bf16 v[64:79], v[32:35], v[188:191], v[64:79]
  s_add_u32 s50, s50, 4096
  buffer_load_dwordx4 a[164:167], v1, s[4:7], s50 offen sc1
  ds_read_b64_tr_b16 v[24:25], v0 offset:8192
  ds_read_b64_tr_b16 v[26:27], v0 offset:8704
  v_mfma_f32_32x32x16_bf16 v[80:95], v[36:39], v[188:191], v[80:95]
  ds_read_b64_tr_b16 v[28:29], v0 offset:36864
  ds_read_b64_tr_b16 v[30:31], v0 offset:37376
  s_waitcnt lgkmcnt(9)
  v_mfma_f32_32x32x16_bf16 v[96:111], v[40:43], v[188:191], v[96:111]
  buffer_load_dwordx4 a[168:171], v1, s[4:7], s49 offen offset:1024 sc1
  ds_read_b64_tr_b16 v[32:33], v6 offset:17408
  ds_read_b64_tr_b16 v[34:35], v6 offset:17920
  v_mfma_f32_32x32x16_bf16 v[112:127], v[44:47], v[188:191], v[112:127]
  ds_read_b64_tr_b16 v[36:37], v6 offset:46080
  ds_read_b64_tr_b16 v[38:39], v6 offset:46592
  s_waitcnt vmcnt(16)
  s_waitcnt lgkmcnt(9)
  v_mfma_f32_32x32x16_bf16 v[64:79], v[16:19], v[192:195], v[64:79]
  buffer_load_dwordx4 a[172:175], v1, s[4:7], s50 offen offset:1024 sc1
  ds_read_b64_tr_b16 v[40:41], v0 offset:9216
  ds_read_b64_tr_b16 v[42:43], v0 offset:9728
  v_mfma_f32_32x32x16_bf16 v[80:95], v[20:23], v[192:195], v[80:95]
  ds_read_b64_tr_b16 v[44:45], v0 offset:37888
  ds_read_b64_tr_b16 v[46:47], v0 offset:38400
  s_waitcnt lgkmcnt(8)
  v_mfma_f32_32x32x16_bf16 v[96:111], v[24:27], v[192:195], v[96:111]
  buffer_load_dwordx4 a[176:179], v1, s[4:7], s49 offen offset:2048 sc1
  ds_read_b64_tr_b16 v[16:17], v6 offset:18432
  ds_read_b64_tr_b16 v[18:19], v6 offset:18944
  v_mfma_f32_32x32x16_bf16 v[112:127], v[28:31], v[192:195], v[112:127]
  ds_read_b64_tr_b16 v[20:21], v6 offset:47104
  ds_read_b64_tr_b16 v[22:23], v6 offset:47616
  s_waitcnt vmcnt(17)
  s_waitcnt lgkmcnt(8)
  v_mfma_f32_32x32x16_bf16 v[64:79], v[32:35], v[196:199], v[64:79]
  buffer_load_dwordx4 a[180:183], v1, s[4:7], s50 offen offset:2048 sc1
  ds_read_b64_tr_b16 v[24:25], v0 offset:10240
  ds_read_b64_tr_b16 v[26:27], v0 offset:10752
  v_mfma_f32_32x32x16_bf16 v[80:95], v[36:39], v[196:199], v[80:95]
  ds_read_b64_tr_b16 v[28:29], v0 offset:38912
  ds_read_b64_tr_b16 v[30:31], v0 offset:39424
  s_waitcnt lgkmcnt(8)
  v_mfma_f32_32x32x16_bf16 v[96:111], v[40:43], v[196:199], v[96:111]
  buffer_load_dwordx4 a[184:187], v1, s[4:7], s49 offen offset:3072 sc1
  ds_read_b64_tr_b16 v[32:33], v6 offset:19456
  ds_read_b64_tr_b16 v[34:35], v6 offset:19968
  v_mfma_f32_32x32x16_bf16 v[112:127], v[44:47], v[196:199], v[112:127]
  ds_read_b64_tr_b16 v[36:37], v6 offset:48128
  ds_read_b64_tr_b16 v[38:39], v6 offset:48640
  s_waitcnt vmcnt(18)
  s_waitcnt lgkmcnt(8)
  v_mfma_f32_32x32x16_bf16 v[64:79], v[16:19], v[200:203], v[64:79]
  buffer_load_dwordx4 a[188:191], v1, s[4:7], s50 offen offset:3072 sc1
  ds_read_b64_tr_b16 v[40:41], v0 offset:11264
  ds_read_b64_tr_b16 v[42:43], v0 offset:11776
  v_mfma_f32_32x32x16_bf16 v[80:95], v[20:23], v[200:203], v[80:95]
  ds_read_b64_tr_b16 v[44:45], v0 offset:39936
  ds_read_b64_tr_b16 v[46:47], v0 offset:40448
  s_waitcnt lgkmcnt(8)
  v_mfma_f32_32x32x16_bf16 v[96:111], v[24:27], v[200:203], v[96:111]
  s_add_u32 s49, s49, 4096
  buffer_load_dwordx4 a[192:195], v1, s[4:7], s49 offen sc1
  ds_read_b64_tr_b16 v[16:17], v6 offset:20480
  ds_read_b64_tr_b16 v[18:19], v6 offset:20992
  v_mfma_f32_32x32x16_bf16 v[112:127], v[28:31], v[200:203], v[112:127]
  ds_read_b64_tr_b16 v[20:21], v6 offset:49152
  ds_read_b64_tr_b16 v[22:23], v6 offset:49664
  s_waitcnt vmcnt(19)
  s_waitcnt lgkmcnt(8)
  v_mfma_f32_32x32x16_bf16 v[64:79], v[32:35], v[204:207], v[64:79]
  s_add_u32 s50, s50, 4096
  buffer_load_dwordx4 a[196:199], v1, s[4:7], s50 offen sc1
  ds_read_b64_tr_b16 v[24:25], v0 offset:12288
  ds_read_b64_tr_b16 v[26:27], v0 offset:12800
  v_mfma_f32_32x32x16_bf16 v[80:95], v[36:39], v[204:207], v[80:95]
  ds_read_b64_tr_b16 v[28:29], v0 offset:40960
  ds_read_b64_tr_b16 v[30:31], v0 offset:41472
  s_waitcnt lgkmcnt(8)
  v_mfma_f32_32x32x16_bf16 v[96:111], v[40:43], v[204:207], v[96:111]
  buffer_load_dwordx4 a[200:203], v1, s[4:7], s49 offen offset:1024 sc1
  ds_read_b64_tr_b16 v[32:33], v6 offset:21504
  ds_read_b64_tr_b16 v[34:35], v6 offset:22016
  v_mfma_f32_32x32x16_bf16 v[112:127], v[44:47], v[204:207], v[112:127]
  ds_read_b64_tr_b16 v[36:37], v6 offset:50176
  ds_read_b64_tr_b16 v[38:39], v6 offset:50688
  s_waitcnt vmcnt(20)
  s_waitcnt lgkmcnt(8)
  v_mfma_f32_32x32x16_bf16 v[64:79], v[16:19], v[208:211], v[64:79]
  buffer_load_dwordx4 a[204:207], v1, s[4:7], s50 offen offset:1024 sc1
  ds_read_b64_tr_b16 v[40:41], v0 offset:13312
  ds_read_b64_tr_b16 v[42:43], v0 offset:13824
  v_mfma_f32_32x32x16_bf16 v[80:95], v[20:23], v[208:211], v[80:95]
  ds_read_b64_tr_b16 v[44:45], v0 offset:41984
  ds_read_b64_tr_b16 v[46:47], v0 offset:42496
  s_waitcnt lgkmcnt(8)
  v_mfma_f32_32x32x16_bf16 v[96:111], v[24:27], v[208:211], v[96:111]
  buffer_load_dwordx4 a[208:211], v1, s[4:7], s49 offen offset:2048 sc1
  ds_read_b64_tr_b16 v[16:17], v6 offset:22528
  ds_read_b64_tr_b16 v[18:19], v6 offset:23040
  v_mfma_f32_32x32x16_bf16 v[112:127], v[28:31], v[208:211], v[112:127]
  ds_read_b64_tr_b16 v[20:21], v6 offset:51200
  ds_read_b64_tr_b16 v[22:23], v6 offset:51712
  s_waitcnt vmcnt(21)
  s_waitcnt lgkmcnt(8)
  v_mfma_f32_32x32x16_bf16 v[64:79], v[32:35], v[212:215], v[64:79]
  buffer_load_dwordx4 a[212:215], v1, s[4:7], s50 offen offset:2048 sc1
  ds_read_b64_tr_b16 v[24:25], v0 offset:14336
  ds_read_b64_tr_b16 v[26:27], v0 offset:14848
  v_mfma_f32_32x32x16_bf16 v[80:95], v[36:39], v[212:215], v[80:95]
  ds_read_b64_tr_b16 v[28:29], v0 offset:43008
  ds_read_b64_tr_b16 v[30:31], v0 offset:43520
  s_waitcnt lgkmcnt(8)
  v_mfma_f32_32x32x16_bf16 v[96:111], v[40:43], v[212:215], v[96:111]
  buffer_load_dwordx4 a[216:219], v1, s[4:7], s49 offen offset:3072 sc1
  ds_read_b64_tr_b16 v[32:33], v6 offset:23552
  ds_read_b64_tr_b16 v[34:35], v6 offset:24064
  v_mfma_f32_32x32x16_bf16 v[112:127], v[44:47], v[212:215], v[112:127]
  ds_read_b64_tr_b16 v[36:37], v6 offset:24576
  ds_read_b64_tr_b16 v[38:39], v6 offset:25088
  s_waitcnt vmcnt(22)
  s_waitcnt lgkmcnt(8)
  v_mfma_f32_32x32x16_bf16 v[64:79], v[16:19], v[216:219], v[64:79]
  buffer_load_dwordx4 a[220:223], v1, s[4:7], s50 offen offset:3072 sc1
  ds_read_b64_tr_b16 v[40:41], v6 offset:25600
  ds_read_b64_tr_b16 v[42:43], v6 offset:26112
  v_mfma_f32_32x32x16_bf16 v[80:95], v[20:23], v[216:219], v[80:95]
  ds_read_b64_tr_b16 v[44:45], v6 offset:26624
  ds_read_b64_tr_b16 v[46:47], v6 offset:27136
  s_waitcnt lgkmcnt(8)
  v_mfma_f32_32x32x16_bf16 v[96:111], v[24:27], v[216:219], v[96:111]
  ds_read_b64_tr_b16 v[16:17], v6 offset:27648
  ds_read_b64_tr_b16 v[18:19], v6 offset:28160
  v_mfma_f32_32x32x16_bf16 v[112:127], v[28:31], v[216:219], v[112:127]
  ds_read_b64_tr_b16 v[20:21], v6 offset:52224
  ds_read_b64_tr_b16 v[22:23], v6 offset:52736
  s_waitcnt vmcnt(22)
  s_waitcnt lgkmcnt(8)
  v_mfma_f32_32x32x16_bf16 v[64:79], v[32:35], v[220:223], v[64:79]
  ds_read_b64_tr_b16 v[24:25], v6 offset:53248
  ds_read_b64_tr_b16 v[26:27], v6 offset:53760
  s_waitcnt vmcnt(21)
  v_mfma_f32_32x32x16_bf16 v[64:79], v[36:39], v[224:227], v[64:79]
  ds_read_b64_tr_b16 v[28:29], v6 offset:54272
  ds_read_b64_tr_b16 v[30:31], v6 offset:54784
  s_waitcnt vmcnt(20)
  s_waitcnt lgkmcnt(8)
  v_mfma_f32_32x32x16_bf16 v[64:79], v[40:43], v[228:231], v[64:79]
  ds_read_b64_tr_b16 v[32:33], v6 offset:55296
  ds_read_b64_tr_b16 v[34:35], v6 offset:55808
  s_waitcnt vmcnt(19)
  v_mfma_f32_32x32x16_bf16 v[64:79], v[44:47], v[232:235], v[64:79]
  ds_read_b64_tr_b16 v[36:37], v6 offset:56320
  ds_read_b64_tr_b16 v[38:39], v6 offset:56832
  s_waitcnt vmcnt(18)
  s_waitcnt lgkmcnt(8)
  v_mfma_f32_32x32x16_bf16 v[64:79], v[16:19], v[236:239], v[64:79]
  ds_read_b64_tr_b16 v[40:41], v0 offset:15360
  ds_read_b64_tr_b16 v[42:43], v0 offset:15872
  v_mfma_f32_32x32x16_bf16 v[80:95], v[20:23], v[220:223], v[80:95]
  ds_read_b64_tr_b16 v[44:45], v0 offset:16384
  ds_read_b64_tr_b16 v[46:47], v0 offset:16896
  s_waitcnt lgkmcnt(8)
  v_mfma_f32_32x32x16_bf16 v[80:95], v[24:27], v[224:227], v[80:95]
  ds_read_b64_tr_b16 v[16:17], v0 offset:17408
  ds_read_b64_tr_b16 v[18:19], v0 offset:17920
  s_nop 2
  v_cvt_pk_bf16_f32 v64, v64, v65
  v_cvt_pk_bf16_f32 v65, v66, v67
  v_cvt_pk_bf16_f32 v66, v68, v69
  v_cvt_pk_bf16_f32 v67, v70, v71
  v_mfma_f32_32x32x16_bf16 v[80:95], v[28:31], v[228:231], v[80:95]
  ds_read_b64_tr_b16 v[20:21], v0 offset:18432
  ds_read_b64_tr_b16 v[22:23], v0 offset:18944
  v_cvt_pk_bf16_f32 v68, v72, v73
  v_cvt_pk_bf16_f32 v69, v74, v75
  v_cvt_pk_bf16_f32 v70, v76, v77
  v_cvt_pk_bf16_f32 v71, v78, v79
  s_waitcnt lgkmcnt(8)
  v_mfma_f32_32x32x16_bf16 v[80:95], v[32:35], v[232:235], v[80:95]
  ds_read_b64_tr_b16 v[24:25], v0 offset:19456
  ds_read_b64_tr_b16 v[26:27], v0 offset:19968
  v_pk_max_i16 v64, v64, 0
  v_pk_max_i16 v65, v65, 0
  v_pk_max_i16 v66, v66, 0
  v_pk_max_i16 v67, v67, 0
  v_mfma_f32_32x32x16_bf16 v[80:95], v[36:39], v[236:239], v[80:95]
  ds_read_b64_tr_b16 v[28:29], v0 offset:44032
  ds_read_b64_tr_b16 v[30:31], v0 offset:44544
  v_pk_max_i16 v68, v68, 0
  v_pk_max_i16 v69, v69, 0
  v_pk_max_i16 v70, v70, 0
  v_pk_max_i16 v71, v71, 0
  s_waitcnt lgkmcnt(8)
  v_mfma_f32_32x32x16_bf16 v[96:111], v[40:43], v[220:223], v[96:111]
  ds_read_b64_tr_b16 v[32:33], v0 offset:45056
  ds_read_b64_tr_b16 v[34:35], v0 offset:45568
  s_cmp_eq_u32 s17, 0
  s_cbranch_scc1 mk_sg23
  buffer_store_dwordx4 v[64:67], v1, s[4:7], s38 offen
  buffer_store_dwordx4 v[68:71], v1, s[4:7], s38 offen offset:1024
mk_sd24:
  v_mfma_f32_32x32x16_bf16 v[96:111], v[44:47], v[224:227], v[96:111]
  ds_read_b64_tr_b16 v[36:37], v0 offset:46080
  ds_read_b64_tr_b16 v[38:39], v0 offset:46592
  v_cvt_pk_bf16_f32 v80, v80, v81
  v_cvt_pk_bf16_f32 v81, v82, v83
  v_cvt_pk_bf16_f32 v82, v84, v85
  v_cvt_pk_bf16_f32 v83, v86, v87
  s_waitcnt lgkmcnt(8)
  v_mfma_f32_32x32x16_bf16 v[96:111], v[16:19], v[228:231], v[96:111]
  ds_read_b64_tr_b16 v[40:41], v0 offset:47104
  ds_read_b64_tr_b16 v[42:43], v0 offset:47616
  v_cvt_pk_bf16_f32 v84, v88, v89
  v_cvt_pk_bf16_f32 v85, v90, v91
  v_cvt_pk_bf16_f32 v86, v92, v93
  v_cvt_pk_bf16_f32 v87, v94, v95
  v_mfma_f32_32x32x16_bf16 v[96:111], v[20:23], v[232:235], v[96:111]
  ds_read_b64_tr_b16 v[44:45], v0 offset:48128
  ds_read_b64_tr_b16 v[46:47], v0 offset:48640
  v_pk_max_i16 v80, v80, 0
  v_pk_max_i16 v81, v81, 0
  v_pk_max_i16 v82, v82, 0
  v_pk_max_i16 v83, v83, 0
  s_waitcnt lgkmcnt(8)
  v_mfma_f32_32x32x16_bf16 v[96:111], v[24:27], v[236:239], v[96:111]
  v_pk_max_i16 v84, v84, 0
  v_pk_max_i16 v85, v85, 0
  v_pk_max_i16 v86, v86, 0
  v_pk_max_i16 v87, v87, 0
  v_mfma_f32_32x32x16_bf16 v[112:127], v[28:31], v[220:223], v[112:127]
  s_cmp_eq_u32 s17, 0
  s_cbranch_scc1 mk_sg25
  buffer_store_dwordx4 v[80:83], v1, s[4:7], s38 offen offset:2048
  buffer_store_dwordx4 v[84:87], v1, s[4:7], s38 offen offset:3072
mk_sd26:
  s_waitcnt lgkmcnt(4)
  v_mfma_f32_32x32x16_bf16 v[112:127], v[32:35], v[224:227], v[112:127]
  s_nop 2
  v_cvt_pk_bf16_f32 v96, v96, v97
  v_cvt_pk_bf16_f32 v97, v98, v99
  v_cvt_pk_bf16_f32 v98, v100, v101
  v_cvt_pk_bf16_f32 v99, v102, v103
  v_mfma_f32_32x32x16_bf16 v[112:127], v[36:39], v[228:231], v[112:127]
  v_cvt_pk_bf16_f32 v100, v104, v105
  v_cvt_pk_bf16_f32 v101, v106, v107
  v_cvt_pk_bf16_f32 v102, v108, v109
  v_cvt_pk_bf16_f32 v103, v110, v111
  s_waitcnt lgkmcnt(0)
  v_mfma_f32_32x32x16_bf16 v[112:127], v[40:43], v[232:235], v[112:127]
  v_pk_max_i16 v96, v96, 0
  v_pk_max_i16 v97, v97, 0
  v_pk_max_i16 v98, v98, 0
  v_pk_max_i16 v99, v99, 0
  v_mfma_f32_32x32x16_bf16 v[112:127], v[44:47], v[236:239], v[112:127]
  v_pk_max_i16 v100, v100, 0
  v_pk_max_i16 v101, v101, 0
  v_pk_max_i16 v102, v102, 0
  v_pk_max_i16 v103, v103, 0
  s_cmp_eq_u32 s17, 0
  s_cbranch_scc1 mk_sg27
  buffer_store_dwordx4 v[96:99], v1, s[4:7], s39 offen
  buffer_store_dwordx4 v[100:103], v1, s[4:7], s39 offen offset:1024
mk_sd28:
  s_nop 5
  v_cvt_pk_bf16_f32 v112, v112, v113
  v_cvt_pk_bf16_f32 v113, v114, v115
  v_cvt_pk_bf16_f32 v114, v116, v117
  v_cvt_pk_bf16_f32 v115, v118, v119
  v_cvt_pk_bf16_f32 v116, v120, v121
  v_cvt_pk_bf16_f32 v117, v122, v123
  v_cvt_pk_bf16_f32 v118, v124, v125
  v_cvt_pk_bf16_f32 v119, v126, v127
  v_pk_max_i16 v112, v112, 0
  v_pk_max_i16 v113, v113, 0
  v_pk_max_i16 v114, v114, 0
  v_pk_max_i16 v115, v115, 0
  v_pk_max_i16 v116, v116, 0
  v_pk_max_i16 v117, v117, 0
  v_pk_max_i16 v118, v118, 0
  v_pk_max_i16 v119, v119, 0
  s_cmp_eq_u32 s17, 0
  s_cbranch_scc1 mk_sg29
  buffer_store_dwordx4 v[112:115], v1, s[4:7], s39 offen offset:2048
  buffer_store_dwordx4 v[116:119], v1, s[4:7], s39 offen offset:3072
mk_sd30:
  s_mov_b32 s51, s37
  s_xor_b32 s30, s20, 1
  s_mul_i32 s30, s30, 12288
  s_add_u32 s30, s30, 114688
  v_add_u32 v60, s30, v1
  s_xor_b32 s30, s20, 2
  s_mul_i32 s30, s30, 12288
  s_add_u32 s30, s30, 118784
  v_add_u32 v61, s30, v1
  s_xor_b32 s30, s20, 3
  s_mul_i32 s30, s30, 12288
  s_add_u32 s30, s30, 122880
  v_add_u32 v62, s30, v1
  s_mul_i32 s30, s20, 12288
  s_add_u32 s30, s30, 114688
  v_add_u32 v63, s30, v1
  v_lshlrev_b32 v16, 16, v8
  v_and_b32 v17, 0xffff0000, v8
  v_lshlrev_b32 v18, 16, v9
  v_and_b32 v19, 0xffff0000, v9
  v_lshlrev_b32 v20, 16, v10
  v_and_b32 v21, 0xffff0000, v10
  v_lshlrev_b32 v22, 16, v11
  v_and_b32 v23, 0xffff0000, v11
  v_lshlrev_b32 v24, 16, v12
  v_and_b32 v25, 0xffff0000, v12
  v_lshlrev_b32 v26, 16, v13
  v_and_b32 v27, 0xffff0000, v13
  v_lshlrev_b32 v28, 16, v14
  v_and_b32 v29, 0xffff0000, v14
  v_lshlrev_b32 v30, 16, v15
  v_and_b32 v31, 0xffff0000, v15
  s_mul_i32 s38, s26, 28672
  s_lshl_b32 s35, s28, 11
  s_add_u32 s38, s38, s35
  s_add_u32 s38, s38, s18
  s_lshr_b32 s30, s28, 1
  s_and_b32 s31, s28, 1
  s_lshl_b32 s39, s30, 12
  s_lshl_b32 s35, s26, 9
  s_add_u32 s39, s39, s35
  s_lshl_b32 s35, s31, 3
  s_add_u32 s39, s39, s35
  s_add_u32 s39, s39, s18
  s_add_u32 s39, s39, 1179648
  s_lshl_b32 s37, s26, 7
  s_lshl_b32 s35, s28, 3
  s_add_u32 s37, s37, s35
  s_add_u32 s37, s37, s57
  s_add_u32 s37, s37, 1249280
  s_mul_i32 s40, s26, 114688
  s_mul_i32 s35, s20, 28672
  s_add_u32 s40, s40, s35
  s_add_u32 s40, s40, s18
  s_add_u32 s40, s40, 262144
  s_mul_i32 s41, s27, 114688
  s_mul_i32 s35, s20, 28672
  s_add_u32 s41, s41, s35
  s_add_u32 s41, s41, s18
  s_add_u32 s41, s41, 262144
  s_lshl_b32 s30, s26, 7
  s_lshl_b32 s31, s27, 7
  v_and_b32 v7, 15, v2
  v_lshlrev_b32 v7, 3, v7
  v_add_u32 v4, s30, v7
  v_add_u32 v7, s31, v7
  v_cmp_gt_u32 vcc, 16, v2
  s_nop 1
  v_cndmask_b32 v7, v7, v4, vcc
  s_mul_i32 s30, s20, 7
  s_lshr_b32 s30, s30, 1
  s_lshl_b32 s56, s30, 3
  s_add_u32 s56, s56, s57
  s_add_u32 s56, s56, 1248256
  v_mov_b32 v4, s58
  v_mov_b32 v5, s59
  s_mov_b64 exec, 1
  s_waitcnt vmcnt(0)
  s_cmp_eq_u32 s17, 0
  s_cbranch_scc1 mk_sg31
  buffer_store_dwordx2 v[4:5], v1, s[4:7], s51 offen
mk_sd32:
  s_mov_b64 exec, -1
  s_waitcnt lgkmcnt(0)
  s_barrier
  s_and_b32 s30, s26, 3
  s_lshl_b32 s30, s30, 7
  s_add_u32 s30, s30, 114688
  v_lshlrev_b32 v4, 2, v2
  v_add_u32 v4, s30, v4
  ds_read_b32 v32, v4 offset:0
  s_mul_i32 s30, s24, 28672
  s_lshl_b32 s35, s20, 10
  s_add_u32 s30, s30, s35
  s_add_u32 s30, s30, 458752
  s_lshl_b32 s44, s20, 11
  s_add_u32 m0, s44, 0
  s_add_u32 s35, s30, 0
  buffer_load_dwordx4 v1, s[4:7], s35 offen sc1 lds
  s_add_u32 m0, s44, 1024
  s_add_u32 s35, s30, 458752
  buffer_load_dwordx4 v1, s[4:7], s35 offen sc1 lds
  s_add_u32 m0, s44, 8192
  s_add_u32 s35, s30, 4096
  buffer_load_dwordx4 v1, s[4:7], s35 offen sc1 lds
  s_add_u32 m0, s44, 9216
  s_add_u32 s35, s30, 462848
  buffer_load_dwordx4 v1, s[4:7], s35 offen sc1 lds
  s_add_u32 m0, s44, 16384
  s_add_u32 s35, s30, 8192
  buffer_load_dwordx4 v1, s[4:7], s35 offen sc1 lds
  s_add_u32 m0, s44, 17408
  s_add_u32 s35, s30, 466944
  buffer_load_dwordx4 v1, s[4:7], s35 offen sc1 lds
  s_add_u32 m0, s44, 24576
  s_add_u32 s35, s30, 12288
  buffer_load_dwordx4 v1, s[4:7], s35 offen sc1 lds
  s_add_u32 m0, s44, 25600
  s_add_u32 s35, s30, 471040
  buffer_load_dwordx4 v1, s[4:7], s35 offen sc1 lds
  s_add_u32 m0, s44, 32768
  s_add_u32 s35, s30, 16384
  buffer_load_dwordx4 v1, s[4:7], s35 offen sc1 lds
  s_add_u32 m0, s44, 33792
  s_add_u32 s35, s30, 475136
  buffer_load_dwordx4 v1, s[4:7], s35 offen sc1 lds
  s_add_u32 m0, s44, 40960
  s_add_u32 s35, s30, 20480
  buffer_load_dwordx4 v1, s[4:7], s35 offen sc1 lds
  s_add_u32 m0, s44, 41984
  s_add_u32 s35, s30, 479232
  buffer_load_dwordx4 v1, s[4:7], s35 offen sc1 lds
  s_add_u32 m0, s44, 49152
  s_add_u32 s35, s30, 24576
  buffer_load_dwordx4 v1, s[4:7], s35 offen sc1 lds
  s_add_u32 m0, s44, 50176
  s_add_u32 s35, s30, 483328
  buffer_load_dwordx4 v1, s[4:7], s35 offen sc1 lds
  s_waitcnt lgkmcnt(0)
  s_barrier
  s_mov_b32 exec_lo, 0xf000f
  s_mov_b32 exec_hi, 0x0
  s_mov_b32 s36, 0
mk_pl33:
  buffer_load_dwordx2 v[4:5], v7, s[4:7], s56 offen sc1
  s_add_u32 s36, s36, 1
  s_cmp_ge_u32 s36, 0x40000
  s_cbranch_scc1 mk_end
  s_waitcnt vmcnt(0)
  v_cmp_ne_u64 vcc, s[58:59], v[4:5]
  s_cbranch_vccnz mk_pl33
  s_mov_b64 exec, -1
  buffer_load_dwordx4 v[128:131], v1, s[4:7], s41 offen sc1
  buffer_load_dwordx4 v[132:135], v1, s[4:7], s41 offen offset:1024 sc1
  buffer_load_dwordx4 v[136:139], v1, s[4:7], s41 offen offset:2048 sc1
  buffer_load_dwordx4 v[140:143], v1, s[4:7], s41 offen offset:3072 sc1
  s_add_u32 s41, s41, 4096
  buffer_load_dwordx4 v[144:147], v1, s[4:7], s41 offen sc1
  buffer_load_dwordx4 v[148:151], v1, s[4:7], s41 offen offset:1024 sc1
  buffer_load_dwordx4 v[152:155], v1, s[4:7], s41 offen offset:2048 sc1
  buffer_load_dwordx4 v[156:159], v1, s[4:7], s41 offen offset:3072 sc1
  s_waitcnt vmcnt(7)
  v_mfma_f32_32x32x16_bf16 v[96:111], a[0:3], v[128:131], 0
  s_add_u32 s41, s41, 4096
  buffer_load_dwordx4 v[160:163], v1, s[4:7], s41 offen sc1
  v_mfma_f32_32x32x16_bf16 v[112:127], a[4:7], v[128:131], 0
  s_waitcnt vmcnt(7)
  v_mfma_f32_32x32x16_bf16 v[96:111], a[8:11], v[132:135], v[96:111]
  buffer_load_dwordx4 v[164:167], v1, s[4:7], s41 offen offset:1024 sc1
  v_mfma_f32_32x32x16_bf16 v[112:127], a[12:15], v[132:135], v[112:127]
  s_waitcnt vmcnt(7)
  v_mfma_f32_32x32x16_bf16 v[96:111], a[16:19], v[136:139], v[96:111]
  buffer_load_dwordx4 v[168:171], v1, s[4:7], s41 offen offset:2048 sc1
  v_mfma_f32_32x32x16_bf16 v[112:127], a[20:23], v[136:139], v[112:127]
  s_waitcnt vmcnt(7)
  v_mfma_f32_32x32x16_bf16 v[96:111], a[24:27], v[140:143], v[96:111]
  buffer_load_dwordx4 v[172:175], v1, s[4:7], s41 offen offset:3072 sc1
  v_mfma_f32_32x32x16_bf16 v[112:127], a[28:31], v[140:143], v[112:127]
  s_waitcnt vmcnt(7)
  v_mfma_f32_32x32x16_bf16 v[96:111], a[32:35], v[144:147], v[96:111]
  s_add_u32 s41, s41, 4096
  buffer_load_dwordx4 v[176:179], v1, s[4:7], s41 offen sc1
  v_mfma_f32_32x32x16_bf16 v[112:127], a[36:39], v[144:147], v[112:127]
  s_waitcnt vmcnt(7)
  v_mfma_f32_32x32x16_bf16 v[96:111], a[40:43], v[148:151], v[96:111]
  buffer_load_dwordx4 v[180:183], v1, s[4:7], s41 offen offset:1024 sc1
  v_mfma_f32_32x32x16_bf16 v[112:127], a[44:47], v[148:151], v[112:127]
  s_waitcnt vmcnt(7)
  v_mfma_f32_32x32x16_bf16 v[96:111], a[48:51], v[152:155], v[96:111]
  buffer_load_dwordx4 v[184:187], v1, s[4:7], s41 offen offset:2048 sc1
  v_mfma_f32_32x32x16_bf16 v[112:127], a[52:55], v[152:155], v[112:127]
  s_waitcnt vmcnt(7)
  v_mfma_f32_32x32x16_bf16 v[96:111], a[56:59], v[156:159], v[96:111]
  buffer_load_dwordx4 v[188:191], v1, s[4:7], s41 offen offset:3072 sc1
  v_mfma_f32_32x32x16_bf16 v[112:127], a[60:63], v[156:159], v[112:127]
  s_waitcnt vmcnt(7)
  v_mfma_f32_32x32x16_bf16 v[96:111], a[64:67], v[160:163], v[96:111]
  s_add_u32 s41, s41, 4096
  buffer_load_dwordx4 v[192:195], v1, s[4:7], s41 offen sc1
  v_mfma_f32_32x32x16_bf16 v[112:127], a[68:71], v[160:163], v[112:127]
  s_waitcnt vmcnt(7)
  v_mfma_f32_32x32x16_bf16 v[96:111], a[72:75], v[164:167], v[96:111]
  buffer_load_dwordx4 v[196:199], v1, s[4:7], s41 offen offset:1024 sc1
  v_mfma_f32_32x32x16_bf16 v[112:127], a[76:79], v[164:167], v[112:127]
  s_waitcnt vmcnt(7)
  v_mfma_f32_32x32x16_bf16 v[96:111], a[80:83], v[168:171], v[96:111]
  buffer_load_dwordx4 v[200:203], v1, s[4:7], s41 offen offset:2048 sc1
  v_mfma_f32_32x32x16_bf16 v[112:127], a[84:87], v[168:171], v[112:127]
  s_waitcnt vmcnt(7)
  v_mfma_f32_32x32x16_bf16 v[96:111], a[88:91], v[172:175], v[96:111]
  buffer_load_dwordx4 v[204:207], v1, s[4:7], s41 offen offset:3072 sc1
  v_mfma_f32_32x32x16_bf16 v[112:127], a[92:95], v[172:175], v[112:127]
  s_waitcnt vmcnt(7)
  v_mfma_f32_32x32x16_bf16 v[96:111], a[96:99], v[176:179], v[96:111]
  s_add_u32 s41, s41, 4096
  buffer_load_dwordx4 v[128:131], v1, s[4:7], s41 offen sc1
  v_mfma_f32_32x32x16_bf16 v[112:127], a[100:103], v[176:179], v[112:127]
  s_waitcnt vmcnt(7)
  v_mfma_f32_32x32x16_bf16 v[96:111], a[104:107], v[180:183], v[96:111]
  buffer_load_dwordx4 v[132:135], v1, s[4:7], s41 offen offset:1024 sc1
  v_mfma_f32_32x32x16_bf16 v[112:127], a[108:111], v[180:183], v[112:127]
  s_waitcnt vmcnt(7)
  v_mfma_f32_32x32x16_bf16 v[96:111], a[112:115], v[184:187], v[96:111]
  buffer_load_dwordx4 v[136:139], v1, s[4:7], s41 offen offset:2048 sc1
  v_mfma_f32_32x32x16_bf16 v[112:127], a[116:119], v[184:187], v[112:127]
  s_waitcnt vmcnt(7)
  v_mfma_f32_32x32x16_bf16 v[96:111], a[120:123], v[188:191], v[96:111]
  buffer_load_dwordx4 v[140:143], v1, s[4:7], s41 offen offset:3072 sc1
  v_mfma_f32_32x32x16_bf16 v[112:127], a[124:127], v[188:191], v[112:127]
  s_waitcnt vmcnt(7)
  v_mfma_f32_32x32x16_bf16 v[96:111], a[128:131], v[192:195], v[96:111]
  s_add_u32 s41, s41, 4096
  buffer_load_dwordx4 v[144:147], v1, s[4:7], s41 offen sc1
  v_mfma_f32_32x32x16_bf16 v[112:127], a[132:135], v[192:195], v[112:127]
  s_waitcnt vmcnt(7)
  v_mfma_f32_32x32x16_bf16 v[96:111], a[136:139], v[196:199], v[96:111]
  buffer_load_dwordx4 v[148:151], v1, s[4:7], s41 offen offset:1024 sc1
  v_mfma_f32_32x32x16_bf16 v[112:127], a[140:143], v[196:199], v[112:127]
  s_waitcnt vmcnt(7)
  v_mfma_f32_32x32x16_bf16 v[96:111], a[144:147], v[200:203], v[96:111]
  buffer_load_dwordx4 v[152:155], v1, s[4:7], s41 offen offset:2048 sc1
  v_mfma_f32_32x32x16_bf16 v[112:127], a[148:151], v[200:203], v[112:127]
  s_waitcnt vmcnt(7)
  v_mfma_f32_32x32x16_bf16 v[96:111], a[152:155], v[204:207], v[96:111]
  buffer_load_dwordx4 v[156:159], v1, s[4:7], s41 offen offset:3072 sc1
  v_mfma_f32_32x32x16_bf16 v[112:127], a[156:159], v[204:207], v[112:127]
  s_waitcnt vmcnt(7)
  v_mfma_f32_32x32x16_bf16 v[96:111], a[160:163], v[128:131], v[96:111]
  buffer_load_dwordx4 v[160:163], v1, s[4:7], s40 offen sc1
  v_mfma_f32_32x32x16_bf16 v[112:127], a[164:167], v[128:131], v[112:127]
  s_waitcnt vmcnt(7)
  v_mfma_f32_32x32x16_bf16 v[96:111], a[168:171], v[132:135], v[96:111]
  buffer_load_dwordx4 v[164:167], v1, s[4:7], s40 offen offset:1024 sc1
  v_mfma_f32_32x32x16_bf16 v[112:127], a[172:175], v[132:135], v[112:127]
  s_waitcnt vmcnt(7)
  v_mfma_f32_32x32x16_bf16 v[96:111], a[176:179], v[136:139], v[96:111]
  buffer_load_dwordx4 v[168:171], v1, s[4:7], s40 offen offset:2048 sc1
  v_mfma_f32_32x32x16_bf16 v[112:127], a[180:183], v[136:139], v[112:127]
  s_waitcnt vmcnt(7)
  v_mfma_f32_32x32x16_bf16 v[96:111], a[184:187], v[140:143], v[96:111]
  buffer_load_dwordx4 v[172:175], v1, s[4:7], s40 offen offset:3072 sc1
  v_mfma_f32_32x32x16_bf16 v[112:127], a[188:191], v[140:143], v[112:127]
  s_waitcnt vmcnt(7)
  v_mfma_f32_32x32x16_bf16 v[96:111], a[192:195], v[144:147], v[96:111]
  s_add_u32 s40, s40, 4096
  buffer_load_dwordx4 v[176:179], v1, s[4:7], s40 offen sc1
  v_mfma_f32_32x32x16_bf16 v[112:127], a[196:199], v[144:147], v[112:127]
  s_waitcnt vmcnt(7)
  v_mfma_f32_32x32x16_bf16 v[96:111], a[200:203], v[148:151], v[96:111]
  buffer_load_dwordx4 v[180:183], v1, s[4:7], s40 offen offset:1024 sc1
  v_mfma_f32_32x32x16_bf16 v[112:127], a[204:207], v[148:151], v[112:127]
  s_waitcnt vmcnt(7)
  v_mfma_f32_32x32x16_bf16 v[96:111], a[208:211], v[152:155], v[96:111]
  buffer_load_dwordx4 v[184:187], v1, s[4:7], s40 offen offset:2048 sc1
  v_mfma_f32_32x32x16_bf16 v[112:127], a[212:215], v[152:155], v[112:127]
  s_waitcnt vmcnt(7)
  v_mfma_f32_32x32x16_bf16 v[96:111], a[216:219], v[156:159], v[96:111]
  buffer_load_dwordx4 v[188:191], v1, s[4:7], s40 offen offset:3072 sc1
  v_mfma_f32_32x32x16_bf16 v[112:127], a[220:223], v[156:159], v[112:127]
  s_waitcnt vmcnt(7)
  v_mfma_f32_32x32x16_bf16 v[80:95], a[4:7], v[160:163], 0
  s_add_u32 s40, s40, 4096
  buffer_load_dwordx4 v[192:195], v1, s[4:7], s40 offen sc1
  v_mfma_f32_32x32x16_bf16 v[64:79], a[0:3], v[160:163], 0
  s_waitcnt vmcnt(7)
  v_mfma_f32_32x32x16_bf16 v[80:95], a[12:15], v[164:167], v[80:95]
  buffer_load_dwordx4 v[196:199], v1, s[4:7], s40 offen offset:1024 sc1
  s_nop 1
  ds_write_b128 v61, v[96:99] offset:0
  v_mfma_f32_32x32x16_bf16 v[64:79], a[8:11], v[164:167], v[64:79]
  ds_write_b128 v61, v[100:103] offset:1024
  s_waitcnt vmcnt(7)
  v_mfma_f32_32x32x16_bf16 v[80:95], a[20:23], v[168:171], v[80:95]
  buffer_load_dwordx4 v[200:203], v1, s[4:7], s40 offen offset:2048 sc1
  ds_write_b128 v61, v[104:107] offset:2048
  v_mfma_f32_32x32x16_bf16 v[64:79], a[16:19], v[168:171], v[64:79]
  ds_write_b128 v61, v[108:111] offset:3072
  s_waitcnt vmcnt(7)
  v_mfma_f32_32x32x16_bf16 v[80:95], a[28:31], v[172:175], v[80:95]
  buffer_load_dwordx4 v[204:207], v1, s[4:7], s40 offen offset:3072 sc1
  ds_write_b128 v62, v[112:115] offset:0
  v_mfma_f32_32x32x16_bf16 v[64:79], a[24:27], v[172:175], v[64:79]
  ds_write_b128 v62, v[116:119] offset:1024
  s_waitcnt vmcnt(7)
  v_mfma_f32_32x32x16_bf16 v[80:95], a[36:39], v[176:179], v[80:95]
  s_add_u32 s40, s40, 4096
  buffer_load_dwordx4 v[128:131], v1, s[4:7], s40 offen sc1
  ds_write_b128 v62, v[120:123] offset:2048
  v_mfma_f32_32x32x16_bf16 v[64:79], a[32:35], v[176:179], v[64:79]
  ds_write_b128 v62, v[124:127] offset:3072
  s_waitcnt vmcnt(7)
  v_mfma_f32_32x32x16_bf16 v[80:95], a[44:47], v[180:183], v[80:95]
  buffer_load_dwordx4 v[132:135], v1, s[4:7], s40 offen offset:1024 sc1
  v_mfma_f32_32x32x16_bf16 v[64:79], a[40:43], v[180:183], v[64:79]
  s_waitcnt vmcnt(7)
  v_mfma_f32_32x32x16_bf16 v[80:95], a[52:55], v[184:187], v[80:95]
  buffer_load_dwordx4 v[136:139], v1, s[4:7], s40 offen offset:2048 sc1
  s_waitcnt lgkmcnt(0)
  s_barrier
  v_mfma_f32_32x32x16_bf16 v[64:79], a[48:51], v[184:187], v[64:79]
  ds_read_b128 v[208:211], v63 offset:4096
  s_waitcnt vmcnt(7)
  v_mfma_f32_32x32x16_bf16 v[80:95], a[60:63], v[188:191], v[80:95]
  buffer_load_dwordx4 v[140:143], v1, s[4:7], s40 offen offset:3072 sc1
  ds_read_b128 v[212:215], v63 offset:5120
  v_mfma_f32_32x32x16_bf16 v[64:79], a[56:59], v[188:191], v[64:79]
  ds_read_b128 v[216:219], v63 offset:6144
  s_waitcnt vmcnt(7)
  v_mfma_f32_32x32x16_bf16 v[80:95], a[68:71], v[192:195], v[80:95]
  s_add_u32 s40, s40, 4096
  buffer_load_dwordx4 v[144:147], v1, s[4:7], s40 offen sc1
  ds_read_b128 v[220:223], v63 offset:7168
  v_mfma_f32_32x32x16_bf16 v[64:79], a[64:67], v[192:195], v[64:79]
  ds_read_b128 v[224:227], v63 offset:8192
  s_waitcnt vmcnt(7)
  v_mfma_f32_32x32x16_bf16 v[80:95], a[76:79], v[196:199], v[80:95]
  buffer_load_dwordx4 v[148:151], v1, s[4:7], s40 offen offset:1024 sc1
  ds_read_b128 v[228:231], v63 offset:9216
  v_mfma_f32_32x32x16_bf16 v[64:79], a[72:75], v[196:199], v[64:79]
  ds_read_b128 v[232:235], v63 offset:10240
  s_waitcnt vmcnt(7)
  v_mfma_f32_32x32x16_bf16 v[80:95], a[84:87], v[200:203], v[80:95]
  buffer_load_dwordx4 v[152:155], v1, s[4:7], s40 offen offset:2048 sc1
  ds_read_b128 v[236:239], v63 offset:11264
  v_mfma_f32_32x32x16_bf16 v[64:79], a[80:83], v[200:203], v[64:79]
  s_waitcnt vmcnt(7)
  v_mfma_f32_32x32x16_bf16 v[80:95], a[92:95], v[204:207], v[80:95]
  buffer_load_dwordx4 v[156:159], v1, s[4:7], s40 offen offset:3072 sc1
  v_mfma_f32_32x32x16_bf16 v[64:79], a[88:91], v[204:207], v[64:79]
  s_waitcnt lgkmcnt(0)
  s_waitcnt vmcnt(7)
  v_mfma_f32_32x32x16_bf16 v[80:95], a[100:103], v[128:131], v[80:95]
  s_add_u32 s40, s40, 4096
  buffer_load_dwordx4 v[160:163], v1, s[4:7], s40 offen sc1
  v_add_f32 v208, v208, v224
  v_add_f32 v209, v209, v225
  v_add_f32 v210, v210, v226
  v_add_f32 v211, v211, v227
  v_mfma_f32_32x32x16_bf16 v[64:79], a[96:99], v[128:131], v[64:79]
  v_add_f32 v212, v212, v228
  v_add_f32 v213, v213, v229
  v_add_f32 v214, v214, v230
  v_add_f32 v215, v215, v231
  s_waitcnt vmcnt(7)
  v_mfma_f32_32x32x16_bf16 v[80:95], a[108:111], v[132:135], v[80:95]
  buffer_load_dwordx4 v[164:167], v1, s[4:7], s40 offen offset:1024 sc1
  v_add_f32 v216, v216, v232
  v_add_f32 v217, v217, v233
  v_add_f32 v218, v218, v234
  v_add_f32 v219, v219, v235
  v_mfma_f32_32x32x16_bf16 v[64:79], a[104:107], v[132:135], v[64:79]
  v_add_f32 v220, v220, v236
  v_add_f32 v221, v221, v237
  v_add_f32 v222, v222, v238
  v_add_f32 v223, v223, v239
  s_waitcnt vmcnt(7)
  v_mfma_f32_32x32x16_bf16 v[80:95], a[116:119], v[136:139], v[80:95]
  buffer_load_dwordx4 v[168:171], v1, s[4:7], s40 offen offset:2048 sc1
  v_mfma_f32_32x32x16_bf16 v[64:79], a[112:115], v[136:139], v[64:79]
  s_waitcnt vmcnt(7)
  v_mfma_f32_32x32x16_bf16 v[80:95], a[124:127], v[140:143], v[80:95]
  buffer_load_dwordx4 v[172:175], v1, s[4:7], s40 offen offset:3072 sc1
  v_mfma_f32_32x32x16_bf16 v[64:79], a[120:123], v[140:143], v[64:79]
  s_waitcnt vmcnt(7)
  v_mfma_f32_32x32x16_bf16 v[80:95], a[132:135], v[144:147], v[80:95]
  s_add_u32 s40, s40, 4096
  buffer_load_dwordx4 v[176:179], v1, s[4:7], s40 offen sc1
  v_mfma_f32_32x32x16_bf16 v[64:79], a[128:131], v[144:147], v[64:79]
  s_waitcnt vmcnt(7)
  v_mfma_f32_32x32x16_bf16 v[80:95], a[140:143], v[148:151], v[80:95]
  buffer_load_dwordx4 v[180:183], v1, s[4:7], s40 offen offset:1024 sc1
  v_mfma_f32_32x32x16_bf16 v[64:79], a[136:139], v[148:151], v[64:79]
  s_waitcnt vmcnt(7)
  v_mfma_f32_32x32x16_bf16 v[80:95], a[148:151], v[152:155], v[80:95]
  buffer_load_dwordx4 v[184:187], v1, s[4:7], s40 offen offset:2048 sc1
  v_mfma_f32_32x32x16_bf16 v[64:79], a[144:147], v[152:155], v[64:79]
  s_waitcnt vmcnt(7)
  v_mfma_f32_32x32x16_bf16 v[80:95], a[156:159], v[156:159], v[80:95]
  buffer_load_dwordx4 v[188:191], v1, s[4:7], s40 offen offset:3072 sc1
  v_mfma_f32_32x32x16_bf16 v[64:79], a[152:155], v[156:159], v[64:79]
  s_waitcnt vmcnt(7)
  v_mfma_f32_32x32x16_bf16 v[80:95], a[164:167], v[160:163], v[80:95]
  v_lshlrev_b32 v47, 3, v2
  v_mov_b32 v4, 0x7fffff00
  v_cmp_eq_u32 vcc, 1, v3
  s_nop 1
  v_cndmask_b32 v47, v47, v4, vcc
  s_lshl_b32 s31, s24, 8
  s_add_u32 s31, s31, 3735552
  v_mfma_f32_32x32x16_bf16 v[64:79], a[160:163], v[160:163], v[64:79]
  s_waitcnt vmcnt(6)
  v_mfma_f32_32x32x16_bf16 v[80:95], a[172:175], v[164:167], v[80:95]
  s_add_u32 s32, s31, 4096
  buffer_load_dwordx2 v[48:49], v47, s[4:7], s32 offen sc1
  v_mov_b32 v50, 0
  v_mov_b32 v51, 0
  v_mfma_f32_32x32x16_bf16 v[64:79], a[168:171], v[164:167], v[64:79]
  s_waitcnt vmcnt(6)
  v_mfma_f32_32x32x16_bf16 v[80:95], a[180:183], v[168:171], v[80:95]
  s_add_u32 s32, s31, 8192
  buffer_load_dwordx2 v[52:53], v47, s[4:7], s32 offen sc1
  v_mov_b32 v54, 0
  v_mov_b32 v55, 0
  v_mfma_f32_32x32x16_bf16 v[64:79], a[176:179], v[168:171], v[64:79]
  s_waitcnt vmcnt(6)
  v_mfma_f32_32x32x16_bf16 v[80:95], a[188:191], v[172:175], v[80:95]
  s_add_u32 s32, s31, 0
  buffer_load_dwordx2 v[56:57], v47, s[4:7], s32 offen sc1
  v_mov_b32 v58, 0
  v_mov_b32 v59, 0
  v_mfma_f32_32x32x16_bf16 v[64:79], a[184:187], v[172:175], v[64:79]
  s_waitcnt vmcnt(6)
  v_mfma_f32_32x32x16_bf16 v[80:95], a[196:199], v[176:179], v[80:95]
  s_waitcnt vmcnt(5)
  v_mfma_f32_32x32x16_bf16 v[80:95], a[204:207], v[180:183], v[80:95]
  s_waitcnt vmcnt(4)
  v_mfma_f32_32x32x16_bf16 v[80:95], a[212:215], v[184:187], v[80:95]
  s_waitcnt vmcnt(3)
  v_mfma_f32_32x32x16_bf16 v[80:95], a[220:223], v[188:191], v[80:95]
  v_mfma_f32_32x32x16_bf16 v[64:79], a[192:195], v[176:179], v[64:79]
  v_mov_b32 v36, 0
  v_mov_b32 v37, 0
  v_mov_b32 v38, 0
  v_mov_b32 v39, 0
  v_mov_b32 v42, 0x3f803f80
  v_lshlrev_b32 v7, 4, v2
  v_mfma_f32_32x32x16_bf16 v[64:79], a[200:203], v[180:183], v[64:79]
  s_nop 3
  ds_write_b128 v60, v[80:83] offset:0
  v_mfma_f32_32x32x16_bf16 v[64:79], a[208:211], v[184:187], v[64:79]
  ds_write_b128 v60, v[84:87] offset:1024
  ds_write_b128 v60, v[88:91] offset:2048
  v_mfma_f32_32x32x16_bf16 v[64:79], a[216:219], v[188:191], v[64:79]
  ds_write_b128 v60, v[92:95] offset:3072
  s_waitcnt lgkmcnt(0)
  s_barrier
  ds_read_b128 v[240:243], v63 offset:0
  ds_read_b128 v[244:247], v63 offset:1024
  ds_read_b128 v[248:251], v63 offset:2048
  ds_read_b128 v[252:255], v63 offset:3072
  s_nop 4
  v_pk_add_f32 v[64:65], v[64:65], v[208:209]
  v_pk_add_f32 v[66:67], v[66:67], v[210:211]
  v_pk_add_f32 v[68:69], v[68:69], v[212:213]
  v_pk_add_f32 v[70:71], v[70:71], v[214:215]
  v_pk_add_f32 v[72:73], v[72:73], v[216:217]
  v_pk_add_f32 v[74:75], v[74:75], v[218:219]
  v_pk_add_f32 v[76:77], v[76:77], v[220:221]
  v_pk_add_f32 v[78:79], v[78:79], v[222:223]
  s_waitcnt lgkmcnt(0)
  v_pk_add_f32 v[64:65], v[64:65], v[240:241]
  v_pk_add_f32 v[66:67], v[66:67], v[242:243]
  v_pk_add_f32 v[68:69], v[68:69], v[244:245]
  v_pk_add_f32 v[70:71], v[70:71], v[246:247]
  v_pk_add_f32 v[72:73], v[72:73], v[248:249]
  v_pk_add_f32 v[74:75], v[74:75], v[250:251]
  v_pk_add_f32 v[76:77], v[76:77], v[252:253]
  v_pk_add_f32 v[78:79], v[78:79], v[254:255]
  v_pk_fma_f32 v[64:65], v[64:65], v[32:33], v[16:17] op_sel_hi:[1,0,1]
  v_pk_fma_f32 v[66:67], v[66:67], v[32:33], v[18:19] op_sel_hi:[1,0,1]
  v_pk_fma_f32 v[68:69], v[68:69], v[32:33], v[20:21] op_sel_hi:[1,0,1]
  v_pk_fma_f32 v[70:71], v[70:71], v[32:33], v[22:23] op_sel_hi:[1,0,1]
  v_pk_fma_f32 v[72:73], v[72:73], v[32:33], v[24:25] op_sel_hi:[1,0,1]
  v_pk_fma_f32 v[74:75], v[74:75], v[32:33], v[26:27] op_sel_hi:[1,0,1]
  v_pk_fma_f32 v[76:77], v[76:77], v[32:33], v[28:29] op_sel_hi:[1,0,1]
  v_pk_fma_f32 v[78:79], v[78:79], v[32:33], v[30:31] op_sel_hi:[1,0,1]
  v_cvt_pk_bf16_f32 v8, v64, v65
  v_cvt_pk_bf16_f32 v9, v66, v67
  v_cvt_pk_bf16_f32 v10, v68, v69
  v_cvt_pk_bf16_f32 v11, v70, v71
  v_cvt_pk_bf16_f32 v12, v72, v73
  v_cvt_pk_bf16_f32 v13, v74, v75
  v_cvt_pk_bf16_f32 v14, v76, v77
  v_cvt_pk_bf16_f32 v15, v78, v79
  s_cmp_eq_u32 s17, 0
  s_cbranch_scc1 mk_sg35
  buffer_store_dwordx4 v[8:11], v1, s[4:7], s38 offen
  buffer_store_dwordx4 v[12:15], v1, s[4:7], s38 offen offset:1024
mk_sd36:
  v_dot2c_f32_bf16 v36, v8, v42
  v_dot2c_f32_bf16 v37, v8, v8
  v_dot2c_f32_bf16 v38, v9, v42
  v_dot2c_f32_bf16 v39, v9, v9
  v_dot2c_f32_bf16 v36, v10, v42
  v_dot2c_f32_bf16 v37, v10, v10
  v_dot2c_f32_bf16 v38, v11, v42
  v_dot2c_f32_bf16 v39, v11, v11
  v_dot2c_f32_bf16 v36, v12, v42
  v_dot2c_f32_bf16 v37, v12, v12
  v_dot2c_f32_bf16 v38, v13, v42
  v_dot2c_f32_bf16 v39, v13, v13
  v_dot2c_f32_bf16 v36, v14, v42
  v_dot2c_f32_bf16 v37, v14, v14
  v_dot2c_f32_bf16 v38, v15, v42
  v_dot2c_f32_bf16 v39, v15, v15
  s_nop 2
  v_pk_add_f32 v[36:37], v[36:37], v[38:39]
  v_mov_b32 v40, v36
  v_mov_b32 v41, v37
  s_nop 0
  v_permlane32_swap_b32 v36, v40
  v_permlane32_swap_b32 v37, v41
  v_pk_add_f32 v[36:37], v[36:37], v[40:41]
  s_mov_b32 exec_hi, 0
  s_cmp_eq_u32 s17, 0
  s_cbranch_scc1 mk_sg37
  buffer_store_dwordx2 v[36:37], v7, s[4:7], s39 offen
mk_sd38:
  s_mov_b32 exec_hi, -1
  s_mov_b32 s51, s37
  s_mov_b32 s16, 1
  s_add_u32 s57, s57, 4096
  s_mov_b32 s47, 12582912
  s_mov_b32 s48, 3833856
  s_mov_b64 s[52:53], 0
  v_lshrrev_b32 v7, 1, v1
  v_add_u32 v63, 0x10000, v1
  s_lshl_b32 s56, s25, 7
  s_add_u32 s56, s56, s57
  s_add_u32 s56, s56, 1245184
  s_mul_i32 s40, s25, 28672
  s_add_u32 s40, s40, s18
  s_lshl_b32 s45, s25, 9
  s_add_u32 s45, s45, s18
  s_add_u32 s45, s45, 1179648
  s_mul_i32 s42, s24, 28672
  s_lshl_b32 s35, s20, 10
  s_add_u32 s42, s42, s35
  s_lshl_b32 s44, s20, 10
  s_lshl_b32 s38, s24, 18
  s_lshl_b32 s35, s23, 14
  s_add_u32 s38, s38, s35
  s_lshl_b32 s35, s20, 12
  s_add_u32 s38, s38, s35
  s_add_u32 s38, s38, s47
  s_lshl_b32 s37, s24, 11
  s_lshl_b32 s35, s23, 7
  s_add_u32 s37, s37, s35
  s_add_u32 s37, s37, s48
  v_mov_b32 v4, s58
  v_mov_b32 v5, s59
  s_mov_b64 exec, 1
  s_waitcnt vmcnt(0)
  s_cmp_eq_u32 s17, 0
  s_cbranch_scc1 mk_sg39
  buffer_store_dwordx2 v[4:5], v1, s[4:7], s51 offen
mk_sd40:
  s_mov_b64 exec, -1
  s_barrier
  s_or_b32 s30, s2, s20
  s_cmp_lg_u32 s30, 0
  s_cbranch_scc1 mk_ep41
  s_mov_b32 s30, 3796992
  v_mov_b32 v4, s58
  v_mov_b32 v5, s59
  s_mov_b64 exec, 1
  buffer_store_dwordx2 v[4:5], v1, s[4:7], s30 offen
  s_mov_b64 exec, -1
mk_ep41:
mk_layer:
  ds_read_b128 v[16:19], v1 offset:0
  ds_read_b128 v[20:23], v1 offset:1024
  ds_read_b128 v[24:27], v1 offset:2048
  ds_read_b128 v[28:31], v1 offset:3072
  ds_read_b128 v[32:35], v1 offset:4096
  ds_read_b128 v[36:39], v1 offset:5120
  s_mov_b32 exec_lo, 0x3fff
  s_mov_b32 exec_hi, 0x0
  s_mov_b32 s36, 0
mk_pl42:
  buffer_load_dwordx2 v[4:5], v7, s[4:7], s56 offen sc1
  s_add_u32 s36, s36, 1
  s_cmp_ge_u32 s36, 0x40000
  s_cbranch_scc1 mk_end
  s_waitcnt vmcnt(0)
  v_cmp_ne_u64 vcc, s[58:59], v[4:5]
  s_cbranch_vccnz mk_pl42
  s_mov_b64 exec, -1
  buffer_load_dwordx4 v[128:131], v1, s[4:7], s40 offen sc1
  buffer_load_dwordx4 v[132:135], v1, s[4:7], s40 offen offset:1024 sc1
  buffer_load_dwordx4 v[136:139], v1, s[4:7], s40 offen offset:2048 sc1
  buffer_load_dwordx4 v[140:143], v1, s[4:7], s40 offen offset:3072 sc1
  s_add_u32 s40, s40, 4096
  buffer_load_dwordx4 v[144:147], v1, s[4:7], s40 offen sc1
  buffer_load_dwordx4 v[148:151], v1, s[4:7], s40 offen offset:1024 sc1
  v_lshlrev_b32 v7, 4, v2
  v_lshlrev_b32 v4, 14, v3
  v_add_u32 v7, v7, v4
  v_mov_b32 v4, 0x7fffff00
  v_cmp_eq_u32 vcc, 1, v3
  s_nop 1
  v_cndmask_b32 v5, v7, v4, vcc
  s_waitcnt vmcnt(5)
  s_waitcnt lgkmcnt(4)
  v_mfma_f32_32x32x16_bf16 v[64:79], v[16:19], v[128:131], 0
  buffer_load_dwordx4 v[152:155], v1, s[4:7], s40 offen offset:2048 sc1
  ds_read_b128 v[40:43], v1 offset:6144
  v_mfma_f32_32x32x16_bf16 v[80:95], v[128:131], v[20:23], 0
  ds_read_b128 v[44:47], v1 offset:7168
  s_waitcnt vmcnt(5)
  s_waitcnt lgkmcnt(4)
  v_mfma_f32_32x32x16_bf16 v[64:79], v[24:27], v[132:135], v[64:79]
  buffer_load_dwordx4 v[156:159], v1, s[4:7], s40 offen offset:3072 sc1
  ds_read_b128 v[16:19], v1 offset:8192
  v_mfma_f32_32x32x16_bf16 v[80:95], v[132:135], v[28:31], v[80:95]
  ds_read_b128 v[20:23], v1 offset:9216
  s_waitcnt vmcnt(5)
  s_waitcnt lgkmcnt(4)
  v_mfma_f32_32x32x16_bf16 v[64:79], v[32:35], v[136:139], v[64:79]
  s_add_u32 s40, s40, 4096
  buffer_load_dwordx4 v[160:163], v1, s[4:7], s40 offen sc1
  ds_read_b128 v[24:27], v1 offset:10240
  v_mfma_f32_32x32x16_bf16 v[80:95], v[136:139], v[36:39], v[80:95]
  buffer_load_dwordx4 v[240:243], v7, s[4:7], s45 offen sc1
  s_add_u32 s45, s45, 4096
  ds_read_b128 v[28:31], v1 offset:11264
  s_waitcnt vmcnt(6)
  s_waitcnt lgkmcnt(4)
  v_mfma_f32_32x32x16_bf16 v[64:79], v[40:43], v[140:143], v[64:79]
  buffer_load_dwordx4 v[164:167], v1, s[4:7], s40 offen offset:1024 sc1
  ds_read_b128 v[32:35], v1 offset:12288
  v_mfma_f32_32x32x16_bf16 v[80:95], v[140:143], v[44:47], v[80:95]
  buffer_load_dwordx4 v[244:247], v7, s[4:7], s45 offen sc1
  s_add_u32 s45, s45, 4096
  ds_read_b128 v[36:39], v1 offset:13312
  s_waitcnt vmcnt(7)
  s_waitcnt lgkmcnt(4)
  v_mfma_f32_32x32x16_bf16 v[64:79], v[16:19], v[144:147], v[64:79]
  buffer_load_dwordx4 v[168:171], v1, s[4:7], s40 offen offset:2048 sc1
  ds_read_b128 v[40:43], v1 offset:14336
  v_mfma_f32_32x32x16_bf16 v[80:95], v[144:147], v[20:23], v[80:95]
  buffer_load_dwordx4 v[248:251], v7, s[4:7], s45 offen sc1
  s_add_u32 s45, s45, 4096
  ds_read_b128 v[44:47], v1 offset:15360
  s_waitcnt vmcnt(8)
  s_waitcnt lgkmcnt(4)
  v_mfma_f32_32x32x16_bf16 v[64:79], v[24:27], v[148:151], v[64:79]
  buffer_load_dwordx4 v[172:175], v1, s[4:7], s40 offen offset:3072 sc1
  ds_read_b128 v[16:19], v1 offset:16384
  v_mfma_f32_32x32x16_bf16 v[80:95], v[148:151], v[28:31], v[80:95]
  buffer_load_dwordx4 v[252:255], v5, s[4:7], s45 offen sc1
  ds_read_b128 v[20:23], v1 offset:17408
  s_waitcnt vmcnt(9)
  s_waitcnt lgkmcnt(4)
  v_mfma_f32_32x32x16_bf16 v[64:79], v[32:35], v[152:155], v[64:79]
  s_add_u32 s40, s40, 4096
  buffer_load_dwordx4 v[176:179], v1, s[4:7], s40 offen sc1
  ds_read_b128 v[24:27], v1 offset:18432
  v_mfma_f32_32x32x16_bf16 v[80:95], v[152:155], v[36:39], v[80:95]
  ds_read_b128 v[28:31], v1 offset:19456
  s_waitcnt vmcnt(9)
  s_waitcnt lgkmcnt(4)
  v_mfma_f32_32x32x16_bf16 v[64:79], v[40:43], v[156:159], v[64:79]
  buffer_load_dwordx4 v[180:183], v1, s[4:7], s40 offen offset:1024 sc1
  ds_read_b128 v[32:35], v1 offset:20480
  v_mfma_f32_32x32x16_bf16 v[80:95], v[156:159], v[44:47], v[80:95]
  ds_read_b128 v[36:39], v1 offset:21504
  s_waitcnt vmcnt(9)
  s_waitcnt lgkmcnt(4)
  v_mfma_f32_32x32x16_bf16 v[64:79], v[16:19], v[160:163], v[64:79]
  buffer_load_dwordx4 v[184:187], v1, s[4:7], s40 offen offset:2048 sc1
  ds_read_b128 v[40:43], v1 offset:22528
  v_mfma_f32_32x32x16_bf16 v[80:95], v[160:163], v[20:23], v[80:95]
  ds_read_b128 v[44:47], v1 offset:23552
  s_waitcnt vmcnt(8)
  s_waitcnt lgkmcnt(4)
  v_mfma_f32_32x32x16_bf16 v[64:79], v[24:27], v[164:167], v[64:79]
  buffer_load_dwordx4 v[188:191], v1, s[4:7], s40 offen offset:3072 sc1
  ds_read_b128 v[16:19], v1 offset:24576
  v_mfma_f32_32x32x16_bf16 v[80:95], v[164:167], v[28:31], v[80:95]
  ds_read_b128 v[20:23], v1 offset:25600
  s_waitcnt vmcnt(7)
  s_waitcnt lgkmcnt(4)
  v_mfma_f32_32x32x16_bf16 v[64:79], v[32:35], v[168:171], v[64:79]
  s_add_u32 s40, s40, 4096
  buffer_load_dwordx4 v[192:195], v1, s[4:7], s40 offen sc1
  ds_read_b128 v[24:27], v1 offset:26624
  v_mfma_f32_32x32x16_bf16 v[80:95], v[168:171], v[36:39], v[80:95]
  ds_read_b128 v[28:31], v1 offset:27648
  s_waitcnt vmcnt(6)
  s_waitcnt lgkmcnt(4)
  v_mfma_f32_32x32x16_bf16 v[64:79], v[40:43], v[172:175], v[64:79]
  buffer_load_dwordx4 v[196:199], v1, s[4:7], s40 offen offset:1024 sc1
  ds_read_b128 v[32:35], v1 offset:28672
  v_mfma_f32_32x32x16_bf16 v[80:95], v[172:175], v[44:47], v[80:95]
  ds_read_b128 v[36:39], v1 offset:29696
  s_waitcnt vmcnt(5)
  s_waitcnt lgkmcnt(4)
  v_mfma_f32_32x32x16_bf16 v[64:79], v[16:19], v[176:179], v[64:79]
  buffer_load_dwordx4 v[200:203], v1, s[4:7], s40 offen offset:2048 sc1
  ds_read_b128 v[40:43], v1 offset:30720
  v_add_f32 v240, v240, v242
  v_add_f32 v241, v241, v243
  v_add_f32 v244, v244, v246
  v_mfma_f32_32x32x16_bf16 v[80:95], v[176:179], v[20:23], v[80:95]
  ds_read_b128 v[44:47], v1 offset:31744
  v_add_f32 v245, v245, v247
  v_add_f32 v248, v248, v250
  v_add_f32 v249, v249, v251
  s_waitcnt vmcnt(5)
  s_waitcnt lgkmcnt(4)
  v_mfma_f32_32x32x16_bf16 v[64:79], v[24:27], v[180:183], v[64:79]
  buffer_load_dwordx4 v[204:207], v1, s[4:7], s40 offen offset:3072 sc1
  ds_read_b128 v[16:19], v1 offset:32768
  v_add_f32 v252, v252, v254
  v_add_f32 v253, v253, v255
  v_add_f32 v240, v240, v244
  v_mfma_f32_32x32x16_bf16 v[80:95], v[180:183], v[28:31], v[80:95]
  ds_read_b128 v[20:23], v1 offset:33792
  v_add_f32 v241, v241, v245
  v_add_f32 v248, v248, v252
  v_add_f32 v249, v249, v253
  s_waitcnt vmcnt(5)
  s_waitcnt lgkmcnt(4)
  v_mfma_f32_32x32x16_bf16 v[64:79], v[32:35], v[184:187], v[64:79]
  s_add_u32 s40, s40, 4096
  buffer_load_dwordx4 v[208:211], v1, s[4:7], s40 offen sc1
  ds_read_b128 v[24:27], v1 offset:34816
  v_add_f32 v240, v240, v248
  v_add_f32 v241, v241, v249
  v_mov_b32 v242, v240
  v_mfma_f32_32x32x16_bf16 v[80:95], v[184:187], v[36:39], v[80:95]
  ds_read_b128 v[28:31], v1 offset:35840
  v_mov_b32 v243, v241
  v_mov_b32 v246, 0
  v_mov_b32 v247, 0
  s_waitcnt vmcnt(5)
  s_waitcnt lgkmcnt(4)
  v_mfma_f32_32x32x16_bf16 v[64:79], v[40:43], v[188:191], v[64:79]
  buffer_load_dwordx4 v[212:215], v1, s[4:7], s40 offen offset:1024 sc1
  ds_read_b128 v[32:35], v1 offset:36864
  v_permlane32_swap_b32 v240, v242
  v_permlane32_swap_b32 v241, v243
  v_add_f32 v240, v240, v242
  v_mfma_f32_32x32x16_bf16 v[80:95], v[188:191], v[44:47], v[80:95]
  ds_read_b128 v[36:39], v1 offset:37888
  v_add_f32 v241, v241, v243
  v_mul_f32 v240, 0xbb124925, v240
  v_mul_f32 v241, 0x3b124925, v241
  s_waitcnt vmcnt(5)
  s_waitcnt lgkmcnt(4)
  v_mfma_f32_32x32x16_bf16 v[64:79], v[16:19], v[192:195], v[64:79]
  buffer_load_dwordx4 v[216:219], v1, s[4:7], s40 offen offset:2048 sc1
  ds_read_b128 v[40:43], v1 offset:38912
  v_fma_f32 v241, -v240, v240, v241
  v_max_f32 v241, 0, v241
  v_add_f32 v241, 0x3727c5ac, v241
  v_mfma_f32_32x32x16_bf16 v[80:95], v[192:195], v[20:23], v[80:95]
  ds_read_b128 v[44:47], v1 offset:39936
  v_rsq_f32 v241, v241
  v_cvt_pk_bf16_f32 v244, v240, v240
  v_and_b32 v245, 0xffff0000, v244
  s_waitcnt vmcnt(5)
  s_waitcnt lgkmcnt(4)
  v_mfma_f32_32x32x16_bf16 v[64:79], v[24:27], v[196:199], v[64:79]
  buffer_load_dwordx4 v[220:223], v1, s[4:7], s40 offen offset:3072 sc1
  ds_read_b128 v[16:19], v1 offset:40960
  v_sub_f32 v245, v240, v245
  v_cvt_pk_bf16_f32 v245, v245, v245
  s_lshl_b32 s30, s20, 7
  v_mfma_f32_32x32x16_bf16 v[80:95], v[196:199], v[28:31], v[80:95]
  ds_read_b128 v[20:23], v1 offset:41984
  s_add_u32 s30, s30, 122880
  v_lshlrev_b32 v4, 2, v2
  v_add_u32 v4, s30, v4
  s_waitcnt vmcnt(5)
  s_waitcnt lgkmcnt(4)
  v_mfma_f32_32x32x16_bf16 v[64:79], v[32:35], v[200:203], v[64:79]
  s_add_u32 s40, s40, 4096
  buffer_load_dwordx4 v[224:227], v1, s[4:7], s40 offen sc1
  ds_read_b128 v[24:27], v1 offset:43008
  v_lshlrev_b32 v5, 4, v3
  v_add_u32 v5, s30, v5
  v_mfma_f32_32x32x16_bf16 v[80:95], v[200:203], v[36:39], v[80:95]
  ds_read_b128 v[28:31], v1 offset:44032
  s_waitcnt vmcnt(5)
  s_waitcnt lgkmcnt(4)
  v_mfma_f32_32x32x16_bf16 v[64:79], v[40:43], v[204:207], v[64:79]
  buffer_load_dwordx4 v[228:231], v1, s[4:7], s40 offen offset:1024 sc1
  ds_read_b128 v[32:35], v1 offset:45056
  v_mfma_f32_32x32x16_bf16 v[80:95], v[204:207], v[44:47], v[80:95]
  ds_read_b128 v[36:39], v1 offset:46080
  ds_write_b32 v4, v241 offset:0
  ds_read_b128 v[112:115], v5 offset:0
  ds_read_b128 v[116:119], v5 offset:32
  ds_read_b128 v[120:123], v5 offset:64
  ds_read_b128 v[124:127], v5 offset:96
  s_waitcnt vmcnt(5)
  s_waitcnt lgkmcnt(9)
  v_mfma_f32_32x32x16_bf16 v[64:79], v[16:19], v[208:211], v[64:79]
  buffer_load_dwordx4 v[232:235], v1, s[4:7], s40 offen offset:2048 sc1
  ds_read_b128 v[40:43], v1 offset:47104
  v_mfma_f32_32x32x16_bf16 v[80:95], v[208:211], v[20:23], v[80:95]
  ds_read_b128 v[44:47], v1 offset:48128
  s_waitcnt vmcnt(5)
  s_waitcnt lgkmcnt(9)
  v_mfma_f32_32x32x16_bf16 v[64:79], v[24:27], v[212:215], v[64:79]
  buffer_load_dwordx4 v[236:239], v1, s[4:7], s40 offen offset:3072 sc1
  ds_read_b128 v[16:19], v1 offset:49152
  v_mfma_f32_32x32x16_bf16 v[80:95], v[212:215], v[28:31], v[80:95]
  ds_read_b128 v[20:23], v1 offset:50176
  v_mfma_f32_32x32x16_bf16 v[64:79], v[48:51], v[244:247], v[64:79]
  v_mfma_f32_32x32x16_bf16 v[80:95], v[244:247], v[52:55], v[80:95]
  s_waitcnt vmcnt(5)
  s_waitcnt lgkmcnt(9)
  v_mfma_f32_32x32x16_bf16 v[64:79], v[32:35], v[216:219], v[64:79]
  ds_read_b128 v[24:27], v1 offset:51200
  v_mfma_f32_32x32x16_bf16 v[80:95], v[216:219], v[36:39], v[80:95]
  ds_read_b128 v[28:31], v1 offset:52224
  s_add_u32 m0, s44, 86016
  s_add_u32 s35, s42, 0
  buffer_load_dwordx4 v1, s[4:7], s35 offen sc1 lds
  s_waitcnt vmcnt(5)
  s_waitcnt lgkmcnt(4)
  v_mfma_f32_32x32x16_bf16 v[64:79], v[40:43], v[220:223], v[64:79]
  ds_read_b128 v[32:35], v1 offset:53248
  v_mfma_f32_32x32x16_bf16 v[80:95], v[220:223], v[44:47], v[80:95]
  ds_read_b128 v[36:39], v1 offset:54272
  s_add_u32 m0, s44, 90112
  s_add_u32 s35, s42, 4096
  buffer_load_dwordx4 v1, s[4:7], s35 offen sc1 lds
  s_waitcnt vmcnt(5)
  s_waitcnt lgkmcnt(4)
  v_mfma_f32_32x32x16_bf16 v[64:79], v[16:19], v[224:227], v[64:79]
  ds_read_b128 v[40:43], v1 offset:55296
  v_mfma_f32_32x32x16_bf16 v[80:95], v[224:227], v[20:23], v[80:95]
  ds_read_b128 v[44:47], v1 offset:56320
  s_add_u32 m0, s44, 94208
  s_add_u32 s35, s42, 8192
  buffer_load_dwordx4 v1, s[4:7], s35 offen sc1 lds
  s_waitcnt vmcnt(5)
  s_waitcnt lgkmcnt(4)
  v_mfma_f32_32x32x16_bf16 v[64:79], v[24:27], v[228:231], v[64:79]
  v_mfma_f32_32x32x16_bf16 v[80:95], v[228:231], v[28:31], v[80:95]
  s_add_u32 m0, s44, 98304
  s_add_u32 s35, s42, 12288
  buffer_load_dwordx4 v1, s[4:7], s35 offen sc1 lds
  s_waitcnt vmcnt(5)
  s_waitcnt lgkmcnt(2)
  v_mfma_f32_32x32x16_bf16 v[64:79], v[32:35], v[232:235], v[64:79]
  v_mfma_f32_32x32x16_bf16 v[80:95], v[232:235], v[36:39], v[80:95]
  s_add_u32 m0, s44, 102400
  s_add_u32 s35, s42, 16384
  buffer_load_dwordx4 v1, s[4:7], s35 offen sc1 lds
  s_waitcnt vmcnt(5)
  s_waitcnt lgkmcnt(0)
  v_mfma_f32_32x32x16_bf16 v[64:79], v[40:43], v[236:239], v[64:79]
  v_mfma_f32_32x32x16_bf16 v[80:95], v[236:239], v[44:47], v[80:95]
  s_add_u32 m0, s44, 106496
  s_add_u32 s35, s42, 20480
  buffer_load_dwordx4 v1, s[4:7], s35 offen sc1 lds
  s_add_u32 m0, s44, 110592
  s_add_u32 s35, s42, 24576
  buffer_load_dwordx4 v1, s[4:7], s35 offen sc1 lds
  v_mov_b32 v4, 0x3f803f80
  v_cmp_eq_u32 vcc, 28, v2
  s_nop 2
  v_pk_mul_f32 v[64:65], v[64:65], v[240:241] op_sel:[0,1] op_sel_hi:[1,1]
  v_pk_mul_f32 v[66:67], v[66:67], v[240:241] op_sel:[0,1] op_sel_hi:[1,1]
  v_pk_mul_f32 v[68:69], v[68:69], v[240:241] op_sel:[0,1] op_sel_hi:[1,1]
  v_pk_mul_f32 v[70:71], v[70:71], v[240:241] op_sel:[0,1] op_sel_hi:[1,1]
  v_pk_mul_f32 v[72:73], v[72:73], v[240:241] op_sel:[0,1] op_sel_hi:[1,1]
  v_pk_mul_f32 v[74:75], v[74:75], v[240:241] op_sel:[0,1] op_sel_hi:[1,1]
  v_pk_mul_f32 v[76:77], v[76:77], v[240:241] op_sel:[0,1] op_sel_hi:[1,1]
  v_pk_mul_f32 v[78:79], v[78:79], v[240:241] op_sel:[0,1] op_sel_hi:[1,1]
  v_cvt_pk_bf16_f32 v64, v64, v65
  v_cvt_pk_bf16_f32 v65, v66, v67
  v_cvt_pk_bf16_f32 v66, v68, v69
  v_cvt_pk_bf16_f32 v67, v70, v71
  v_cvt_pk_bf16_f32 v68, v72, v73
  v_cvt_pk_bf16_f32 v69, v74, v75
  v_cvt_pk_bf16_f32 v70, v76, v77
  v_cvt_pk_bf16_f32 v71, v78, v79
  buffer_store_dwordx4 v[64:67], v1, s[4:7], s38 offen sc1
  buffer_store_dwordx4 v[68:71], v1, s[4:7], s38 offen offset:1024 sc1
  v_pk_mul_f32 v[80:81], v[80:81], v[112:113]
  v_pk_mul_f32 v[82:83], v[82:83], v[114:115]
  v_pk_mul_f32 v[84:85], v[84:85], v[116:117]
  v_pk_mul_f32 v[86:87], v[86:87], v[118:119]
  v_pk_mul_f32 v[88:89], v[88:89], v[120:121]
  v_pk_mul_f32 v[90:91], v[90:91], v[122:123]
  v_pk_mul_f32 v[92:93], v[92:93], v[124:125]
  v_pk_mul_f32 v[94:95], v[94:95], v[126:127]
  v_cvt_pk_bf16_f32 v80, v80, v81
  v_cvt_pk_bf16_f32 v81, v82, v83
  v_cvt_pk_bf16_f32 v82, v84, v85
  v_cvt_pk_bf16_f32 v83, v86, v87
  v_cvt_pk_bf16_f32 v84, v88, v89
  v_cvt_pk_bf16_f32 v85, v90, v91
  v_cvt_pk_bf16_f32 v86, v92, v93
  v_cvt_pk_bf16_f32 v87, v94, v95
  v_cndmask_b32 v80, v80, v4, vcc
  v_cndmask_b32 v81, v81, v4, vcc
  v_cndmask_b32 v82, v82, v4, vcc
  v_cndmask_b32 v83, v83, v4, vcc
  v_cndmask_b32 v84, v84, v4, vcc
  v_cndmask_b32 v85, v85, v4, vcc
  v_cndmask_b32 v86, v86, v4, vcc
  v_cndmask_b32 v87, v87, v4, vcc
  buffer_store_dwordx4 v[80:83], v1, s[4:7], s38 offen offset:2048 sc1
  buffer_store_dwordx4 v[84:87], v1, s[4:7], s38 offen offset:3072 sc1
  s_waitcnt vmcnt(0)
  s_barrier
  s_cmp_lg_u32 s20, 0
  s_cselect_b32 s37, 0x40000000, s37
  v_mov_b32 v4, s58
  v_mov_b32 v5, s59
  s_mov_b64 exec, 1
  buffer_store_dwordx2 v[4:5], v1, s[4:7], s37 offen sc1
  s_mov_b64 exec, -1
  ds_read_b128 v[16:19], v63 offset:20480
  ds_read_b128 v[20:23], v63 offset:21504
  ds_read_b128 v[24:27], v63 offset:22528
  ds_read_b128 v[28:31], v63 offset:23552
  v_lshrrev_b32 v62, 6, v1
  v_mul_u32_u24 v62, 3584, v62
  v_and_b32 v4, 48, v1
  v_add_u32 v62, v62, v4
  s_lshl_b32 s42, s24, 8
  s_mul_i32 s35, s20, 57344
  s_add_u32 s42, s42, s35
  s_waitcnt lgkmcnt(3)
  v_mfma_f32_32x32x16_bf16 v[96:111], v[16:19], v[128:131], 0
  ds_read_b128 v[32:35], v63 offset:24576
  s_add_u32 m0, s44, 0
  s_add_u32 s43, s42, 0
  buffer_load_dwordx4 v62, s[60:63], s43 offen lds
  s_waitcnt lgkmcnt(3)
  v_mfma_f32_32x32x16_bf16 v[96:111], v[20:23], v[132:135], v[96:111]
  ds_read_b128 v[36:39], v63 offset:25600
  s_add_u32 m0, s44, 28672
  s_add_u32 s43, s42, 64
  buffer_load_dwordx4 v62, s[60:63], s43 offen lds
  s_waitcnt lgkmcnt(3)
  v_mfma_f32_32x32x16_bf16 v[96:111], v[24:27], v[136:139], v[96:111]
  ds_read_b128 v[40:43], v63 offset:26624
  s_add_u32 m0, s44, 4096
  s_add_u32 s43, s42, 229376
  buffer_load_dwordx4 v62, s[60:63], s43 offen lds
  s_waitcnt lgkmcnt(3)
  v_mfma_f32_32x32x16_bf16 v[96:111], v[28:31], v[140:143], v[96:111]
  ds_read_b128 v[44:47], v63 offset:27648
  s_add_u32 m0, s44, 32768
  s_add_u32 s43, s42, 229440
  buffer_load_dwordx4 v62, s[60:63], s43 offen lds
  s_waitcnt lgkmcnt(3)
  v_mfma_f32_32x32x16_bf16 v[96:111], v[32:35], v[144:147], v[96:111]
  ds_read_b128 v[16:19], v63 offset:28672
  s_add_u32 m0, s44, 8192
  s_add_u32 s43, s42, 458752
  buffer_load_dwordx4 v62, s[60:63], s43 offen lds
  s_waitcnt lgkmcnt(3)
  v_mfma_f32_32x32x16_bf16 v[96:111], v[36:39], v[148:151], v[96:111]
  ds_read_b128 v[20:23], v63 offset:29696
  s_add_u32 m0, s44, 36864
  s_add_u32 s43, s42, 458816
  buffer_load_dwordx4 v62, s[60:63], s43 offen lds
  s_waitcnt lgkmcnt(3)
  v_mfma_f32_32x32x16_bf16 v[96:111], v[40:43], v[152:155], v[96:111]
  ds_read_b128 v[24:27], v63 offset:30720
  s_add_u32 m0, s44, 12288
  s_add_u32 s43, s42, 688128
  buffer_load_dwordx4 v62, s[60:63], s43 offen lds
  s_waitcnt lgkmcnt(3)
  v_mfma_f32_32x32x16_bf16 v[96:111], v[44:47], v[156:159], v[96:111]
  ds_read_b128 v[28:31], v63 offset:31744
  s_add_u32 m0, s44, 40960
  s_add_u32 s43, s42, 688192
  buffer_load_dwordx4 v62, s[60:63], s43 offen lds
  s_waitcnt lgkmcnt(3)
  v_mfma_f32_32x32x16_bf16 v[96:111], v[16:19], v[160:163], v[96:111]
  ds_read_b128 v[32:35], v63 offset:32768
  s_waitcnt lgkmcnt(3)
  v_mfma_f32_32x32x16_bf16 v[96:111], v[20:23], v[164:167], v[96:111]
  ds_read_b128 v[36:39], v63 offset:33792
  s_waitcnt lgkmcnt(3)
  v_mfma_f32_32x32x16_bf16 v[96:111], v[24:27], v[168:171], v[96:111]
  ds_read_b128 v[40:43], v63 offset:34816
  s_waitcnt lgkmcnt(3)
  v_mfma_f32_32x32x16_bf16 v[96:111], v[28:31], v[172:175], v[96:111]
  ds_read_b128 v[44:47], v63 offset:35840
  s_waitcnt lgkmcnt(3)
  v_mfma_f32_32x32x16_bf16 v[96:111], v[32:35], v[176:179], v[96:111]
  ds_read_b128 v[16:19], v63 offset:36864
  s_waitcnt lgkmcnt(3)
  v_mfma_f32_32x32x16_bf16 v[96:111], v[36:39], v[180:183], v[96:111]
  ds_read_b128 v[20:23], v63 offset:37888
  s_waitcnt lgkmcnt(3)
  v_mfma_f32_32x32x16_bf16 v[96:111], v[40:43], v[184:187], v[96:111]
  ds_read_b128 v[24:27], v63 offset:38912
  s_waitcnt lgkmcnt(3)
  v_mfma_f32_32x32x16_bf16 v[96:111], v[44:47], v[188:191], v[96:111]
  ds_read_b128 v[28:31], v63 offset:39936
  s_waitcnt lgkmcnt(3)
  v_mfma_f32_32x32x16_bf16 v[96:111], v[16:19], v[192:195], v[96:111]
  ds_read_b128 v[32:35], v63 offset:40960
  s_waitcnt lgkmcnt(3)
  v_mfma_f32_32x32x16_bf16 v[96:111], v[20:23], v[196:199], v[96:111]
  ds_read_b128 v[36:39], v63 offset:41984
  s_waitcnt lgkmcnt(3)
  v_mfma_f32_32x32x16_bf16 v[96:111], v[24:27], v[200:203], v[96:111]
  ds_read_b128 v[40:43], v63 offset:43008
  s_waitcnt lgkmcnt(3)
  v_mfma_f32_32x32x16_bf16 v[96:111], v[28:31], v[204:207], v[96:111]
  ds_read_b128 v[44:47], v63 offset:44032
  s_waitcnt lgkmcnt(3)
  v_mfma_f32_32x32x16_bf16 v[96:111], v[32:35], v[208:211], v[96:111]
  ds_read_b128 v[16:19], v63 offset:45056
  s_waitcnt lgkmcnt(3)
  v_mfma_f32_32x32x16_bf16 v[96:111], v[36:39], v[212:215], v[96:111]
  ds_read_b128 v[20:23], v63 offset:46080
  s_waitcnt lgkmcnt(3)
  v_mfma_f32_32x32x16_bf16 v[96:111], v[40:43], v[216:219], v[96:111]
  ds_read_b128 v[24:27], v63 offset:47104
  s_waitcnt lgkmcnt(3)
  v_mfma_f32_32x32x16_bf16 v[96:111], v[44:47], v[220:223], v[96:111]
  ds_read_b128 v[28:31], v63 offset:48128
  s_waitcnt lgkmcnt(3)
  v_mfma_f32_32x32x16_bf16 v[96:111], v[16:19], v[224:227], v[96:111]
  s_waitcnt lgkmcnt(2)
  v_mfma_f32_32x32x16_bf16 v[96:111], v[20:23], v[228:231], v[96:111]
  s_waitcnt lgkmcnt(1)
  v_mfma_f32_32x32x16_bf16 v[96:111], v[24:27], v[232:235], v[96:111]
  s_waitcnt lgkmcnt(0)
  v_mfma_f32_32x32x16_bf16 v[96:111], v[28:31], v[236:239], v[96:111]
  v_mfma_f32_32x32x16_bf16 v[96:111], v[56:59], v[244:247], v[96:111]
  v_mul_f32 v241, 0x3e8b97f6, v241
  v_mov_b32 v128, v64
  v_mov_b32 v136, v80
  v_mov_b32 v129, v65
  v_mov_b32 v137, v81
  v_mov_b32 v130, v66
  v_mov_b32 v138, v82
  v_mov_b32 v131, v67
  v_mov_b32 v139, v83
  v_mov_b32 v132, v68
  v_mov_b32 v140, v84
  v_mov_b32 v133, v69
  v_mov_b32 v141, v85
  v_mov_b32 v134, v70
  v_mov_b32 v142, v86
  v_mov_b32 v135, v71
  v_mov_b32 v143, v87
  v_pk_mul_f32 v[96:97], v[96:97], v[240:241] op_sel:[0,1] op_sel_hi:[1,1]
  v_pk_mul_f32 v[98:99], v[98:99], v[240:241] op_sel:[0,1] op_sel_hi:[1,1]
  v_pk_mul_f32 v[100:101], v[100:101], v[240:241] op_sel:[0,1] op_sel_hi:[1,1]
  v_pk_mul_f32 v[102:103], v[102:103], v[240:241] op_sel:[0,1] op_sel_hi:[1,1]
  v_pk_mul_f32 v[104:105], v[104:105], v[240:241] op_sel:[0,1] op_sel_hi:[1,1]
  v_pk_mul_f32 v[106:107], v[106:107], v[240:241] op_sel:[0,1] op_sel_hi:[1,1]
  v_pk_mul_f32 v[108:109], v[108:109], v[240:241] op_sel:[0,1] op_sel_hi:[1,1]
  v_pk_mul_f32 v[110:111], v[110:111], v[240:241] op_sel:[0,1] op_sel_hi:[1,1]
  v_cvt_pk_bf16_f32 v96, v96, v97
  v_cvt_pk_bf16_f32 v97, v98, v99
  v_cvt_pk_bf16_f32 v98, v100, v101
  v_cvt_pk_bf16_f32 v99, v102, v103
  v_cvt_pk_bf16_f32 v100, v104, v105
  v_cvt_pk_bf16_f32 v101, v106, v107
  v_cvt_pk_bf16_f32 v102, v108, v109
  v_cvt_pk_bf16_f32 v103, v110, v111
  s_lshl_b32 s30, s20, 11
  s_add_u32 s30, s30, 114688
  v_add_u32 v4, s30, v1
  ds_write_b128 v4, v[96:99] offset:0
  ds_write_b128 v4, v[100:103] offset:1024
  s_waitcnt lgkmcnt(0)
  s_barrier
  s_xor_b32 s30, s20, 0
  s_lshl_b32 s30, s30, 11
  s_add_u32 s30, s30, 114688
  v_add_u32 v4, s30, v1
  ds_read_b128 a[224:227], v4 offset:0
  ds_read_b128 a[228:231], v4 offset:1024
  s_xor_b32 s30, s20, 1
  s_lshl_b32 s30, s30, 11
  s_add_u32 s30, s30, 114688
  v_add_u32 v4, s30, v1
  ds_read_b128 a[232:235], v4 offset:0
  ds_read_b128 a[236:239], v4 offset:1024
  s_xor_b32 s30, s20, 2
  s_lshl_b32 s30, s30, 11
  s_add_u32 s30, s30, 114688
  v_add_u32 v4, s30, v1
  ds_read_b128 a[240:243], v4 offset:0
  ds_read_b128 a[244:247], v4 offset:1024
  s_xor_b32 s30, s20, 3
  s_lshl_b32 s30, s30, 11
  s_add_u32 s30, s30, 114688
  v_add_u32 v4, s30, v1
  ds_read_b128 a[248:251], v4 offset:0
  ds_read_b128 a[252:255], v4 offset:1024
  v_mov_b32 v58, v62
  s_xor_b32 s30, s20, 1
  s_mul_i32 s30, s30, 12288
  s_add_u32 s30, s30, 114688
  v_add_u32 v60, s30, v1
  s_xor_b32 s30, s20, 2
  s_mul_i32 s30, s30, 12288
  s_add_u32 s30, s30, 118784
  v_add_u32 v61, s30, v1
  s_xor_b32 s30, s20, 3
  s_mul_i32 s30, s30, 12288
  s_add_u32 s30, s30, 122880
  v_add_u32 v62, s30, v1
  s_mul_i32 s30, s20, 12288
  s_add_u32 s30, s30, 114688
  v_add_u32 v63, s30, v1
  s_lshl_b32 s30, s24, 11
  s_add_u32 s30, s30, s48
  v_xor_b32 v7, s23, v2
  v_lshlrev_b32 v7, 7, v7
  v_add_u32 v7, s30, v7
  v_mov_b32 v4, 0x7fffff00
  v_cmp_gt_u32 vcc, 256, v1
  s_nop 1
  v_cndmask_b32 v57, v4, v7, vcc
  s_mov_b32 s56, 0
  s_mov_b32 s46, s38
  s_lshl_b32 s32, s28, 15
  s_lshl_b32 s35, s20, 13
  s_add_u32 s32, s32, s35
  s_add_u32 s32, s32, 1376256
  s_lshl_b32 s33, s29, 15
  s_lshl_b32 s35, s20, 13
  s_add_u32 s33, s33, s35
  s_add_u32 s33, s33, 1376256
  s_mul_i32 s38, s25, 114688
  s_lshl_b32 s35, s24, 11
  s_add_u32 s38, s38, s35
  s_add_u32 s38, s38, s18
  s_add_u32 s38, s38, 262144
  s_lshl_b32 s37, s25, 7
  s_lshl_b32 s35, s24, 3
  s_add_u32 s37, s37, s35
  s_add_u32 s37, s37, s57
  s_add_u32 s37, s37, 1246208
  s_mul_i32 s54, s22, 40960
  s_mul_i32 s35, s20, 10240
  s_add_u32 s54, s54, s35
  s_add_u32 s54, s54, s18
  s_add_u32 s55, s54, 2048
  v_lshlrev_b32 v59, 3, v1
  s_waitcnt lgkmcnt(0)
  v_mfma_f32_32x32x16_bf16 v[16:31], v[128:131], a[232:235], 0
  v_mfma_f32_32x32x16_bf16 v[16:31], v[132:135], a[236:239], v[16:31]
  s_barrier
  s_nop 10
  v_exp_f32 v16, v16
  v_exp_f32 v17, v17
  v_exp_f32 v18, v18
  v_exp_f32 v19, v19
  s_mov_b32 exec_lo, 0xe
  s_mov_b32 exec_hi, 0x0
  s_mov_b32 s36, 0
mk_pl44:
  s_sleep 1
  buffer_load_dwordx2 v[4:5], v7, s[4:7], s56 offen sc1
  s_add_u32 s36, s36, 1
  s_cmp_ge_u32 s36, 0x40000
  s_cbranch_scc1 mk_end
  s_waitcnt vmcnt(0)
  v_cmp_ne_u64 vcc, s[58:59], v[4:5]
  s_cbranch_vccnz mk_pl44
  s_mov_b64 exec, -1
  s_xor_b32 s40, s46, 16384
  buffer_load_dwordx4 v[144:147], v1, s[4:7], s40 offen sc1
  buffer_load_dwordx4 v[148:151], v1, s[4:7], s40 offen offset:1024 sc1
  buffer_load_dwordx4 v[152:155], v1, s[4:7], s40 offen offset:2048 sc1
  buffer_load_dwordx4 v[156:159], v1, s[4:7], s40 offen offset:3072 sc1
  v_exp_f32 v20, v20
  v_exp_f32 v21, v21
  v_exp_f32 v22, v22
  v_mfma_f32_32x32x16_bf16 v[32:47], v[128:131], a[240:243], 0
  s_xor_b32 s40, s46, 32768
  v_cvt_pk_bf16_f32 v48, v16, v17
  v_cvt_pk_bf16_f32 v49, v18, v19
  v_exp_f32 v23, v23
  v_exp_f32 v24, v24
  v_exp_f32 v25, v25
  v_exp_f32 v26, v26
  v_mfma_f32_32x32x16_bf16 v[32:47], v[132:135], a[244:247], v[32:47]
  buffer_load_dwordx4 v[160:163], v1, s[4:7], s40 offen sc1
  v_cvt_pk_bf16_f32 v50, v20, v21
  v_cvt_pk_bf16_f32 v51, v22, v23
  v_exp_f32 v27, v27
  v_exp_f32 v28, v28
  v_exp_f32 v29, v29
  v_exp_f32 v30, v30
  v_mfma_f32_32x32x16_bf16 v[80:95], v[136:139], v[48:51], 0
  buffer_load_dwordx4 v[164:167], v1, s[4:7], s40 offen offset:1024 sc1
  v_exp_f32 v31, v31
  v_cvt_pk_bf16_f32 v52, v24, v25
  v_cvt_pk_bf16_f32 v53, v26, v27
  v_cvt_pk_bf16_f32 v54, v28, v29
  v_cvt_pk_bf16_f32 v55, v30, v31
  v_exp_f32 v32, v32
  v_exp_f32 v33, v33
  v_exp_f32 v34, v34
  v_exp_f32 v35, v35
  v_mfma_f32_32x32x16_bf16 v[80:95], v[140:143], v[52:55], v[80:95]
  buffer_load_dwordx4 v[168:171], v1, s[4:7], s40 offen offset:2048 sc1
  v_exp_f32 v36, v36
  v_exp_f32 v37, v37
  v_exp_f32 v38, v38
  v_mfma_f32_32x32x16_bf16 v[16:31], v[128:131], a[248:251], 0
  buffer_load_dwordx4 v[172:175], v1, s[4:7], s40 offen offset:3072 sc1
  v_cvt_pk_bf16_f32 v48, v32, v33
  v_cvt_pk_bf16_f32 v49, v34, v35
  v_exp_f32 v39, v39
  v_exp_f32 v40, v40
  v_exp_f32 v41, v41
  v_exp_f32 v42, v42
  v_mfma_f32_32x32x16_bf16 v[16:31], v[132:135], a[252:255], v[16:31]
  buffer_load_dwordx2 v[4:5], v57, s[4:7], s56 offen sc1
  v_cvt_pk_bf16_f32 v50, v36, v37
  v_cvt_pk_bf16_f32 v51, v38, v39
  v_exp_f32 v43, v43
  v_exp_f32 v44, v44
  v_exp_f32 v45, v45
  v_exp_f32 v46, v46
  v_mfma_f32_32x32x16_bf16 v[96:111], v[136:139], v[48:51], 0
  s_xor_b32 s40, s46, 49152
  v_exp_f32 v47, v47
  v_cvt_pk_bf16_f32 v52, v40, v41
  v_cvt_pk_bf16_f32 v53, v42, v43
  v_cvt_pk_bf16_f32 v54, v44, v45
  v_cvt_pk_bf16_f32 v55, v46, v47
  v_exp_f32 v16, v16
  v_exp_f32 v17, v17
  v_exp_f32 v18, v18
  v_exp_f32 v19, v19
  v_mfma_f32_32x32x16_bf16 v[96:111], v[140:143], v[52:55], v[96:111]
  buffer_load_dwordx4 v[176:179], v1, s[4:7], s40 offen sc1
  v_exp_f32 v20, v20
  v_exp_f32 v21, v21
  v_exp_f32 v22, v22
  v_mfma_f32_32x32x16_bf16 v[32:47], v[128:131], a[224:227], 0
  buffer_load_dwordx4 v[180:183], v1, s[4:7], s40 offen offset:1024 sc1
  v_cvt_pk_bf16_f32 v48, v16, v17
  v_cvt_pk_bf16_f32 v49, v18, v19
  v_exp_f32 v23, v23
  v_exp_f32 v24, v24
  v_exp_f32 v25, v25
  v_exp_f32 v26, v26
  v_mfma_f32_32x32x16_bf16 v[32:47], v[132:135], a[228:231], v[32:47]
  buffer_load_dwordx4 v[184:187], v1, s[4:7], s40 offen offset:2048 sc1
  v_cvt_pk_bf16_f32 v50, v20, v21
  v_cvt_pk_bf16_f32 v51, v22, v23
  v_exp_f32 v27, v27
  v_exp_f32 v28, v28
  v_exp_f32 v29, v29
  v_exp_f32 v30, v30
  v_mfma_f32_32x32x16_bf16 v[112:127], v[136:139], v[48:51], 0
  buffer_load_dwordx4 v[188:191], v1, s[4:7], s40 offen offset:3072 sc1
  v_exp_f32 v31, v31
  v_cvt_pk_bf16_f32 v52, v24, v25
  v_cvt_pk_bf16_f32 v53, v26, v27
  v_cvt_pk_bf16_f32 v54, v28, v29
  v_cvt_pk_bf16_f32 v55, v30, v31
  v_exp_f32 v32, v32
  v_exp_f32 v33, v33
  v_exp_f32 v34, v34
  v_exp_f32 v35, v35
  v_mfma_f32_32x32x16_bf16 v[112:127], v[140:143], v[52:55], v[112:127]
  s_waitcnt vmcnt(9)
  v_exp_f32 v36, v36
  v_exp_f32 v37, v37
  v_exp_f32 v38, v38
  v_mfma_f32_32x32x16_bf16 v[16:31], v[144:147], a[232:235], 0
  v_cvt_pk_bf16_f32 v48, v32, v33
  v_cvt_pk_bf16_f32 v49, v34, v35
  v_exp_f32 v39, v39
  v_exp_f32 v40, v40
  v_exp_f32 v41, v41
  v_exp_f32 v42, v42
  v_mfma_f32_32x32x16_bf16 v[16:31], v[148:151], a[236:239], v[16:31]
  v_cvt_pk_bf16_f32 v50, v36, v37
  v_cvt_pk_bf16_f32 v51, v38, v39
  v_exp_f32 v43, v43
  v_exp_f32 v44, v44
  v_exp_f32 v45, v45
  v_exp_f32 v46, v46
  v_mfma_f32_32x32x16_bf16 v[64:79], v[136:139], v[48:51], 0
  v_exp_f32 v47, v47
  v_cvt_pk_bf16_f32 v52, v40, v41
  v_cvt_pk_bf16_f32 v53, v42, v43
  v_cvt_pk_bf16_f32 v54, v44, v45
  v_cvt_pk_bf16_f32 v55, v46, v47
  v_exp_f32 v16, v16
  v_exp_f32 v17, v17
  v_exp_f32 v18, v18
  v_exp_f32 v19, v19
  v_mfma_f32_32x32x16_bf16 v[64:79], v[140:143], v[52:55], v[64:79]
  v_exp_f32 v20, v20
  v_exp_f32 v21, v21
  v_exp_f32 v22, v22
  v_mfma_f32_32x32x16_bf16 v[32:47], v[144:147], a[240:243], 0
  s_add_u32 m0, s44, 16384
  v_cvt_pk_bf16_f32 v48, v16, v17
  v_cvt_pk_bf16_f32 v49, v18, v19
  v_exp_f32 v23, v23
  v_exp_f32 v24, v24
  v_exp_f32 v25, v25
  v_exp_f32 v26, v26
  v_mfma_f32_32x32x16_bf16 v[32:47], v[148:151], a[244:247], v[32:47]
  s_add_u32 s43, s42, 917504
  v_cvt_pk_bf16_f32 v50, v20, v21
  v_cvt_pk_bf16_f32 v51, v22, v23
  v_exp_f32 v27, v27
  v_exp_f32 v28, v28
  v_exp_f32 v29, v29
  v_exp_f32 v30, v30
  v_mfma_f32_32x32x16_bf16 v[80:95], v[152:155], v[48:51], v[80:95]
  v_exp_f32 v31, v31
  v_cvt_pk_bf16_f32 v52, v24, v25
  v_cvt_pk_bf16_f32 v53, v26, v27
  v_cvt_pk_bf16_f32 v54, v28, v29
  v_cvt_pk_bf16_f32 v55, v30, v31
  v_exp_f32 v32, v32
  v_exp_f32 v33, v33
  v_exp_f32 v34, v34
  v_exp_f32 v35, v35
  v_mfma_f32_32x32x16_bf16 v[80:95], v[156:159], v[52:55], v[80:95]
  v_exp_f32 v36, v36
  v_exp_f32 v37, v37
  v_exp_f32 v38, v38
  v_mfma_f32_32x32x16_bf16 v[16:31], v[144:147], a[248:251], 0
  buffer_load_dwordx4 v58, s[60:63], s43 offen lds
  v_cvt_pk_bf16_f32 v48, v32, v33
  v_cvt_pk_bf16_f32 v49, v34, v35
  v_exp_f32 v39, v39
  v_exp_f32 v40, v40
  v_exp_f32 v41, v41
  v_exp_f32 v42, v42
  v_mfma_f32_32x32x16_bf16 v[16:31], v[148:151], a[252:255], v[16:31]
  buffer_load_dwordx4 v[192:195], v1, s[4:7], s32 offen sc1
  v_cvt_pk_bf16_f32 v50, v36, v37
  v_cvt_pk_bf16_f32 v51, v38, v39
  v_exp_f32 v43, v43
  v_exp_f32 v44, v44
  v_exp_f32 v45, v45
  v_exp_f32 v46, v46
  v_mfma_f32_32x32x16_bf16 v[96:111], v[152:155], v[48:51], v[96:111]
  v_exp_f32 v47, v47
  v_cvt_pk_bf16_f32 v52, v40, v41
  v_cvt_pk_bf16_f32 v53, v42, v43
  v_cvt_pk_bf16_f32 v54, v44, v45
  v_cvt_pk_bf16_f32 v55, v46, v47
  v_exp_f32 v16, v16
  v_exp_f32 v17, v17
  v_exp_f32 v18, v18
  v_exp_f32 v19, v19
  v_mfma_f32_32x32x16_bf16 v[96:111], v[156:159], v[52:55], v[96:111]
  v_exp_f32 v20, v20
  v_exp_f32 v21, v21
  v_exp_f32 v22, v22
  v_mfma_f32_32x32x16_bf16 v[32:47], v[144:147], a[224:227], 0
  s_add_u32 m0, s44, 45056
  v_cvt_pk_bf16_f32 v48, v16, v17
  v_cvt_pk_bf16_f32 v49, v18, v19
  v_exp_f32 v23, v23
  v_exp_f32 v24, v24
  v_exp_f32 v25, v25
  v_exp_f32 v26, v26
  v_mfma_f32_32x32x16_bf16 v[32:47], v[148:151], a[228:231], v[32:47]
  v_cvt_pk_bf16_f32 v50, v20, v21
  v_cvt_pk_bf16_f32 v51, v22, v23
  v_exp_f32 v27, v27
  v_exp_f32 v28, v28
  v_exp_f32 v29, v29
  v_exp_f32 v30, v30
  v_mfma_f32_32x32x16_bf16 v[112:127], v[152:155], v[48:51], v[112:127]
  v_exp_f32 v31, v31
  v_cvt_pk_bf16_f32 v52, v24, v25
  v_cvt_pk_bf16_f32 v53, v26, v27
  v_cvt_pk_bf16_f32 v54, v28, v29
  v_cvt_pk_bf16_f32 v55, v30, v31
  v_exp_f32 v32, v32
  v_exp_f32 v33, v33
  v_exp_f32 v34, v34
  v_exp_f32 v35, v35
  v_mfma_f32_32x32x16_bf16 v[112:127], v[156:159], v[52:55], v[112:127]
  s_waitcnt vmcnt(7)
  v_exp_f32 v36, v36
  v_exp_f32 v37, v37
  v_exp_f32 v38, v38
  v_mfma_f32_32x32x16_bf16 v[16:31], v[160:163], a[232:235], 0
  s_add_u32 s43, s42, 917568
  v_cvt_pk_bf16_f32 v48, v32, v33
  v_cvt_pk_bf16_f32 v49, v34, v35
  v_exp_f32 v39, v39
  v_exp_f32 v40, v40
  v_exp_f32 v41, v41
  v_exp_f32 v42, v42
  v_mfma_f32_32x32x16_bf16 v[16:31], v[164:167], a[236:239], v[16:31]
  buffer_load_dwordx4 v58, s[60:63], s43 offen lds
  v_cvt_pk_bf16_f32 v50, v36, v37
  v_cvt_pk_bf16_f32 v51, v38, v39
  v_exp_f32 v43, v43
  v_exp_f32 v44, v44
  v_exp_f32 v45, v45
  v_exp_f32 v46, v46
  v_mfma_f32_32x32x16_bf16 v[64:79], v[152:155], v[48:51], v[64:79]
  v_exp_f32 v47, v47
  v_cvt_pk_bf16_f32 v52, v40, v41
  v_cvt_pk_bf16_f32 v53, v42, v43
  v_cvt_pk_bf16_f32 v54, v44, v45
  v_cvt_pk_bf16_f32 v55, v46, v47
  v_exp_f32 v16, v16
  v_exp_f32 v17, v17
  v_exp_f32 v18, v18
  v_exp_f32 v19, v19
  v_mfma_f32_32x32x16_bf16 v[64:79], v[156:159], v[52:55], v[64:79]
  v_exp_f32 v20, v20
  v_exp_f32 v21, v21
  v_exp_f32 v22, v22
  v_mfma_f32_32x32x16_bf16 v[32:47], v[160:163], a[240:243], 0
  s_waitcnt vmcnt(7)
  v_cmp_ne_u64 vcc, s[58:59], v[4:5]
  s_nop 0
  s_and_b32 s34, vcc_lo, 0xf0
  s_cbranch_scc1 mk_fs46
mk_fr47:
  v_cvt_pk_bf16_f32 v48, v16, v17
  v_cvt_pk_bf16_f32 v49, v18, v19
  v_exp_f32 v23, v23
  v_exp_f32 v24, v24
  v_exp_f32 v25, v25
  v_exp_f32 v26, v26
  v_mfma_f32_32x32x16_bf16 v[32:47], v[164:167], a[244:247], v[32:47]
  s_xor_b32 s40, s46, 65536
  v_cvt_pk_bf16_f32 v50, v20, v21
  v_cvt_pk_bf16_f32 v51, v22, v23
  v_exp_f32 v27, v27
  v_exp_f32 v28, v28
  v_exp_f32 v29, v29
  v_exp_f32 v30, v30
  v_mfma_f32_32x32x16_bf16 v[80:95], v[168:171], v[48:51], v[80:95]
  buffer_load_dwordx4 v[128:131], v1, s[4:7], s40 offen sc1
  v_exp_f32 v31, v31
  v_cvt_pk_bf16_f32 v52, v24, v25
  v_cvt_pk_bf16_f32 v53, v26, v27
  v_cvt_pk_bf16_f32 v54, v28, v29
  v_cvt_pk_bf16_f32 v55, v30, v31
  v_exp_f32 v32, v32
  v_exp_f32 v33, v33
  v_exp_f32 v34, v34
  v_exp_f32 v35, v35
  v_mfma_f32_32x32x16_bf16 v[80:95], v[172:175], v[52:55], v[80:95]
  buffer_load_dwordx4 v[132:135], v1, s[4:7], s40 offen offset:1024 sc1
  v_exp_f32 v36, v36
  v_exp_f32 v37, v37
  v_exp_f32 v38, v38
  v_mfma_f32_32x32x16_bf16 v[16:31], v[160:163], a[248:251], 0
  buffer_load_dwordx4 v[136:139], v1, s[4:7], s40 offen offset:2048 sc1
  v_cvt_pk_bf16_f32 v48, v32, v33
  v_cvt_pk_bf16_f32 v49, v34, v35
  v_exp_f32 v39, v39
  v_exp_f32 v40, v40
  v_exp_f32 v41, v41
  v_exp_f32 v42, v42
  v_mfma_f32_32x32x16_bf16 v[16:31], v[164:167], a[252:255], v[16:31]
  buffer_load_dwordx4 v[140:143], v1, s[4:7], s40 offen offset:3072 sc1
  v_cvt_pk_bf16_f32 v50, v36, v37
  v_cvt_pk_bf16_f32 v51, v38, v39
  v_exp_f32 v43, v43
  v_exp_f32 v44, v44
  v_exp_f32 v45, v45
  v_exp_f32 v46, v46
  v_mfma_f32_32x32x16_bf16 v[96:111], v[168:171], v[48:51], v[96:111]
  s_xor_b32 s40, s46, 81920
  v_exp_f32 v47, v47
  v_cvt_pk_bf16_f32 v52, v40, v41
  v_cvt_pk_bf16_f32 v53, v42, v43
  v_cvt_pk_bf16_f32 v54, v44, v45
  v_cvt_pk_bf16_f32 v55, v46, v47
  v_exp_f32 v16, v16
  v_exp_f32 v17, v17
  v_exp_f32 v18, v18
  v_exp_f32 v19, v19
  v_mfma_f32_32x32x16_bf16 v[96:111], v[172:175], v[52:55], v[96:111]
  buffer_load_dwordx4 v[144:147], v1, s[4:7], s40 offen sc1
  v_exp_f32 v20, v20
  v_exp_f32 v21, v21
  v_exp_f32 v22, v22
  v_mfma_f32_32x32x16_bf16 v[32:47], v[160:163], a[224:227], 0
  buffer_load_dwordx4 v[148:151], v1, s[4:7], s40 offen offset:1024 sc1
  v_cvt_pk_bf16_f32 v48, v16, v17
  v_cvt_pk_bf16_f32 v49, v18, v19
  v_exp_f32 v23, v23
  v_exp_f32 v24, v24
  v_exp_f32 v25, v25
  v_exp_f32 v26, v26
  v_mfma_f32_32x32x16_bf16 v[32:47], v[164:167], a[228:231], v[32:47]
  buffer_load_dwordx4 v[152:155], v1, s[4:7], s40 offen offset:2048 sc1
  v_cvt_pk_bf16_f32 v50, v20, v21
  v_cvt_pk_bf16_f32 v51, v22, v23
  v_exp_f32 v27, v27
  v_exp_f32 v28, v28
  v_exp_f32 v29, v29
  v_exp_f32 v30, v30
  v_mfma_f32_32x32x16_bf16 v[112:127], v[168:171], v[48:51], v[112:127]
  buffer_load_dwordx4 v[156:159], v1, s[4:7], s40 offen offset:3072 sc1
  v_exp_f32 v31, v31
  v_cvt_pk_bf16_f32 v52, v24, v25
  v_cvt_pk_bf16_f32 v53, v26, v27
  v_cvt_pk_bf16_f32 v54, v28, v29
  v_cvt_pk_bf16_f32 v55, v30, v31
  v_exp_f32 v32, v32
  v_exp_f32 v33, v33
  v_exp_f32 v34, v34
  v_exp_f32 v35, v35
  v_mfma_f32_32x32x16_bf16 v[112:127], v[172:175], v[52:55], v[112:127]
  s_waitcnt vmcnt(11)
  v_exp_f32 v36, v36
  v_exp_f32 v37, v37
  v_exp_f32 v38, v38
  v_mfma_f32_32x32x16_bf16 v[16:31], v[176:179], a[232:235], 0
  buffer_load_dwordx4 v[196:199], v1, s[4:7], s33 offen sc1
  v_cvt_pk_bf16_f32 v48, v32, v33
  v_cvt_pk_bf16_f32 v49, v34, v35
  v_exp_f32 v39, v39
  v_exp_f32 v40, v40
  v_exp_f32 v41, v41
  v_exp_f32 v42, v42
  v_mfma_f32_32x32x16_bf16 v[16:31], v[180:183], a[236:239], v[16:31]
  s_add_u32 m0, s44, 20480
  v_cvt_pk_bf16_f32 v50, v36, v37
  v_cvt_pk_bf16_f32 v51, v38, v39
  v_exp_f32 v43, v43
  v_exp_f32 v44, v44
  v_exp_f32 v45, v45
  v_exp_f32 v46, v46
  v_mfma_f32_32x32x16_bf16 v[64:79], v[168:171], v[48:51], v[64:79]
  s_add_u32 s43, s42, 1146880
  v_exp_f32 v47, v47
  v_cvt_pk_bf16_f32 v52, v40, v41
  v_cvt_pk_bf16_f32 v53, v42, v43
  v_cvt_pk_bf16_f32 v54, v44, v45
  v_cvt_pk_bf16_f32 v55, v46, v47
  v_exp_f32 v16, v16
  v_exp_f32 v17, v17
  v_exp_f32 v18, v18
  v_exp_f32 v19, v19
  v_mfma_f32_32x32x16_bf16 v[64:79], v[172:175], v[52:55], v[64:79]
  buffer_load_dwordx4 v58, s[60:63], s43 offen lds
  v_exp_f32 v20, v20
  v_exp_f32 v21, v21
  v_exp_f32 v22, v22
  v_mfma_f32_32x32x16_bf16 v[32:47], v[176:179], a[240:243], 0
  buffer_load_dwordx2 v[4:5], v57, s[4:7], s56 offen sc1
  v_cvt_pk_bf16_f32 v48, v16, v17
  v_cvt_pk_bf16_f32 v49, v18, v19
  v_exp_f32 v23, v23
  v_exp_f32 v24, v24
  v_exp_f32 v25, v25
  v_exp_f32 v26, v26
  v_mfma_f32_32x32x16_bf16 v[32:47], v[180:183], a[244:247], v[32:47]
  s_xor_b32 s40, s46, 98304
  v_cvt_pk_bf16_f32 v50, v20, v21
  v_cvt_pk_bf16_f32 v51, v22, v23
  v_exp_f32 v27, v27
  v_exp_f32 v28, v28
  v_exp_f32 v29, v29
  v_exp_f32 v30, v30
  v_mfma_f32_32x32x16_bf16 v[80:95], v[184:187], v[48:51], v[80:95]
  buffer_load_dwordx4 v[160:163], v1, s[4:7], s40 offen sc1
  v_exp_f32 v31, v31
  v_cvt_pk_bf16_f32 v52, v24, v25
  v_cvt_pk_bf16_f32 v53, v26, v27
  v_cvt_pk_bf16_f32 v54, v28, v29
  v_cvt_pk_bf16_f32 v55, v30, v31
  v_exp_f32 v32, v32
  v_exp_f32 v33, v33
  v_exp_f32 v34, v34
  v_exp_f32 v35, v35
  v_mfma_f32_32x32x16_bf16 v[80:95], v[188:191], v[52:55], v[80:95]
  buffer_load_dwordx4 v[164:167], v1, s[4:7], s40 offen offset:1024 sc1
  v_exp_f32 v36, v36
  v_exp_f32 v37, v37
  v_exp_f32 v38, v38
  v_mfma_f32_32x32x16_bf16 v[16:31], v[176:179], a[248:251], 0
  buffer_load_dwordx4 v[168:171], v1, s[4:7], s40 offen offset:2048 sc1
  v_cvt_pk_bf16_f32 v48, v32, v33
  v_cvt_pk_bf16_f32 v49, v34, v35
  v_exp_f32 v39, v39
  v_exp_f32 v40, v40
  v_exp_f32 v41, v41
  v_exp_f32 v42, v42
  v_mfma_f32_32x32x16_bf16 v[16:31], v[180:183], a[252:255], v[16:31]
  buffer_load_dwordx4 v[172:175], v1, s[4:7], s40 offen offset:3072 sc1
  v_cvt_pk_bf16_f32 v50, v36, v37
  v_cvt_pk_bf16_f32 v51, v38, v39
  v_exp_f32 v43, v43
  v_exp_f32 v44, v44
  v_exp_f32 v45, v45
  v_exp_f32 v46, v46
  v_mfma_f32_32x32x16_bf16 v[96:111], v[184:187], v[48:51], v[96:111]
  buffer_load_dwordx4 v[200:203], v1, s[4:7], s32 offen offset:1024 sc1
  v_exp_f32 v47, v47
  v_cvt_pk_bf16_f32 v52, v40, v41
  v_cvt_pk_bf16_f32 v53, v42, v43
  v_cvt_pk_bf16_f32 v54, v44, v45
  v_cvt_pk_bf16_f32 v55, v46, v47
  v_exp_f32 v16, v16
  v_exp_f32 v17, v17
  v_exp_f32 v18, v18
  v_exp_f32 v19, v19
  v_mfma_f32_32x32x16_bf16 v[96:111], v[188:191], v[52:55], v[96:111]
  s_add_u32 m0, s44, 49152
  v_exp_f32 v20, v20
  v_exp_f32 v21, v21
  v_exp_f32 v22, v22
  v_mfma_f32_32x32x16_bf16 v[32:47], v[176:179], a[224:227], 0
  s_add_u32 s43, s42, 1146944
  v_cvt_pk_bf16_f32 v48, v16, v17
  v_cvt_pk_bf16_f32 v49, v18, v19
  v_exp_f32 v23, v23
  v_exp_f32 v24, v24
  v_exp_f32 v25, v25
  v_exp_f32 v26, v26
  v_mfma_f32_32x32x16_bf16 v[32:47], v[180:183], a[228:231], v[32:47]
  buffer_load_dwordx4 v58, s[60:63], s43 offen lds
  v_cvt_pk_bf16_f32 v50, v20, v21
  v_cvt_pk_bf16_f32 v51, v22, v23
  v_exp_f32 v27, v27
  v_exp_f32 v28, v28
  v_exp_f32 v29, v29
  v_exp_f32 v30, v30
  v_mfma_f32_32x32x16_bf16 v[112:127], v[184:187], v[48:51], v[112:127]
  buffer_load_dwordx4 v[204:207], v1, s[4:7], s33 offen offset:1024 sc1
  v_exp_f32 v31, v31
  v_cvt_pk_bf16_f32 v52, v24, v25
  v_cvt_pk_bf16_f32 v53, v26, v27
  v_cvt_pk_bf16_f32 v54, v28, v29
  v_cvt_pk_bf16_f32 v55, v30, v31
  v_exp_f32 v32, v32
  v_exp_f32 v33, v33
  v_exp_f32 v34, v34
  v_exp_f32 v35, v35
  v_mfma_f32_32x32x16_bf16 v[112:127], v[188:191], v[52:55], v[112:127]
  s_waitcnt vmcnt(14)
  v_exp_f32 v36, v36
  v_exp_f32 v37, v37
  v_exp_f32 v38, v38
  v_mfma_f32_32x32x16_bf16 v[16:31], v[128:131], a[232:235], 0
  s_add_u32 m0, s44, 24576
  v_cvt_pk_bf16_f32 v48, v32, v33
  v_cvt_pk_bf16_f32 v49, v34, v35
  v_exp_f32 v39, v39
  v_exp_f32 v40, v40
  v_exp_f32 v41, v41
  v_exp_f32 v42, v42
  v_mfma_f32_32x32x16_bf16 v[16:31], v[132:135], a[236:239], v[16:31]
  s_add_u32 s43, s42, 1376256
  v_cvt_pk_bf16_f32 v50, v36, v37
  v_cvt_pk_bf16_f32 v51, v38, v39
  v_exp_f32 v43, v43
  v_exp_f32 v44, v44
  v_exp_f32 v45, v45
  v_exp_f32 v46, v46
  v_mfma_f32_32x32x16_bf16 v[64:79], v[184:187], v[48:51], v[64:79]
  buffer_load_dwordx4 v58, s[60:63], s43 offen lds
  v_exp_f32 v47, v47
  v_cvt_pk_bf16_f32 v52, v40, v41
  v_cvt_pk_bf16_f32 v53, v42, v43
  v_cvt_pk_bf16_f32 v54, v44, v45
  v_cvt_pk_bf16_f32 v55, v46, v47
  v_exp_f32 v16, v16
  v_exp_f32 v17, v17
  v_exp_f32 v18, v18
  v_exp_f32 v19, v19
  v_mfma_f32_32x32x16_bf16 v[64:79], v[188:191], v[52:55], v[64:79]
  s_add_u32 m0, s44, 53248
  v_exp_f32 v20, v20
  v_exp_f32 v21, v21
  v_exp_f32 v22, v22
  v_mfma_f32_32x32x16_bf16 v[32:47], v[128:131], a[240:243], 0
  s_xor_b32 s40, s46, 114688
  v_cvt_pk_bf16_f32 v48, v16, v17
  v_cvt_pk_bf16_f32 v49, v18, v19
  v_exp_f32 v23, v23
  v_exp_f32 v24, v24
  v_exp_f32 v25, v25
  v_exp_f32 v26, v26
  v_mfma_f32_32x32x16_bf16 v[32:47], v[132:135], a[244:247], v[32:47]
  buffer_load_dwordx4 v[176:179], v1, s[4:7], s40 offen sc1
  v_cvt_pk_bf16_f32 v50, v20, v21
  v_cvt_pk_bf16_f32 v51, v22, v23
  v_exp_f32 v27, v27
  v_exp_f32 v28, v28
  v_exp_f32 v29, v29
  v_exp_f32 v30, v30
  v_mfma_f32_32x32x16_bf16 v[80:95], v[136:139], v[48:51], v[80:95]
  buffer_load_dwordx4 v[180:183], v1, s[4:7], s40 offen offset:1024 sc1
  v_exp_f32 v31, v31
  v_cvt_pk_bf16_f32 v52, v24, v25
  v_cvt_pk_bf16_f32 v53, v26, v27
  v_cvt_pk_bf16_f32 v54, v28, v29
  v_cvt_pk_bf16_f32 v55, v30, v31
  v_exp_f32 v32, v32
  v_exp_f32 v33, v33
  v_exp_f32 v34, v34
  v_exp_f32 v35, v35
  v_mfma_f32_32x32x16_bf16 v[80:95], v[140:143], v[52:55], v[80:95]
  buffer_load_dwordx4 v[184:187], v1, s[4:7], s40 offen offset:2048 sc1
  v_exp_f32 v36, v36
  v_exp_f32 v37, v37
  v_exp_f32 v38, v38
  v_mfma_f32_32x32x16_bf16 v[16:31], v[128:131], a[248:251], 0
  buffer_load_dwordx4 v[188:191], v1, s[4:7], s40 offen offset:3072 sc1
  v_cvt_pk_bf16_f32 v48, v32, v33
  v_cvt_pk_bf16_f32 v49, v34, v35
  v_exp_f32 v39, v39
  v_exp_f32 v40, v40
  v_exp_f32 v41, v41
  v_exp_f32 v42, v42
  v_mfma_f32_32x32x16_bf16 v[16:31], v[132:135], a[252:255], v[16:31]
  s_add_u32 s43, s42, 1376320
  v_cvt_pk_bf16_f32 v50, v36, v37
  v_cvt_pk_bf16_f32 v51, v38, v39
  v_exp_f32 v43, v43
  v_exp_f32 v44, v44
  v_exp_f32 v45, v45
  v_exp_f32 v46, v46
  v_mfma_f32_32x32x16_bf16 v[96:111], v[136:139], v[48:51], v[96:111]
  buffer_load_dwordx4 v58, s[60:63], s43 offen lds
  v_exp_f32 v47, v47
  v_cvt_pk_bf16_f32 v52, v40, v41
  v_cvt_pk_bf16_f32 v53, v42, v43
  v_cvt_pk_bf16_f32 v54, v44, v45
  v_cvt_pk_bf16_f32 v55, v46, v47
  v_exp_f32 v16, v16
  v_exp_f32 v17, v17
  v_exp_f32 v18, v18
  v_exp_f32 v19, v19
  v_mfma_f32_32x32x16_bf16 v[96:111], v[140:143], v[52:55], v[96:111]
  buffer_load_dwordx4 v[208:211], v1, s[4:7], s32 offen offset:2048 sc1
  v_exp_f32 v20, v20
  v_exp_f32 v21, v21
  v_exp_f32 v22, v22
  v_mfma_f32_32x32x16_bf16 v[32:47], v[128:131], a[224:227], 0
  s_add_u32 m0, s44, 57344
  v_cvt_pk_bf16_f32 v48, v16, v17
  v_cvt_pk_bf16_f32 v49, v18, v19
  v_exp_f32 v23, v23
  v_exp_f32 v24, v24
  v_exp_f32 v25, v25
  v_exp_f32 v26, v26
  v_mfma_f32_32x32x16_bf16 v[32:47], v[132:135], a[228:231], v[32:47]
  s_add_u32 s43, s42, 128
  v_cvt_pk_bf16_f32 v50, v20, v21
  v_cvt_pk_bf16_f32 v51, v22, v23
  v_exp_f32 v27, v27
  v_exp_f32 v28, v28
  v_exp_f32 v29, v29
  v_exp_f32 v30, v30
  v_mfma_f32_32x32x16_bf16 v[112:127], v[136:139], v[48:51], v[112:127]
  v_exp_f32 v31, v31
  v_cvt_pk_bf16_f32 v52, v24, v25
  v_cvt_pk_bf16_f32 v53, v26, v27
  v_cvt_pk_bf16_f32 v54, v28, v29
  v_cvt_pk_bf16_f32 v55, v30, v31
  v_exp_f32 v32, v32
  v_exp_f32 v33, v33
  v_exp_f32 v34, v34
  v_exp_f32 v35, v35
  v_mfma_f32_32x32x16_bf16 v[112:127], v[140:143], v[52:55], v[112:127]
  s_waitcnt vmcnt(17)
  v_exp_f32 v36, v36
  v_exp_f32 v37, v37
  v_exp_f32 v38, v38
  v_mfma_f32_32x32x16_bf16 v[16:31], v[144:147], a[232:235], 0
  buffer_load_dwordx4 v58, s[60:63], s43 offen lds
  v_cvt_pk_bf16_f32 v48, v32, v33
  v_cvt_pk_bf16_f32 v49, v34, v35
  v_exp_f32 v39, v39
  v_exp_f32 v40, v40
  v_exp_f32 v41, v41
  v_exp_f32 v42, v42
  v_mfma_f32_32x32x16_bf16 v[16:31], v[148:151], a[236:239], v[16:31]
  v_cvt_pk_bf16_f32 v50, v36, v37
  v_cvt_pk_bf16_f32 v51, v38, v39
  v_exp_f32 v43, v43
  v_exp_f32 v44, v44
  v_exp_f32 v45, v45
  v_exp_f32 v46, v46
  v_mfma_f32_32x32x16_bf16 v[64:79], v[136:139], v[48:51], v[64:79]
  v_exp_f32 v47, v47
  v_cvt_pk_bf16_f32 v52, v40, v41
  v_cvt_pk_bf16_f32 v53, v42, v43
  v_cvt_pk_bf16_f32 v54, v44, v45
  v_cvt_pk_bf16_f32 v55, v46, v47
  v_exp_f32 v16, v16
  v_exp_f32 v17, v17
  v_exp_f32 v18, v18
  v_exp_f32 v19, v19
  v_mfma_f32_32x32x16_bf16 v[64:79], v[140:143], v[52:55], v[64:79]
  v_exp_f32 v20, v20
  v_exp_f32 v21, v21
  v_exp_f32 v22, v22
  v_mfma_f32_32x32x16_bf16 v[32:47], v[144:147], a[240:243], 0
  s_waitcnt vmcnt(15)
  v_cmp_ne_u64 vcc, s[58:59], v[4:5]
  s_nop 0
  s_and_b32 s34, vcc_lo, 0xff00
  s_cbranch_scc1 mk_fs48
mk_fr49:
  v_cvt_pk_bf16_f32 v48, v16, v17
  v_cvt_pk_bf16_f32 v49, v18, v19
  v_exp_f32 v23, v23
  v_exp_f32 v24, v24
  v_exp_f32 v25, v25
  v_exp_f32 v26, v26
  v_mfma_f32_32x32x16_bf16 v[32:47], v[148:151], a[244:247], v[32:47]
  s_xor_b32 s40, s46, 131072
  v_cvt_pk_bf16_f32 v50, v20, v21
  v_cvt_pk_bf16_f32 v51, v22, v23
  v_exp_f32 v27, v27
  v_exp_f32 v28, v28
  v_exp_f32 v29, v29
  v_exp_f32 v30, v30
  v_mfma_f32_32x32x16_bf16 v[80:95], v[152:155], v[48:51], v[80:95]
  buffer_load_dwordx4 v[128:131], v1, s[4:7], s40 offen sc1
  v_exp_f32 v31, v31
  v_cvt_pk_bf16_f32 v52, v24, v25
  v_cvt_pk_bf16_f32 v53, v26, v27
  v_cvt_pk_bf16_f32 v54, v28, v29
  v_cvt_pk_bf16_f32 v55, v30, v31
  v_exp_f32 v32, v32
  v_exp_f32 v33, v33
  v_exp_f32 v34, v34
  v_exp_f32 v35, v35
  v_mfma_f32_32x32x16_bf16 v[80:95], v[156:159], v[52:55], v[80:95]
  buffer_load_dwordx4 v[132:135], v1, s[4:7], s40 offen offset:1024 sc1
  v_exp_f32 v36, v36
  v_exp_f32 v37, v37
  v_exp_f32 v38, v38
  v_mfma_f32_32x32x16_bf16 v[16:31], v[144:147], a[248:251], 0
  buffer_load_dwordx4 v[136:139], v1, s[4:7], s40 offen offset:2048 sc1
  v_cvt_pk_bf16_f32 v48, v32, v33
  v_cvt_pk_bf16_f32 v49, v34, v35
  v_exp_f32 v39, v39
  v_exp_f32 v40, v40
  v_exp_f32 v41, v41
  v_exp_f32 v42, v42
  v_mfma_f32_32x32x16_bf16 v[16:31], v[148:151], a[252:255], v[16:31]
  buffer_load_dwordx4 v[140:143], v1, s[4:7], s40 offen offset:3072 sc1
  v_cvt_pk_bf16_f32 v50, v36, v37
  v_cvt_pk_bf16_f32 v51, v38, v39
  v_exp_f32 v43, v43
  v_exp_f32 v44, v44
  v_exp_f32 v45, v45
  v_exp_f32 v46, v46
  v_mfma_f32_32x32x16_bf16 v[96:111], v[152:155], v[48:51], v[96:111]
  buffer_load_dwordx4 v[212:215], v1, s[4:7], s33 offen offset:2048 sc1
  v_exp_f32 v47, v47
  v_cvt_pk_bf16_f32 v52, v40, v41
  v_cvt_pk_bf16_f32 v53, v42, v43
  v_cvt_pk_bf16_f32 v54, v44, v45
  v_cvt_pk_bf16_f32 v55, v46, v47
  v_exp_f32 v16, v16
  v_exp_f32 v17, v17
  v_exp_f32 v18, v18
  v_exp_f32 v19, v19
  v_mfma_f32_32x32x16_bf16 v[96:111], v[156:159], v[52:55], v[96:111]
  s_add_u32 m0, s44, 86016
  v_exp_f32 v20, v20
  v_exp_f32 v21, v21
  v_exp_f32 v22, v22
  v_mfma_f32_32x32x16_bf16 v[32:47], v[144:147], a[224:227], 0
  s_add_u32 s43, s42, 192
  v_cvt_pk_bf16_f32 v48, v16, v17
  v_cvt_pk_bf16_f32 v49, v18, v19
  v_exp_f32 v23, v23
  v_exp_f32 v24, v24
  v_exp_f32 v25, v25
  v_exp_f32 v26, v26
  v_mfma_f32_32x32x16_bf16 v[32:47], v[148:151], a[228:231], v[32:47]
  buffer_load_dwordx4 v58, s[60:63], s43 offen lds
  v_cvt_pk_bf16_f32 v50, v20, v21
  v_cvt_pk_bf16_f32 v51, v22, v23
  v_exp_f32 v27, v27
  v_exp_f32 v28, v28
  v_exp_f32 v29, v29
  v_exp_f32 v30, v30
  v_mfma_f32_32x32x16_bf16 v[112:127], v[152:155], v[48:51], v[112:127]
  buffer_load_dwordx4 v[216:219], v1, s[4:7], s32 offen offset:3072 sc1
  v_exp_f32 v31, v31
  v_cvt_pk_bf16_f32 v52, v24, v25
  v_cvt_pk_bf16_f32 v53, v26, v27
  v_cvt_pk_bf16_f32 v54, v28, v29
  v_cvt_pk_bf16_f32 v55, v30, v31
  v_exp_f32 v32, v32
  v_exp_f32 v33, v33
  v_exp_f32 v34, v34
  v_exp_f32 v35, v35
  v_mfma_f32_32x32x16_bf16 v[112:127], v[156:159], v[52:55], v[112:127]
  s_waitcnt vmcnt(18)
  v_exp_f32 v36, v36
  v_exp_f32 v37, v37
  v_exp_f32 v38, v38
  v_mfma_f32_32x32x16_bf16 v[16:31], v[160:163], a[232:235], 0
  s_add_u32 m0, s44, 61440
  v_cvt_pk_bf16_f32 v48, v32, v33
  v_cvt_pk_bf16_f32 v49, v34, v35
  v_exp_f32 v39, v39
  v_exp_f32 v40, v40
  v_exp_f32 v41, v41
  v_exp_f32 v42, v42
  v_mfma_f32_32x32x16_bf16 v[16:31], v[164:167], a[236:239], v[16:31]
  s_add_u32 s43, s42, 229504
  v_cvt_pk_bf16_f32 v50, v36, v37
  v_cvt_pk_bf16_f32 v51, v38, v39
  v_exp_f32 v43, v43
  v_exp_f32 v44, v44
  v_exp_f32 v45, v45
  v_exp_f32 v46, v46
  v_mfma_f32_32x32x16_bf16 v[64:79], v[152:155], v[48:51], v[64:79]
  v_exp_f32 v47, v47
  v_cvt_pk_bf16_f32 v52, v40, v41
  v_cvt_pk_bf16_f32 v53, v42, v43
  v_cvt_pk_bf16_f32 v54, v44, v45
  v_cvt_pk_bf16_f32 v55, v46, v47
  v_exp_f32 v16, v16
  v_exp_f32 v17, v17
  v_exp_f32 v18, v18
  v_exp_f32 v19, v19
  v_mfma_f32_32x32x16_bf16 v[64:79], v[156:159], v[52:55], v[64:79]
  v_exp_f32 v20, v20
  v_exp_f32 v21, v21
  v_exp_f32 v22, v22
  v_mfma_f32_32x32x16_bf16 v[32:47], v[160:163], a[240:243], 0
  s_xor_b32 s40, s46, 147456
  v_cvt_pk_bf16_f32 v48, v16, v17
  v_cvt_pk_bf16_f32 v49, v18, v19
  v_exp_f32 v23, v23
  v_exp_f32 v24, v24
  v_exp_f32 v25, v25
  v_exp_f32 v26, v26
  v_mfma_f32_32x32x16_bf16 v[32:47], v[164:167], a[244:247], v[32:47]
  buffer_load_dwordx4 v[144:147], v1, s[4:7], s40 offen sc1
  v_cvt_pk_bf16_f32 v50, v20, v21
  v_cvt_pk_bf16_f32 v51, v22, v23
  v_exp_f32 v27, v27
  v_exp_f32 v28, v28
  v_exp_f32 v29, v29
  v_exp_f32 v30, v30
  v_mfma_f32_32x32x16_bf16 v[80:95], v[168:171], v[48:51], v[80:95]
  buffer_load_dwordx4 v[148:151], v1, s[4:7], s40 offen offset:1024 sc1
  v_exp_f32 v31, v31
  v_cvt_pk_bf16_f32 v52, v24, v25
  v_cvt_pk_bf16_f32 v53, v26, v27
  v_cvt_pk_bf16_f32 v54, v28, v29
  v_cvt_pk_bf16_f32 v55, v30, v31
  v_exp_f32 v32, v32
  v_exp_f32 v33, v33
  v_exp_f32 v34, v34
  v_exp_f32 v35, v35
  v_mfma_f32_32x32x16_bf16 v[80:95], v[172:175], v[52:55], v[80:95]
  buffer_load_dwordx4 v[152:155], v1, s[4:7], s40 offen offset:2048 sc1
  v_exp_f32 v36, v36
  v_exp_f32 v37, v37
  v_exp_f32 v38, v38
  v_mfma_f32_32x32x16_bf16 v[16:31], v[160:163], a[248:251], 0
  buffer_load_dwordx4 v[156:159], v1, s[4:7], s40 offen offset:3072 sc1
  v_cvt_pk_bf16_f32 v48, v32, v33
  v_cvt_pk_bf16_f32 v49, v34, v35
  v_exp_f32 v39, v39
  v_exp_f32 v40, v40
  v_exp_f32 v41, v41
  v_exp_f32 v42, v42
  v_mfma_f32_32x32x16_bf16 v[16:31], v[164:167], a[252:255], v[16:31]
  buffer_load_dwordx4 v58, s[60:63], s43 offen lds
  v_cvt_pk_bf16_f32 v50, v36, v37
  v_cvt_pk_bf16_f32 v51, v38, v39
  v_exp_f32 v43, v43
  v_exp_f32 v44, v44
  v_exp_f32 v45, v45
  v_exp_f32 v46, v46
  v_mfma_f32_32x32x16_bf16 v[96:111], v[168:171], v[48:51], v[96:111]
  buffer_load_dwordx4 v[220:223], v1, s[4:7], s33 offen offset:3072 sc1
  v_exp_f32 v47, v47
  v_cvt_pk_bf16_f32 v52, v40, v41
  v_cvt_pk_bf16_f32 v53, v42, v43
  v_cvt_pk_bf16_f32 v54, v44, v45
  v_cvt_pk_bf16_f32 v55, v46, v47
  v_exp_f32 v16, v16
  v_exp_f32 v17, v17
  v_exp_f32 v18, v18
  v_exp_f32 v19, v19
  v_mfma_f32_32x32x16_bf16 v[96:111], v[172:175], v[52:55], v[96:111]
  s_add_u32 m0, s44, 90112
  v_exp_f32 v20, v20
  v_exp_f32 v21, v21
  v_exp_f32 v22, v22
  v_mfma_f32_32x32x16_bf16 v[32:47], v[160:163], a[224:227], 0
  s_add_u32 s43, s42, 229568
  v_cvt_pk_bf16_f32 v48, v16, v17
  v_cvt_pk_bf16_f32 v49, v18, v19
  v_exp_f32 v23, v23
  v_exp_f32 v24, v24
  v_exp_f32 v25, v25
  v_exp_f32 v26, v26
  v_mfma_f32_32x32x16_bf16 v[32:47], v[164:167], a[228:231], v[32:47]
  buffer_load_dwordx4 v58, s[60:63], s43 offen lds
  v_cvt_pk_bf16_f32 v50, v20, v21
  v_cvt_pk_bf16_f32 v51, v22, v23
  v_exp_f32 v27, v27
  v_exp_f32 v28, v28
  v_exp_f32 v29, v29
  v_exp_f32 v30, v30
  v_mfma_f32_32x32x16_bf16 v[112:127], v[168:171], v[48:51], v[112:127]
  v_exp_f32 v31, v31
  v_cvt_pk_bf16_f32 v52, v24, v25
  v_cvt_pk_bf16_f32 v53, v26, v27
  v_cvt_pk_bf16_f32 v54, v28, v29
  v_cvt_pk_bf16_f32 v55, v30, v31
  v_exp_f32 v32, v32
  v_exp_f32 v33, v33
  v_exp_f32 v34, v34
  v_exp_f32 v35, v35
  v_mfma_f32_32x32x16_bf16 v[112:127], v[172:175], v[52:55], v[112:127]
  s_waitcnt vmcnt(17)
  v_exp_f32 v36, v36
  v_exp_f32 v37, v37
  v_exp_f32 v38, v38
  v_mfma_f32_32x32x16_bf16 v[16:31], v[176:179], a[232:235], 0
  s_add_u32 m0, s44, 65536
  v_cvt_pk_bf16_f32 v48, v32, v33
  v_cvt_pk_bf16_f32 v49, v34, v35
  v_exp_f32 v39, v39
  v_exp_f32 v40, v40
  v_exp_f32 v41, v41
  v_exp_f32 v42, v42
  v_mfma_f32_32x32x16_bf16 v[16:31], v[180:183], a[236:239], v[16:31]
  v_cvt_pk_bf16_f32 v50, v36, v37
  v_cvt_pk_bf16_f32 v51, v38, v39
  v_exp_f32 v43, v43
  v_exp_f32 v44, v44
  v_exp_f32 v45, v45
  v_exp_f32 v46, v46
  v_mfma_f32_32x32x16_bf16 v[64:79], v[168:171], v[48:51], v[64:79]
  v_exp_f32 v47, v47
  v_cvt_pk_bf16_f32 v52, v40, v41
  v_cvt_pk_bf16_f32 v53, v42, v43
  v_cvt_pk_bf16_f32 v54, v44, v45
  v_cvt_pk_bf16_f32 v55, v46, v47
  v_exp_f32 v16, v16
  v_exp_f32 v17, v17
  v_exp_f32 v18, v18
  v_exp_f32 v19, v19
  v_mfma_f32_32x32x16_bf16 v[64:79], v[172:175], v[52:55], v[64:79]
  v_exp_f32 v20, v20
  v_exp_f32 v21, v21
  v_exp_f32 v22, v22
  v_mfma_f32_32x32x16_bf16 v[32:47], v[176:179], a[240:243], 0
  s_xor_b32 s40, s46, 163840
  v_cvt_pk_bf16_f32 v48, v16, v17
  v_cvt_pk_bf16_f32 v49, v18, v19
  v_exp_f32 v23, v23
  v_exp_f32 v24, v24
  v_exp_f32 v25, v25
  v_exp_f32 v26, v26
  v_mfma_f32_32x32x16_bf16 v[32:47], v[180:183], a[244:247], v[32:47]
  buffer_load_dwordx4 v[160:163], v1, s[4:7], s40 offen sc1
  v_cvt_pk_bf16_f32 v50, v20, v21
  v_cvt_pk_bf16_f32 v51, v22, v23
  v_exp_f32 v27, v27
  v_exp_f32 v28, v28
  v_exp_f32 v29, v29
  v_exp_f32 v30, v30
  v_mfma_f32_32x32x16_bf16 v[80:95], v[184:187], v[48:51], v[80:95]
  buffer_load_dwordx4 v[164:167], v1, s[4:7], s40 offen offset:1024 sc1
  v_exp_f32 v31, v31
  v_cvt_pk_bf16_f32 v52, v24, v25
  v_cvt_pk_bf16_f32 v53, v26, v27
  v_cvt_pk_bf16_f32 v54, v28, v29
  v_cvt_pk_bf16_f32 v55, v30, v31
  v_exp_f32 v32, v32
  v_exp_f32 v33, v33
  v_exp_f32 v34, v34
  v_exp_f32 v35, v35
  v_mfma_f32_32x32x16_bf16 v[80:95], v[188:191], v[52:55], v[80:95]
  buffer_load_dwordx4 v[168:171], v1, s[4:7], s40 offen offset:2048 sc1
  v_exp_f32 v36, v36
  v_exp_f32 v37, v37
  v_exp_f32 v38, v38
  v_mfma_f32_32x32x16_bf16 v[16:31], v[176:179], a[248:251], 0
  buffer_load_dwordx4 v[172:175], v1, s[4:7], s40 offen offset:3072 sc1
  v_cvt_pk_bf16_f32 v48, v32, v33
  v_cvt_pk_bf16_f32 v49, v34, v35
  v_exp_f32 v39, v39
  v_exp_f32 v40, v40
  v_exp_f32 v41, v41
  v_exp_f32 v42, v42
  v_mfma_f32_32x32x16_bf16 v[16:31], v[180:183], a[252:255], v[16:31]
  s_add_u32 s43, s42, 458880
  v_cvt_pk_bf16_f32 v50, v36, v37
  v_cvt_pk_bf16_f32 v51, v38, v39
  v_exp_f32 v43, v43
  v_exp_f32 v44, v44
  v_exp_f32 v45, v45
  v_exp_f32 v46, v46
  v_mfma_f32_32x32x16_bf16 v[96:111], v[184:187], v[48:51], v[96:111]
  buffer_load_dwordx4 v58, s[60:63], s43 offen lds
  v_exp_f32 v47, v47
  v_cvt_pk_bf16_f32 v52, v40, v41
  v_cvt_pk_bf16_f32 v53, v42, v43
  v_cvt_pk_bf16_f32 v54, v44, v45
  v_cvt_pk_bf16_f32 v55, v46, v47
  v_exp_f32 v16, v16
  v_exp_f32 v17, v17
  v_exp_f32 v18, v18
  v_exp_f32 v19, v19
  v_mfma_f32_32x32x16_bf16 v[96:111], v[188:191], v[52:55], v[96:111]
  s_add_u32 s32, s32, 4096
  v_exp_f32 v20, v20
  v_exp_f32 v21, v21
  v_exp_f32 v22, v22
  v_mfma_f32_32x32x16_bf16 v[32:47], v[176:179], a[224:227], 0
  buffer_load_dwordx4 v[224:227], v1, s[4:7], s32 offen sc1
  v_cvt_pk_bf16_f32 v48, v16, v17
  v_cvt_pk_bf16_f32 v49, v18, v19
  v_exp_f32 v23, v23
  v_exp_f32 v24, v24
  v_exp_f32 v25, v25
  v_exp_f32 v26, v26
  v_mfma_f32_32x32x16_bf16 v[32:47], v[180:183], a[228:231], v[32:47]
  s_add_u32 m0, s44, 94208
  v_cvt_pk_bf16_f32 v50, v20, v21
  v_cvt_pk_bf16_f32 v51, v22, v23
  v_exp_f32 v27, v27
  v_exp_f32 v28, v28
  v_exp_f32 v29, v29
  v_exp_f32 v30, v30
  v_mfma_f32_32x32x16_bf16 v[112:127], v[184:187], v[48:51], v[112:127]
  v_exp_f32 v31, v31
  v_cvt_pk_bf16_f32 v52, v24, v25
  v_cvt_pk_bf16_f32 v53, v26, v27
  v_cvt_pk_bf16_f32 v54, v28, v29
  v_cvt_pk_bf16_f32 v55, v30, v31
  v_exp_f32 v32, v32
  v_exp_f32 v33, v33
  v_exp_f32 v34, v34
  v_exp_f32 v35, v35
  v_mfma_f32_32x32x16_bf16 v[112:127], v[188:191], v[52:55], v[112:127]
  s_waitcnt vmcnt(16)
  v_exp_f32 v36, v36
  v_exp_f32 v37, v37
  v_exp_f32 v38, v38
  v_mfma_f32_32x32x16_bf16 v[16:31], v[128:131], a[232:235], 0
  s_add_u32 s43, s42, 458944
  v_cvt_pk_bf16_f32 v48, v32, v33
  v_cvt_pk_bf16_f32 v49, v34, v35
  v_exp_f32 v39, v39
  v_exp_f32 v40, v40
  v_exp_f32 v41, v41
  v_exp_f32 v42, v42
  v_mfma_f32_32x32x16_bf16 v[16:31], v[132:135], a[236:239], v[16:31]
  buffer_load_dwordx4 v58, s[60:63], s43 offen lds
  v_cvt_pk_bf16_f32 v50, v36, v37
  v_cvt_pk_bf16_f32 v51, v38, v39
  v_exp_f32 v43, v43
  v_exp_f32 v44, v44
  v_exp_f32 v45, v45
  v_exp_f32 v46, v46
  v_mfma_f32_32x32x16_bf16 v[64:79], v[184:187], v[48:51], v[64:79]
  v_exp_f32 v47, v47
  v_cvt_pk_bf16_f32 v52, v40, v41
  v_cvt_pk_bf16_f32 v53, v42, v43
  v_cvt_pk_bf16_f32 v54, v44, v45
  v_cvt_pk_bf16_f32 v55, v46, v47
  v_exp_f32 v16, v16
  v_exp_f32 v17, v17
  v_exp_f32 v18, v18
  v_exp_f32 v19, v19
  v_mfma_f32_32x32x16_bf16 v[64:79], v[188:191], v[52:55], v[64:79]
  v_exp_f32 v20, v20
  v_exp_f32 v21, v21
  v_exp_f32 v22, v22
  v_mfma_f32_32x32x16_bf16 v[32:47], v[128:131], a[240:243], 0
  s_xor_b32 s40, s46, 180224
  v_cvt_pk_bf16_f32 v48, v16, v17
  v_cvt_pk_bf16_f32 v49, v18, v19
  v_exp_f32 v23, v23
  v_exp_f32 v24, v24
  v_exp_f32 v25, v25
  v_exp_f32 v26, v26
  v_mfma_f32_32x32x16_bf16 v[32:47], v[132:135], a[244:247], v[32:47]
  buffer_load_dwordx4 v[176:179], v1, s[4:7], s40 offen sc1
  v_cvt_pk_bf16_f32 v50, v20, v21
  v_cvt_pk_bf16_f32 v51, v22, v23
  v_exp_f32 v27, v27
  v_exp_f32 v28, v28
  v_exp_f32 v29, v29
  v_exp_f32 v30, v30
  v_mfma_f32_32x32x16_bf16 v[80:95], v[136:139], v[48:51], v[80:95]
  buffer_load_dwordx4 v[180:183], v1, s[4:7], s40 offen offset:1024 sc1
  v_exp_f32 v31, v31
  v_cvt_pk_bf16_f32 v52, v24, v25
  v_cvt_pk_bf16_f32 v53, v26, v27
  v_cvt_pk_bf16_f32 v54, v28, v29
  v_cvt_pk_bf16_f32 v55, v30, v31
  v_exp_f32 v32, v32
  v_exp_f32 v33, v33
  v_exp_f32 v34, v34
  v_exp_f32 v35, v35
  v_mfma_f32_32x32x16_bf16 v[80:95], v[140:143], v[52:55], v[80:95]
  buffer_load_dwordx4 v[184:187], v1, s[4:7], s40 offen offset:2048 sc1
  v_exp_f32 v36, v36
  v_exp_f32 v37, v37
  v_exp_f32 v38, v38
  v_mfma_f32_32x32x16_bf16 v[16:31], v[128:131], a[248:251], 0
  buffer_load_dwordx4 v[188:191], v1, s[4:7], s40 offen offset:3072 sc1
  v_cvt_pk_bf16_f32 v48, v32, v33
  v_cvt_pk_bf16_f32 v49, v34, v35
  v_exp_f32 v39, v39
  v_exp_f32 v40, v40
  v_exp_f32 v41, v41
  v_exp_f32 v42, v42
  v_mfma_f32_32x32x16_bf16 v[16:31], v[132:135], a[252:255], v[16:31]
  s_add_u32 s33, s33, 4096
  v_cvt_pk_bf16_f32 v50, v36, v37
  v_cvt_pk_bf16_f32 v51, v38, v39
  v_exp_f32 v43, v43
  v_exp_f32 v44, v44
  v_exp_f32 v45, v45
  v_exp_f32 v46, v46
  v_mfma_f32_32x32x16_bf16 v[96:111], v[136:139], v[48:51], v[96:111]
  buffer_load_dwordx4 v[228:231], v1, s[4:7], s33 offen sc1
  v_exp_f32 v47, v47
  v_cvt_pk_bf16_f32 v52, v40, v41
  v_cvt_pk_bf16_f32 v53, v42, v43
  v_cvt_pk_bf16_f32 v54, v44, v45
  v_cvt_pk_bf16_f32 v55, v46, v47
  v_exp_f32 v16, v16
  v_exp_f32 v17, v17
  v_exp_f32 v18, v18
  v_exp_f32 v19, v19
  v_mfma_f32_32x32x16_bf16 v[96:111], v[140:143], v[52:55], v[96:111]
  s_add_u32 m0, s44, 69632
  v_exp_f32 v20, v20
  v_exp_f32 v21, v21
  v_exp_f32 v22, v22
  v_mfma_f32_32x32x16_bf16 v[32:47], v[128:131], a[224:227], 0
  s_add_u32 s43, s42, 688256
  v_cvt_pk_bf16_f32 v48, v16, v17
  v_cvt_pk_bf16_f32 v49, v18, v19
  v_exp_f32 v23, v23
  v_exp_f32 v24, v24
  v_exp_f32 v25, v25
  v_exp_f32 v26, v26
  v_mfma_f32_32x32x16_bf16 v[32:47], v[132:135], a[228:231], v[32:47]
  buffer_load_dwordx4 v58, s[60:63], s43 offen lds
  v_cvt_pk_bf16_f32 v50, v20, v21
  v_cvt_pk_bf16_f32 v51, v22, v23
  v_exp_f32 v27, v27
  v_exp_f32 v28, v28
  v_exp_f32 v29, v29
  v_exp_f32 v30, v30
  v_mfma_f32_32x32x16_bf16 v[112:127], v[136:139], v[48:51], v[112:127]
  v_exp_f32 v31, v31
  v_cvt_pk_bf16_f32 v52, v24, v25
  v_cvt_pk_bf16_f32 v53, v26, v27
  v_cvt_pk_bf16_f32 v54, v28, v29
  v_cvt_pk_bf16_f32 v55, v30, v31
  v_exp_f32 v32, v32
  v_exp_f32 v33, v33
  v_exp_f32 v34, v34
  v_exp_f32 v35, v35
  v_mfma_f32_32x32x16_bf16 v[112:127], v[140:143], v[52:55], v[112:127]
  s_waitcnt vmcnt(16)
  v_exp_f32 v36, v36
  v_exp_f32 v37, v37
  v_exp_f32 v38, v38
  v_mfma_f32_32x32x16_bf16 v[16:31], v[144:147], a[232:235], 0
  buffer_load_dwordx4 v[232:235], v1, s[4:7], s32 offen offset:1024 sc1
  v_cvt_pk_bf16_f32 v48, v32, v33
  v_cvt_pk_bf16_f32 v49, v34, v35
  v_exp_f32 v39, v39
  v_exp_f32 v40, v40
  v_exp_f32 v41, v41
  v_exp_f32 v42, v42
  v_mfma_f32_32x32x16_bf16 v[16:31], v[148:151], a[236:239], v[16:31]
  v_cvt_pk_bf16_f32 v50, v36, v37
  v_cvt_pk_bf16_f32 v51, v38, v39
  v_exp_f32 v43, v43
  v_exp_f32 v44, v44
  v_exp_f32 v45, v45
  v_exp_f32 v46, v46
  v_mfma_f32_32x32x16_bf16 v[64:79], v[136:139], v[48:51], v[64:79]
  v_exp_f32 v47, v47
  v_cvt_pk_bf16_f32 v52, v40, v41
  v_cvt_pk_bf16_f32 v53, v42, v43
  v_cvt_pk_bf16_f32 v54, v44, v45
  v_cvt_pk_bf16_f32 v55, v46, v47
  v_exp_f32 v16, v16
  v_exp_f32 v17, v17
  v_exp_f32 v18, v18
  v_exp_f32 v19, v19
  v_mfma_f32_32x32x16_bf16 v[64:79], v[140:143], v[52:55], v[64:79]
  v_exp_f32 v20, v20
  v_exp_f32 v21, v21
  v_exp_f32 v22, v22
  v_mfma_f32_32x32x16_bf16 v[32:47], v[144:147], a[240:243], 0
  s_xor_b32 s40, s46, 196608
  v_cvt_pk_bf16_f32 v48, v16, v17
  v_cvt_pk_bf16_f32 v49, v18, v19
  v_exp_f32 v23, v23
  v_exp_f32 v24, v24
  v_exp_f32 v25, v25
  v_exp_f32 v26, v26
  v_mfma_f32_32x32x16_bf16 v[32:47], v[148:151], a[244:247], v[32:47]
  buffer_load_dwordx4 v[128:131], v1, s[4:7], s40 offen sc1
  v_cvt_pk_bf16_f32 v50, v20, v21
  v_cvt_pk_bf16_f32 v51, v22, v23
  v_exp_f32 v27, v27
  v_exp_f32 v28, v28
  v_exp_f32 v29, v29
  v_exp_f32 v30, v30
  v_mfma_f32_32x32x16_bf16 v[80:95], v[152:155], v[48:51], v[80:95]
  buffer_load_dwordx4 v[132:135], v1, s[4:7], s40 offen offset:1024 sc1
  v_exp_f32 v31, v31
  v_cvt_pk_bf16_f32 v52, v24, v25
  v_cvt_pk_bf16_f32 v53, v26, v27
  v_cvt_pk_bf16_f32 v54, v28, v29
  v_cvt_pk_bf16_f32 v55, v30, v31
  v_exp_f32 v32, v32
  v_exp_f32 v33, v33
  v_exp_f32 v34, v34
  v_exp_f32 v35, v35
  v_mfma_f32_32x32x16_bf16 v[80:95], v[156:159], v[52:55], v[80:95]
  buffer_load_dwordx4 v[136:139], v1, s[4:7], s40 offen offset:2048 sc1
  v_exp_f32 v36, v36
  v_exp_f32 v37, v37
  v_exp_f32 v38, v38
  v_mfma_f32_32x32x16_bf16 v[16:31], v[144:147], a[248:251], 0
  buffer_load_dwordx4 v[140:143], v1, s[4:7], s40 offen offset:3072 sc1
  v_cvt_pk_bf16_f32 v48, v32, v33
  v_cvt_pk_bf16_f32 v49, v34, v35
  v_exp_f32 v39, v39
  v_exp_f32 v40, v40
  v_exp_f32 v41, v41
  v_exp_f32 v42, v42
  v_mfma_f32_32x32x16_bf16 v[16:31], v[148:151], a[252:255], v[16:31]
  s_add_u32 m0, s44, 98304
  v_cvt_pk_bf16_f32 v50, v36, v37
  v_cvt_pk_bf16_f32 v51, v38, v39
  v_exp_f32 v43, v43
  v_exp_f32 v44, v44
  v_exp_f32 v45, v45
  v_exp_f32 v46, v46
  v_mfma_f32_32x32x16_bf16 v[96:111], v[152:155], v[48:51], v[96:111]
  s_add_u32 s43, s42, 688320
  v_exp_f32 v47, v47
  v_cvt_pk_bf16_f32 v52, v40, v41
  v_cvt_pk_bf16_f32 v53, v42, v43
  v_cvt_pk_bf16_f32 v54, v44, v45
  v_cvt_pk_bf16_f32 v55, v46, v47
  v_exp_f32 v16, v16
  v_exp_f32 v17, v17
  v_exp_f32 v18, v18
  v_exp_f32 v19, v19
  v_mfma_f32_32x32x16_bf16 v[96:111], v[156:159], v[52:55], v[96:111]
  buffer_load_dwordx4 v58, s[60:63], s43 offen lds
  v_exp_f32 v20, v20
  v_exp_f32 v21, v21
  v_exp_f32 v22, v22
  v_mfma_f32_32x32x16_bf16 v[32:47], v[144:147], a[224:227], 0
  buffer_load_dwordx4 v[236:239], v1, s[4:7], s33 offen offset:1024 sc1
  v_cvt_pk_bf16_f32 v48, v16, v17
  v_cvt_pk_bf16_f32 v49, v18, v19
  v_exp_f32 v23, v23
  v_exp_f32 v24, v24
  v_exp_f32 v25, v25
  v_exp_f32 v26, v26
  v_mfma_f32_32x32x16_bf16 v[32:47], v[148:151], a[228:231], v[32:47]
  s_add_u32 m0, s44, 73728
  v_cvt_pk_bf16_f32 v50, v20, v21
  v_cvt_pk_bf16_f32 v51, v22, v23
  v_exp_f32 v27, v27
  v_exp_f32 v28, v28
  v_exp_f32 v29, v29
  v_exp_f32 v30, v30
  v_mfma_f32_32x32x16_bf16 v[112:127], v[152:155], v[48:51], v[112:127]
  v_exp_f32 v31, v31
  v_cvt_pk_bf16_f32 v52, v24, v25
  v_cvt_pk_bf16_f32 v53, v26, v27
  v_cvt_pk_bf16_f32 v54, v28, v29
  v_cvt_pk_bf16_f32 v55, v30, v31
  v_exp_f32 v32, v32
  v_exp_f32 v33, v33
  v_exp_f32 v34, v34
  v_exp_f32 v35, v35
  v_mfma_f32_32x32x16_bf16 v[112:127], v[156:159], v[52:55], v[112:127]
  s_waitcnt vmcnt(16)
  v_exp_f32 v36, v36
  v_exp_f32 v37, v37
  v_exp_f32 v38, v38
  v_mfma_f32_32x32x16_bf16 v[16:31], v[160:163], a[232:235], 0
  s_add_u32 s43, s42, 917632
  v_cvt_pk_bf16_f32 v48, v32, v33
  v_cvt_pk_bf16_f32 v49, v34, v35
  v_exp_f32 v39, v39
  v_exp_f32 v40, v40
  v_exp_f32 v41, v41
  v_exp_f32 v42, v42
  v_mfma_f32_32x32x16_bf16 v[16:31], v[164:167], a[236:239], v[16:31]
  buffer_load_dwordx4 v58, s[60:63], s43 offen lds
  v_cvt_pk_bf16_f32 v50, v36, v37
  v_cvt_pk_bf16_f32 v51, v38, v39
  v_exp_f32 v43, v43
  v_exp_f32 v44, v44
  v_exp_f32 v45, v45
  v_exp_f32 v46, v46
  v_mfma_f32_32x32x16_bf16 v[64:79], v[152:155], v[48:51], v[64:79]
  v_exp_f32 v47, v47
  v_cvt_pk_bf16_f32 v52, v40, v41
  v_cvt_pk_bf16_f32 v53, v42, v43
  v_cvt_pk_bf16_f32 v54, v44, v45
  v_cvt_pk_bf16_f32 v55, v46, v47
  v_exp_f32 v16, v16
  v_exp_f32 v17, v17
  v_exp_f32 v18, v18
  v_exp_f32 v19, v19
  v_mfma_f32_32x32x16_bf16 v[64:79], v[156:159], v[52:55], v[64:79]
  v_exp_f32 v20, v20
  v_exp_f32 v21, v21
  v_exp_f32 v22, v22
  v_mfma_f32_32x32x16_bf16 v[32:47], v[160:163], a[240:243], 0
  s_xor_b32 s40, s46, 212992
  v_cvt_pk_bf16_f32 v48, v16, v17
  v_cvt_pk_bf16_f32 v49, v18, v19
  v_exp_f32 v23, v23
  v_exp_f32 v24, v24
  v_exp_f32 v25, v25
  v_exp_f32 v26, v26
  v_mfma_f32_32x32x16_bf16 v[32:47], v[164:167], a[244:247], v[32:47]
  buffer_load_dwordx4 v[144:147], v1, s[4:7], s40 offen sc1
  v_cvt_pk_bf16_f32 v50, v20, v21
  v_cvt_pk_bf16_f32 v51, v22, v23
  v_exp_f32 v27, v27
  v_exp_f32 v28, v28
  v_exp_f32 v29, v29
  v_exp_f32 v30, v30
  v_mfma_f32_32x32x16_bf16 v[80:95], v[168:171], v[48:51], v[80:95]
  buffer_load_dwordx4 v[148:151], v1, s[4:7], s40 offen offset:1024 sc1
  v_exp_f32 v31, v31
  v_cvt_pk_bf16_f32 v52, v24, v25
  v_cvt_pk_bf16_f32 v53, v26, v27
  v_cvt_pk_bf16_f32 v54, v28, v29
  v_cvt_pk_bf16_f32 v55, v30, v31
  v_exp_f32 v32, v32
  v_exp_f32 v33, v33
  v_exp_f32 v34, v34
  v_exp_f32 v35, v35
  v_mfma_f32_32x32x16_bf16 v[80:95], v[172:175], v[52:55], v[80:95]
  buffer_load_dwordx4 v[152:155], v1, s[4:7], s40 offen offset:2048 sc1
  v_exp_f32 v36, v36
  v_exp_f32 v37, v37
  v_exp_f32 v38, v38
  v_mfma_f32_32x32x16_bf16 v[16:31], v[160:163], a[248:251], 0
  buffer_load_dwordx4 v[156:159], v1, s[4:7], s40 offen offset:3072 sc1
  v_cvt_pk_bf16_f32 v48, v32, v33
  v_cvt_pk_bf16_f32 v49, v34, v35
  v_exp_f32 v39, v39
  v_exp_f32 v40, v40
  v_exp_f32 v41, v41
  v_exp_f32 v42, v42
  v_mfma_f32_32x32x16_bf16 v[16:31], v[164:167], a[252:255], v[16:31]
  s_add_u32 m0, s44, 102400
  v_cvt_pk_bf16_f32 v50, v36, v37
  v_cvt_pk_bf16_f32 v51, v38, v39
  v_exp_f32 v43, v43
  v_exp_f32 v44, v44
  v_exp_f32 v45, v45
  v_exp_f32 v46, v46
  v_mfma_f32_32x32x16_bf16 v[96:111], v[168:171], v[48:51], v[96:111]
  s_add_u32 s43, s42, 917696
  v_exp_f32 v47, v47
  v_cvt_pk_bf16_f32 v52, v40, v41
  v_cvt_pk_bf16_f32 v53, v42, v43
  v_cvt_pk_bf16_f32 v54, v44, v45
  v_cvt_pk_bf16_f32 v55, v46, v47
  v_exp_f32 v16, v16
  v_exp_f32 v17, v17
  v_exp_f32 v18, v18
  v_exp_f32 v19, v19
  v_mfma_f32_32x32x16_bf16 v[96:111], v[172:175], v[52:55], v[96:111]
  buffer_load_dwordx4 v58, s[60:63], s43 offen lds
  v_exp_f32 v20, v20
  v_exp_f32 v21, v21
  v_exp_f32 v22, v22
  v_mfma_f32_32x32x16_bf16 v[32:47], v[160:163], a[224:227], 0
  buffer_load_dwordx4 v[240:243], v1, s[4:7], s32 offen offset:2048 sc1
  v_cvt_pk_bf16_f32 v48, v16, v17
  v_cvt_pk_bf16_f32 v49, v18, v19
  v_exp_f32 v23, v23
  v_exp_f32 v24, v24
  v_exp_f32 v25, v25
  v_exp_f32 v26, v26
  v_mfma_f32_32x32x16_bf16 v[32:47], v[164:167], a[228:231], v[32:47]
  s_add_u32 m0, s44, 77824
  v_cvt_pk_bf16_f32 v50, v20, v21
  v_cvt_pk_bf16_f32 v51, v22, v23
  v_exp_f32 v27, v27
  v_exp_f32 v28, v28
  v_exp_f32 v29, v29
  v_exp_f32 v30, v30
  v_mfma_f32_32x32x16_bf16 v[112:127], v[168:171], v[48:51], v[112:127]
  v_exp_f32 v31, v31
  v_cvt_pk_bf16_f32 v52, v24, v25
  v_cvt_pk_bf16_f32 v53, v26, v27
  v_cvt_pk_bf16_f32 v54, v28, v29
  v_cvt_pk_bf16_f32 v55, v30, v31
  v_exp_f32 v32, v32
  v_exp_f32 v33, v33
  v_exp_f32 v34, v34
  v_exp_f32 v35, v35
  v_mfma_f32_32x32x16_bf16 v[112:127], v[172:175], v[52:55], v[112:127]
  s_waitcnt vmcnt(16)
  v_exp_f32 v36, v36
  v_exp_f32 v37, v37
  v_exp_f32 v38, v38
  v_mfma_f32_32x32x16_bf16 v[16:31], v[176:179], a[232:235], 0
  s_add_u32 s43, s42, 1147008
  v_cvt_pk_bf16_f32 v48, v32, v33
  v_cvt_pk_bf16_f32 v49, v34, v35
  v_exp_f32 v39, v39
  v_exp_f32 v40, v40
  v_exp_f32 v41, v41
  v_exp_f32 v42, v42
  v_mfma_f32_32x32x16_bf16 v[16:31], v[180:183], a[236:239], v[16:31]
  v_cvt_pk_bf16_f32 v50, v36, v37
  v_cvt_pk_bf16_f32 v51, v38, v39
  v_exp_f32 v43, v43
  v_exp_f32 v44, v44
  v_exp_f32 v45, v45
  v_exp_f32 v46, v46
  v_mfma_f32_32x32x16_bf16 v[64:79], v[168:171], v[48:51], v[64:79]
  v_exp_f32 v47, v47
  v_cvt_pk_bf16_f32 v52, v40, v41
  v_cvt_pk_bf16_f32 v53, v42, v43
  v_cvt_pk_bf16_f32 v54, v44, v45
  v_cvt_pk_bf16_f32 v55, v46, v47
  v_exp_f32 v16, v16
  v_exp_f32 v17, v17
  v_exp_f32 v18, v18
  v_exp_f32 v19, v19
  v_mfma_f32_32x32x16_bf16 v[64:79], v[172:175], v[52:55], v[64:79]
  v_exp_f32 v20, v20
  v_exp_f32 v21, v21
  v_exp_f32 v22, v22
  v_mfma_f32_32x32x16_bf16 v[32:47], v[176:179], a[240:243], 0
  s_xor_b32 s40, s46, 229376
  v_cvt_pk_bf16_f32 v48, v16, v17
  v_cvt_pk_bf16_f32 v49, v18, v19
  v_exp_f32 v23, v23
  v_exp_f32 v24, v24
  v_exp_f32 v25, v25
  v_exp_f32 v26, v26
  v_mfma_f32_32x32x16_bf16 v[32:47], v[180:183], a[244:247], v[32:47]
  buffer_load_dwordx4 v[160:163], v1, s[4:7], s40 offen sc1
  v_cvt_pk_bf16_f32 v50, v20, v21
  v_cvt_pk_bf16_f32 v51, v22, v23
  v_exp_f32 v27, v27
  v_exp_f32 v28, v28
  v_exp_f32 v29, v29
  v_exp_f32 v30, v30
  v_mfma_f32_32x32x16_bf16 v[80:95], v[184:187], v[48:51], v[80:95]
  buffer_load_dwordx4 v[164:167], v1, s[4:7], s40 offen offset:1024 sc1
  v_exp_f32 v31, v31
  v_cvt_pk_bf16_f32 v52, v24, v25
  v_cvt_pk_bf16_f32 v53, v26, v27
  v_cvt_pk_bf16_f32 v54, v28, v29
  v_cvt_pk_bf16_f32 v55, v30, v31
  v_exp_f32 v32, v32
  v_exp_f32 v33, v33
  v_exp_f32 v34, v34
  v_exp_f32 v35, v35
  v_mfma_f32_32x32x16_bf16 v[80:95], v[188:191], v[52:55], v[80:95]
  buffer_load_dwordx4 v[168:171], v1, s[4:7], s40 offen offset:2048 sc1
  v_exp_f32 v36, v36
  v_exp_f32 v37, v37
  v_exp_f32 v38, v38
  v_mfma_f32_32x32x16_bf16 v[16:31], v[176:179], a[248:251], 0
  buffer_load_dwordx4 v[172:175], v1, s[4:7], s40 offen offset:3072 sc1
  v_cvt_pk_bf16_f32 v48, v32, v33
  v_cvt_pk_bf16_f32 v49, v34, v35
  v_exp_f32 v39, v39
  v_exp_f32 v40, v40
  v_exp_f32 v41, v41
  v_exp_f32 v42, v42
  v_mfma_f32_32x32x16_bf16 v[16:31], v[180:183], a[252:255], v[16:31]
  buffer_load_dwordx4 v58, s[60:63], s43 offen lds
  v_cvt_pk_bf16_f32 v50, v36, v37
  v_cvt_pk_bf16_f32 v51, v38, v39
  v_exp_f32 v43, v43
  v_exp_f32 v44, v44
  v_exp_f32 v45, v45
  v_exp_f32 v46, v46
  v_mfma_f32_32x32x16_bf16 v[96:111], v[184:187], v[48:51], v[96:111]
  buffer_load_dwordx4 v[244:247], v1, s[4:7], s33 offen offset:2048 sc1
  v_exp_f32 v47, v47
  v_cvt_pk_bf16_f32 v52, v40, v41
  v_cvt_pk_bf16_f32 v53, v42, v43
  v_cvt_pk_bf16_f32 v54, v44, v45
  v_cvt_pk_bf16_f32 v55, v46, v47
  v_exp_f32 v16, v16
  v_exp_f32 v17, v17
  v_exp_f32 v18, v18
  v_exp_f32 v19, v19
  v_mfma_f32_32x32x16_bf16 v[96:111], v[188:191], v[52:55], v[96:111]
  s_add_u32 m0, s44, 106496
  v_exp_f32 v20, v20
  v_exp_f32 v21, v21
  v_exp_f32 v22, v22
  v_mfma_f32_32x32x16_bf16 v[32:47], v[176:179], a[224:227], 0
  s_add_u32 s43, s42, 1147072
  v_cvt_pk_bf16_f32 v48, v16, v17
  v_cvt_pk_bf16_f32 v49, v18, v19
  v_exp_f32 v23, v23
  v_exp_f32 v24, v24
  v_exp_f32 v25, v25
  v_exp_f32 v26, v26
  v_mfma_f32_32x32x16_bf16 v[32:47], v[180:183], a[228:231], v[32:47]
  buffer_load_dwordx4 v58, s[60:63], s43 offen lds
  v_cvt_pk_bf16_f32 v50, v20, v21
  v_cvt_pk_bf16_f32 v51, v22, v23
  v_exp_f32 v27, v27
  v_exp_f32 v28, v28
  v_exp_f32 v29, v29
  v_exp_f32 v30, v30
  v_mfma_f32_32x32x16_bf16 v[112:127], v[184:187], v[48:51], v[112:127]
  v_exp_f32 v31, v31
  v_cvt_pk_bf16_f32 v52, v24, v25
  v_cvt_pk_bf16_f32 v53, v26, v27
  v_cvt_pk_bf16_f32 v54, v28, v29
  v_cvt_pk_bf16_f32 v55, v30, v31
  v_exp_f32 v32, v32
  v_exp_f32 v33, v33
  v_exp_f32 v34, v34
  v_exp_f32 v35, v35
  v_mfma_f32_32x32x16_bf16 v[112:127], v[188:191], v[52:55], v[112:127]
  s_waitcnt vmcnt(16)
  v_exp_f32 v36, v36
  v_exp_f32 v37, v37
  v_exp_f32 v38, v38
  v_mfma_f32_32x32x16_bf16 v[16:31], v[128:131], a[232:235], 0
  buffer_load_dwordx4 v[248:251], v1, s[4:7], s32 offen offset:3072 sc1
  v_cvt_pk_bf16_f32 v48, v32, v33
  v_cvt_pk_bf16_f32 v49, v34, v35
  v_exp_f32 v39, v39
  v_exp_f32 v40, v40
  v_exp_f32 v41, v41
  v_exp_f32 v42, v42
  v_mfma_f32_32x32x16_bf16 v[16:31], v[132:135], a[236:239], v[16:31]
  s_add_u32 m0, s44, 81920
  v_cvt_pk_bf16_f32 v50, v36, v37
  v_cvt_pk_bf16_f32 v51, v38, v39
  v_exp_f32 v43, v43
  v_exp_f32 v44, v44
  v_exp_f32 v45, v45
  v_exp_f32 v46, v46
  v_mfma_f32_32x32x16_bf16 v[64:79], v[184:187], v[48:51], v[64:79]
  v_exp_f32 v47, v47
  v_cvt_pk_bf16_f32 v52, v40, v41
  v_cvt_pk_bf16_f32 v53, v42, v43
  v_cvt_pk_bf16_f32 v54, v44, v45
  v_cvt_pk_bf16_f32 v55, v46, v47
  v_exp_f32 v16, v16
  v_exp_f32 v17, v17
  v_exp_f32 v18, v18
  v_exp_f32 v19, v19
  v_mfma_f32_32x32x16_bf16 v[64:79], v[188:191], v[52:55], v[64:79]
  v_exp_f32 v20, v20
  v_exp_f32 v21, v21
  v_exp_f32 v22, v22
  v_mfma_f32_32x32x16_bf16 v[32:47], v[128:131], a[240:243], 0
  s_xor_b32 s40, s46, 245760
  v_cvt_pk_bf16_f32 v48, v16, v17
  v_cvt_pk_bf16_f32 v49, v18, v19
  v_exp_f32 v23, v23
  v_exp_f32 v24, v24
  v_exp_f32 v25, v25
  v_exp_f32 v26, v26
  v_mfma_f32_32x32x16_bf16 v[32:47], v[132:135], a[244:247], v[32:47]
  buffer_load_dwordx4 v[176:179], v1, s[4:7], s40 offen sc1
  v_cvt_pk_bf16_f32 v50, v20, v21
  v_cvt_pk_bf16_f32 v51, v22, v23
  v_exp_f32 v27, v27
  v_exp_f32 v28, v28
  v_exp_f32 v29, v29
  v_exp_f32 v30, v30
  v_mfma_f32_32x32x16_bf16 v[80:95], v[136:139], v[48:51], v[80:95]
  buffer_load_dwordx4 v[180:183], v1, s[4:7], s40 offen offset:1024 sc1
  v_exp_f32 v31, v31
  v_cvt_pk_bf16_f32 v52, v24, v25
  v_cvt_pk_bf16_f32 v53, v26, v27
  v_cvt_pk_bf16_f32 v54, v28, v29
  v_cvt_pk_bf16_f32 v55, v30, v31
  v_exp_f32 v32, v32
  v_exp_f32 v33, v33
  v_exp_f32 v34, v34
  v_exp_f32 v35, v35
  v_mfma_f32_32x32x16_bf16 v[80:95], v[140:143], v[52:55], v[80:95]
  buffer_load_dwordx4 v[184:187], v1, s[4:7], s40 offen offset:2048 sc1
  v_exp_f32 v36, v36
  v_exp_f32 v37, v37
  v_exp_f32 v38, v38
  v_mfma_f32_32x32x16_bf16 v[16:31], v[128:131], a[248:251], 0
  buffer_load_dwordx4 v[188:191], v1, s[4:7], s40 offen offset:3072 sc1
  v_cvt_pk_bf16_f32 v48, v32, v33
  v_cvt_pk_bf16_f32 v49, v34, v35
  v_exp_f32 v39, v39
  v_exp_f32 v40, v40
  v_exp_f32 v41, v41
  v_exp_f32 v42, v42
  v_mfma_f32_32x32x16_bf16 v[16:31], v[132:135], a[252:255], v[16:31]
  s_add_u32 s43, s42, 1376384
  v_cvt_pk_bf16_f32 v50, v36, v37
  v_cvt_pk_bf16_f32 v51, v38, v39
  v_exp_f32 v43, v43
  v_exp_f32 v44, v44
  v_exp_f32 v45, v45
  v_exp_f32 v46, v46
  v_mfma_f32_32x32x16_bf16 v[96:111], v[136:139], v[48:51], v[96:111]
  buffer_load_dwordx4 v58, s[60:63], s43 offen lds
  v_exp_f32 v47, v47
  v_cvt_pk_bf16_f32 v52, v40, v41
  v_cvt_pk_bf16_f32 v53, v42, v43
  v_cvt_pk_bf16_f32 v54, v44, v45
  v_cvt_pk_bf16_f32 v55, v46, v47
  v_exp_f32 v16, v16
  v_exp_f32 v17, v17
  v_exp_f32 v18, v18
  v_exp_f32 v19, v19
  v_mfma_f32_32x32x16_bf16 v[96:111], v[140:143], v[52:55], v[96:111]
  buffer_load_dwordx4 v[252:255], v1, s[4:7], s33 offen offset:3072 sc1
  v_exp_f32 v20, v20
  v_exp_f32 v21, v21
  v_exp_f32 v22, v22
  v_mfma_f32_32x32x16_bf16 v[32:47], v[128:131], a[224:227], 0
  s_add_u32 m0, s44, 110592
  v_cvt_pk_bf16_f32 v48, v16, v17
  v_cvt_pk_bf16_f32 v49, v18, v19
  v_exp_f32 v23, v23
  v_exp_f32 v24, v24
  v_exp_f32 v25, v25
  v_exp_f32 v26, v26
  v_mfma_f32_32x32x16_bf16 v[32:47], v[132:135], a[228:231], v[32:47]
  s_add_u32 s43, s42, 1376448
  v_cvt_pk_bf16_f32 v50, v20, v21
  v_cvt_pk_bf16_f32 v51, v22, v23
  v_exp_f32 v27, v27
  v_exp_f32 v28, v28
  v_exp_f32 v29, v29
  v_exp_f32 v30, v30
  v_mfma_f32_32x32x16_bf16 v[112:127], v[136:139], v[48:51], v[112:127]
  v_exp_f32 v31, v31
  v_cvt_pk_bf16_f32 v52, v24, v25
  v_cvt_pk_bf16_f32 v53, v26, v27
  v_cvt_pk_bf16_f32 v54, v28, v29
  v_cvt_pk_bf16_f32 v55, v30, v31
  v_exp_f32 v32, v32
  v_exp_f32 v33, v33
  v_exp_f32 v34, v34
  v_exp_f32 v35, v35
  v_mfma_f32_32x32x16_bf16 v[112:127], v[140:143], v[52:55], v[112:127]
  s_waitcnt vmcnt(16)
  v_exp_f32 v36, v36
  v_exp_f32 v37, v37
  v_exp_f32 v38, v38
  v_mfma_f32_32x32x16_bf16 v[16:31], v[144:147], a[232:235], 0
  buffer_load_dwordx4 v58, s[60:63], s43 offen lds
  v_cvt_pk_bf16_f32 v48, v32, v33
  v_cvt_pk_bf16_f32 v49, v34, v35
  v_exp_f32 v39, v39
  v_exp_f32 v40, v40
  v_exp_f32 v41, v41
  v_exp_f32 v42, v42
  v_mfma_f32_32x32x16_bf16 v[16:31], v[148:151], a[236:239], v[16:31]
  v_cvt_pk_bf16_f32 v50, v36, v37
  v_cvt_pk_bf16_f32 v51, v38, v39
  v_exp_f32 v43, v43
  v_exp_f32 v44, v44
  v_exp_f32 v45, v45
  v_exp_f32 v46, v46
  v_mfma_f32_32x32x16_bf16 v[64:79], v[136:139], v[48:51], v[64:79]
  v_exp_f32 v47, v47
  v_cvt_pk_bf16_f32 v52, v40, v41
  v_cvt_pk_bf16_f32 v53, v42, v43
  v_cvt_pk_bf16_f32 v54, v44, v45
  v_cvt_pk_bf16_f32 v55, v46, v47
  v_exp_f32 v16, v16
  v_exp_f32 v17, v17
  v_exp_f32 v18, v18
  v_exp_f32 v19, v19
  v_mfma_f32_32x32x16_bf16 v[64:79], v[140:143], v[52:55], v[64:79]
  v_exp_f32 v20, v20
  v_exp_f32 v21, v21
  v_exp_f32 v22, v22
  v_mfma_f32_32x32x16_bf16 v[32:47], v[144:147], a[240:243], 0
  buffer_load_dword v57, v59, s[4:7], s54 offen sc1
  v_cvt_pk_bf16_f32 v48, v16, v17
  v_cvt_pk_bf16_f32 v49, v18, v19
  v_exp_f32 v23, v23
  v_exp_f32 v24, v24
  v_exp_f32 v25, v25
  v_exp_f32 v26, v26
  v_mfma_f32_32x32x16_bf16 v[32:47], v[148:151], a[244:247], v[32:47]
  buffer_load_dword v59, v59, s[4:7], s55 offen sc1
  v_cvt_pk_bf16_f32 v50, v20, v21
  v_cvt_pk_bf16_f32 v51, v22, v23
  v_exp_f32 v27, v27
  v_exp_f32 v28, v28
  v_exp_f32 v29, v29
  v_exp_f32 v30, v30
  v_mfma_f32_32x32x16_bf16 v[80:95], v[152:155], v[48:51], v[80:95]
  v_exp_f32 v31, v31
  v_cvt_pk_bf16_f32 v52, v24, v25
  v_cvt_pk_bf16_f32 v53, v26, v27
  v_cvt_pk_bf16_f32 v54, v28, v29
  v_cvt_pk_bf16_f32 v55, v30, v31
  v_exp_f32 v32, v32
  v_exp_f32 v33, v33
  v_exp_f32 v34, v34
  v_exp_f32 v35, v35
  v_mfma_f32_32x32x16_bf16 v[80:95], v[156:159], v[52:55], v[80:95]
  v_exp_f32 v36, v36
  v_exp_f32 v37, v37
  v_exp_f32 v38, v38
  v_mfma_f32_32x32x16_bf16 v[16:31], v[144:147], a[248:251], 0
  v_cvt_pk_bf16_f32 v48, v32, v33
  v_cvt_pk_bf16_f32 v49, v34, v35
  v_exp_f32 v39, v39
  v_exp_f32 v40, v40
  v_exp_f32 v41, v41
  v_exp_f32 v42, v42
  v_mfma_f32_32x32x16_bf16 v[16:31], v[148:151], a[252:255], v[16:31]
  v_cvt_pk_bf16_f32 v50, v36, v37
  v_cvt_pk_bf16_f32 v51, v38, v39
  v_exp_f32 v43, v43
  v_exp_f32 v44, v44
  v_exp_f32 v45, v45
  v_exp_f32 v46, v46
  v_mfma_f32_32x32x16_bf16 v[96:111], v[152:155], v[48:51], v[96:111]
  v_exp_f32 v47, v47
  v_cvt_pk_bf16_f32 v52, v40, v41
  v_cvt_pk_bf16_f32 v53, v42, v43
  v_cvt_pk_bf16_f32 v54, v44, v45
  v_cvt_pk_bf16_f32 v55, v46, v47
  v_exp_f32 v16, v16
  v_exp_f32 v17, v17
  v_exp_f32 v18, v18
  v_exp_f32 v19, v19
  v_mfma_f32_32x32x16_bf16 v[96:111], v[156:159], v[52:55], v[96:111]
  v_exp_f32 v20, v20
  v_exp_f32 v21, v21
  v_exp_f32 v22, v22
  v_mfma_f32_32x32x16_bf16 v[32:47], v[144:147], a[224:227], 0
  v_cvt_pk_bf16_f32 v48, v16, v17
  v_cvt_pk_bf16_f32 v49, v18, v19
  v_exp_f32 v23, v23
  v_exp_f32 v24, v24
  v_exp_f32 v25, v25
  v_exp_f32 v26, v26
  v_mfma_f32_32x32x16_bf16 v[32:47], v[148:151], a[228:231], v[32:47]
  v_cvt_pk_bf16_f32 v50, v20, v21
  v_cvt_pk_bf16_f32 v51, v22, v23
  v_exp_f32 v27, v27
  v_exp_f32 v28, v28
  v_exp_f32 v29, v29
  v_exp_f32 v30, v30
  v_mfma_f32_32x32x16_bf16 v[112:127], v[152:155], v[48:51], v[112:127]
  v_exp_f32 v31, v31
  v_cvt_pk_bf16_f32 v52, v24, v25
  v_cvt_pk_bf16_f32 v53, v26, v27
  v_cvt_pk_bf16_f32 v54, v28, v29
  v_cvt_pk_bf16_f32 v55, v30, v31
  v_exp_f32 v32, v32
  v_exp_f32 v33, v33
  v_exp_f32 v34, v34
  v_exp_f32 v35, v35
  v_mfma_f32_32x32x16_bf16 v[112:127], v[156:159], v[52:55], v[112:127]
  s_waitcnt vmcnt(13)
  v_exp_f32 v36, v36
  v_exp_f32 v37, v37
  v_exp_f32 v38, v38
  v_mfma_f32_32x32x16_bf16 v[16:31], v[160:163], a[232:235], 0
  v_cvt_pk_bf16_f32 v48, v32, v33
  v_cvt_pk_bf16_f32 v49, v34, v35
  v_exp_f32 v39, v39
  v_exp_f32 v40, v40
  v_exp_f32 v41, v41
  v_exp_f32 v42, v42
  v_mfma_f32_32x32x16_bf16 v[16:31], v[164:167], a[236:239], v[16:31]
  v_cvt_pk_bf16_f32 v50, v36, v37
  v_cvt_pk_bf16_f32 v51, v38, v39
  v_exp_f32 v43, v43
  v_exp_f32 v44, v44
  v_exp_f32 v45, v45
  v_exp_f32 v46, v46
  v_mfma_f32_32x32x16_bf16 v[64:79], v[152:155], v[48:51], v[64:79]
  v_exp_f32 v47, v47
  v_cvt_pk_bf16_f32 v52, v40, v41
  v_cvt_pk_bf16_f32 v53, v42, v43
  v_cvt_pk_bf16_f32 v54, v44, v45
  v_cvt_pk_bf16_f32 v55, v46, v47
  v_exp_f32 v16, v16
  v_exp_f32 v17, v17
  v_exp_f32 v18, v18
  v_exp_f32 v19, v19
  v_mfma_f32_32x32x16_bf16 v[64:79], v[156:159], v[52:55], v[64:79]
  s_waitcnt vmcnt(5)
  v_exp_f32 v20, v20
  v_exp_f32 v21, v21
  v_exp_f32 v22, v22
  v_mfma_f32_32x32x16_bf16 v[32:47], v[176:179], a[232:235], 0
  v_cvt_pk_bf16_f32 v48, v16, v17
  v_cvt_pk_bf16_f32 v49, v18, v19
  v_exp_f32 v23, v23
  v_exp_f32 v24, v24
  v_exp_f32 v25, v25
  v_exp_f32 v26, v26
  v_mfma_f32_32x32x16_bf16 v[32:47], v[180:183], a[236:239], v[32:47]
  v_cvt_pk_bf16_f32 v50, v20, v21
  v_cvt_pk_bf16_f32 v51, v22, v23
  v_exp_f32 v27, v27
  v_exp_f32 v28, v28
  v_exp_f32 v29, v29
  v_exp_f32 v30, v30
  v_mfma_f32_32x32x16_bf16 v[80:95], v[168:171], v[48:51], v[80:95]
  v_exp_f32 v31, v31
  v_cvt_pk_bf16_f32 v52, v24, v25
  v_cvt_pk_bf16_f32 v53, v26, v27
  v_cvt_pk_bf16_f32 v54, v28, v29
  v_cvt_pk_bf16_f32 v55, v30, v31
  v_exp_f32 v32, v32
  v_exp_f32 v33, v33
  v_exp_f32 v34, v34
  v_exp_f32 v35, v35
  v_mfma_f32_32x32x16_bf16 v[80:95], v[172:175], v[52:55], v[80:95]
  v_exp_f32 v36, v36
  v_exp_f32 v37, v37
  v_exp_f32 v38, v38
  v_mfma_f32_32x32x16_bf16 v[16:31], v[160:163], a[240:243], 0
  v_cvt_pk_bf16_f32 v48, v32, v33
  v_cvt_pk_bf16_f32 v49, v34, v35
  v_exp_f32 v39, v39
  v_exp_f32 v40, v40
  v_exp_f32 v41, v41
  v_exp_f32 v42, v42
  v_mfma_f32_32x32x16_bf16 v[16:31], v[164:167], a[244:247], v[16:31]
  v_cvt_pk_bf16_f32 v50, v36, v37
  v_cvt_pk_bf16_f32 v51, v38, v39
  v_exp_f32 v43, v43
  v_exp_f32 v44, v44
  v_exp_f32 v45, v45
  v_exp_f32 v46, v46
  v_mfma_f32_32x32x16_bf16 v[80:95], v[184:187], v[48:51], v[80:95]
  v_exp_f32 v47, v47
  v_cvt_pk_bf16_f32 v52, v40, v41
  v_cvt_pk_bf16_f32 v53, v42, v43
  v_cvt_pk_bf16_f32 v54, v44, v45
  v_cvt_pk_bf16_f32 v55, v46, v47
  v_exp_f32 v16, v16
  v_exp_f32 v17, v17
  v_exp_f32 v18, v18
  v_exp_f32 v19, v19
  v_mfma_f32_32x32x16_bf16 v[80:95], v[188:191], v[52:55], v[80:95]
  v_exp_f32 v20, v20
  v_exp_f32 v21, v21
  v_exp_f32 v22, v22
  v_mfma_f32_32x32x16_bf16 v[32:47], v[176:179], a[240:243], 0
  v_cvt_pk_bf16_f32 v48, v16, v17
  v_cvt_pk_bf16_f32 v49, v18, v19
  v_exp_f32 v23, v23
  v_exp_f32 v24, v24
  v_exp_f32 v25, v25
  v_exp_f32 v26, v26
  v_mfma_f32_32x32x16_bf16 v[32:47], v[180:183], a[244:247], v[32:47]
  s_nop 0
  ds_write_b128 v60, v[80:83] offset:0
  v_cvt_pk_bf16_f32 v50, v20, v21
  v_cvt_pk_bf16_f32 v51, v22, v23
  v_exp_f32 v27, v27
  v_exp_f32 v28, v28
  v_exp_f32 v29, v29
  v_exp_f32 v30, v30
  v_mfma_f32_32x32x16_bf16 v[96:111], v[168:171], v[48:51], v[96:111]
  ds_write_b128 v60, v[84:87] offset:1024
  v_exp_f32 v31, v31
  v_cvt_pk_bf16_f32 v52, v24, v25
  v_cvt_pk_bf16_f32 v53, v26, v27
  v_cvt_pk_bf16_f32 v54, v28, v29
  v_cvt_pk_bf16_f32 v55, v30, v31
  v_exp_f32 v32, v32
  v_exp_f32 v33, v33
  v_exp_f32 v34, v34
  v_exp_f32 v35, v35
  v_mfma_f32_32x32x16_bf16 v[96:111], v[172:175], v[52:55], v[96:111]
  ds_write_b128 v60, v[88:91] offset:2048
  v_exp_f32 v36, v36
  v_exp_f32 v37, v37
  v_exp_f32 v38, v38
  v_mfma_f32_32x32x16_bf16 v[16:31], v[160:163], a[248:251], 0
  ds_write_b128 v60, v[92:95] offset:3072
  v_cvt_pk_bf16_f32 v48, v32, v33
  v_cvt_pk_bf16_f32 v49, v34, v35
  v_exp_f32 v39, v39
  v_exp_f32 v40, v40
  v_exp_f32 v41, v41
  v_exp_f32 v42, v42
  v_mfma_f32_32x32x16_bf16 v[16:31], v[164:167], a[252:255], v[16:31]
  v_cvt_pk_bf16_f32 v50, v36, v37
  v_cvt_pk_bf16_f32 v51, v38, v39
  v_exp_f32 v43, v43
  v_exp_f32 v44, v44
  v_exp_f32 v45, v45
  v_exp_f32 v46, v46
  v_mfma_f32_32x32x16_bf16 v[96:111], v[184:187], v[48:51], v[96:111]
  v_exp_f32 v47, v47
  v_cvt_pk_bf16_f32 v52, v40, v41
  v_cvt_pk_bf16_f32 v53, v42, v43
  v_cvt_pk_bf16_f32 v54, v44, v45
  v_cvt_pk_bf16_f32 v55, v46, v47
  v_exp_f32 v16, v16
  v_exp_f32 v17, v17
  v_exp_f32 v18, v18
  v_exp_f32 v19, v19
  v_mfma_f32_32x32x16_bf16 v[96:111], v[188:191], v[52:55], v[96:111]
  v_exp_f32 v20, v20
  v_exp_f32 v21, v21
  v_exp_f32 v22, v22
  v_mfma_f32_32x32x16_bf16 v[32:47], v[176:179], a[248:251], 0
  v_cvt_pk_bf16_f32 v48, v16, v17
  v_cvt_pk_bf16_f32 v49, v18, v19
  v_exp_f32 v23, v23
  v_exp_f32 v24, v24
  v_exp_f32 v25, v25
  v_exp_f32 v26, v26
  v_mfma_f32_32x32x16_bf16 v[32:47], v[180:183], a[252:255], v[32:47]
  s_nop 0
  ds_write_b128 v61, v[96:99] offset:0
  v_cvt_pk_bf16_f32 v50, v20, v21
  v_cvt_pk_bf16_f32 v51, v22, v23
  v_exp_f32 v27, v27
  v_exp_f32 v28, v28
  v_exp_f32 v29, v29
  v_exp_f32 v30, v30
  v_mfma_f32_32x32x16_bf16 v[112:127], v[168:171], v[48:51], v[112:127]
  ds_write_b128 v61, v[100:103] offset:1024
  v_exp_f32 v31, v31
  v_cvt_pk_bf16_f32 v52, v24, v25
  v_cvt_pk_bf16_f32 v53, v26, v27
  v_cvt_pk_bf16_f32 v54, v28, v29
  v_cvt_pk_bf16_f32 v55, v30, v31
  v_exp_f32 v32, v32
  v_exp_f32 v33, v33
  v_exp_f32 v34, v34
  v_exp_f32 v35, v35
  v_mfma_f32_32x32x16_bf16 v[112:127], v[172:175], v[52:55], v[112:127]
  ds_write_b128 v61, v[104:107] offset:2048
  v_exp_f32 v36, v36
  v_exp_f32 v37, v37
  v_exp_f32 v38, v38
  v_mfma_f32_32x32x16_bf16 v[16:31], v[160:163], a[224:227], 0
  ds_write_b128 v61, v[108:111] offset:3072
  v_cvt_pk_bf16_f32 v48, v32, v33
  v_cvt_pk_bf16_f32 v49, v34, v35
  v_exp_f32 v39, v39
  v_exp_f32 v40, v40
  v_exp_f32 v41, v41
  v_exp_f32 v42, v42
  v_mfma_f32_32x32x16_bf16 v[16:31], v[164:167], a[228:231], v[16:31]
  v_cvt_pk_bf16_f32 v50, v36, v37
  v_cvt_pk_bf16_f32 v51, v38, v39
  v_exp_f32 v43, v43
  v_exp_f32 v44, v44
  v_exp_f32 v45, v45
  v_exp_f32 v46, v46
  v_mfma_f32_32x32x16_bf16 v[112:127], v[184:187], v[48:51], v[112:127]
  v_exp_f32 v47, v47
  v_cvt_pk_bf16_f32 v52, v40, v41
  v_cvt_pk_bf16_f32 v53, v42, v43
  v_cvt_pk_bf16_f32 v54, v44, v45
  v_cvt_pk_bf16_f32 v55, v46, v47
  v_exp_f32 v16, v16
  v_exp_f32 v17, v17
  v_exp_f32 v18, v18
  v_exp_f32 v19, v19
  v_mfma_f32_32x32x16_bf16 v[112:127], v[188:191], v[52:55], v[112:127]
  v_exp_f32 v20, v20
  v_exp_f32 v21, v21
  v_exp_f32 v22, v22
  v_mfma_f32_32x32x16_bf16 v[32:47], v[176:179], a[224:227], 0
  v_cvt_pk_bf16_f32 v48, v16, v17
  v_cvt_pk_bf16_f32 v49, v18, v19
  v_exp_f32 v23, v23
  v_exp_f32 v24, v24
  v_exp_f32 v25, v25
  v_exp_f32 v26, v26
  v_mfma_f32_32x32x16_bf16 v[32:47], v[180:183], a[228:231], v[32:47]
  s_nop 0
  ds_write_b128 v62, v[112:115] offset:0
  ds_write_b128 v62, v[116:119] offset:1024
  v_cvt_pk_bf16_f32 v50, v20, v21
  v_cvt_pk_bf16_f32 v51, v22, v23
  v_exp_f32 v27, v27
  v_exp_f32 v28, v28
  v_exp_f32 v29, v29
  v_exp_f32 v30, v30
  v_mfma_f32_32x32x16_bf16 v[64:79], v[168:171], v[48:51], v[64:79]
  ds_write_b128 v62, v[120:123] offset:2048
  ds_write_b128 v62, v[124:127] offset:3072
  v_exp_f32 v31, v31
  v_cvt_pk_bf16_f32 v52, v24, v25
  v_cvt_pk_bf16_f32 v53, v26, v27
  v_cvt_pk_bf16_f32 v54, v28, v29
  v_cvt_pk_bf16_f32 v55, v30, v31
  v_exp_f32 v32, v32
  v_exp_f32 v33, v33
  v_exp_f32 v34, v34
  v_exp_f32 v35, v35
  v_mfma_f32_32x32x16_bf16 v[64:79], v[172:175], v[52:55], v[64:79]
  v_exp_f32 v36, v36
  v_exp_f32 v37, v37
  v_exp_f32 v38, v38
  s_waitcnt lgkmcnt(0)
  s_barrier
  ds_read_b128 v[128:131], v63 offset:0
  ds_read_b128 v[132:135], v63 offset:1024
  ds_read_b128 v[136:139], v63 offset:2048
  ds_read_b128 v[140:143], v63 offset:3072
  ds_read_b128 v[144:147], v63 offset:4096
  ds_read_b128 v[148:151], v63 offset:5120
  ds_read_b128 v[152:155], v63 offset:6144
  ds_read_b128 v[156:159], v63 offset:7168
  ds_read_b128 v[80:83], v63 offset:8192
  ds_read_b128 v[84:87], v63 offset:9216
  ds_read_b128 v[88:91], v63 offset:10240
  ds_read_b128 v[92:95], v63 offset:11264
  v_cvt_pk_bf16_f32 v48, v32, v33
  v_cvt_pk_bf16_f32 v49, v34, v35
  v_exp_f32 v39, v39
  v_exp_f32 v40, v40
  v_exp_f32 v41, v41
  v_exp_f32 v42, v42
  v_cvt_pk_bf16_f32 v50, v36, v37
  v_cvt_pk_bf16_f32 v51, v38, v39
  v_exp_f32 v43, v43
  v_exp_f32 v44, v44
  v_exp_f32 v45, v45
  v_exp_f32 v46, v46
  v_mfma_f32_32x32x16_bf16 v[64:79], v[184:187], v[48:51], v[64:79]
  v_exp_f32 v47, v47
  v_cvt_pk_bf16_f32 v52, v40, v41
  v_cvt_pk_bf16_f32 v53, v42, v43
  v_cvt_pk_bf16_f32 v54, v44, v45
  v_cvt_pk_bf16_f32 v55, v46, v47
  s_nop 1
  v_mfma_f32_32x32x16_bf16 v[64:79], v[188:191], v[52:55], v[64:79]
  v_mov_b32 v20, 0x1f8
  v_mov_b32 v18, 0x21800000
  v_mov_b32 v19, 0x71800000
  s_waitcnt lgkmcnt(0)
  v_pk_add_f32 v[128:129], v[128:129], v[144:145]
  v_pk_add_f32 v[130:131], v[130:131], v[146:147]
  v_pk_add_f32 v[132:133], v[132:133], v[148:149]
  v_pk_add_f32 v[134:135], v[134:135], v[150:151]
  v_pk_add_f32 v[136:137], v[136:137], v[152:153]
  v_pk_add_f32 v[138:139], v[138:139], v[154:155]
  v_pk_add_f32 v[140:141], v[140:141], v[156:157]
  v_pk_add_f32 v[142:143], v[142:143], v[158:159]
  v_pk_add_f32 v[128:129], v[128:129], v[80:81]
  v_pk_add_f32 v[130:131], v[130:131], v[82:83]
  v_pk_add_f32 v[132:133], v[132:133], v[84:85]
  v_pk_add_f32 v[134:135], v[134:135], v[86:87]
  v_pk_add_f32 v[136:137], v[136:137], v[88:89]
  v_pk_add_f32 v[138:139], v[138:139], v[90:91]
  v_pk_add_f32 v[140:141], v[140:141], v[92:93]
  v_pk_add_f32 v[142:143], v[142:143], v[94:95]
  v_pk_add_f32 v[64:65], v[64:65], v[128:129]
  v_pk_add_f32 v[66:67], v[66:67], v[130:131]
  v_pk_add_f32 v[68:69], v[68:69], v[132:133]
  v_pk_add_f32 v[70:71], v[70:71], v[134:135]
  v_pk_add_f32 v[72:73], v[72:73], v[136:137]
  v_pk_add_f32 v[74:75], v[74:75], v[138:139]
  v_pk_add_f32 v[76:77], v[76:77], v[140:141]
  v_pk_add_f32 v[78:79], v[78:79], v[142:143]
  v_mov_b32 v4, v76
  v_mov_b32 v5, v76
  s_nop 1
  v_permlane32_swap_b32 v4, v5
  v_pk_add_f32 v[16:17], v[64:65], v[66:67]
  v_pk_add_f32 v[22:23], v[68:69], v[70:71]
  v_pk_add_f32 v[16:17], v[16:17], v[72:73]
  v_pk_add_f32 v[22:23], v[22:23], v[74:75]
  v_pk_add_f32 v[16:17], v[16:17], v[76:77]
  v_pk_add_f32 v[22:23], v[22:23], v[78:79]
  v_pk_add_f32 v[16:17], v[16:17], v[22:23]
  v_cmp_le_f32 s[32:33], v18, v5
  v_cmp_ge_f32 s[34:35], v19, v5
  v_add_f32 v16, v16, v17
  v_cmp_class_f32 vcc, v16, v20
  s_and_b64 s[32:33], s[32:33], s[34:35]
  s_and_b64 vcc, vcc, s[32:33]
  s_cmp_eq_u64 vcc, -1
  s_cbranch_scc0 mk_fbk51
mk_ok50:
  v_rcp_f32 v5, v5
  s_nop 0
  v_pk_mul_f32 v[64:65], v[64:65], v[4:5] op_sel:[0,1] op_sel_hi:[1,1]
  v_pk_mul_f32 v[66:67], v[66:67], v[4:5] op_sel:[0,1] op_sel_hi:[1,1]
  v_pk_mul_f32 v[68:69], v[68:69], v[4:5] op_sel:[0,1] op_sel_hi:[1,1]
  v_pk_mul_f32 v[70:71], v[70:71], v[4:5] op_sel:[0,1] op_sel_hi:[1,1]
  v_pk_mul_f32 v[72:73], v[72:73], v[4:5] op_sel:[0,1] op_sel_hi:[1,1]
  v_pk_mul_f32 v[74:75], v[74:75], v[4:5] op_sel:[0,1] op_sel_hi:[1,1]
  v_pk_mul_f32 v[76:77], v[76:77], v[4:5] op_sel:[0,1] op_sel_hi:[1,1]
  v_pk_mul_f32 v[78:79], v[78:79], v[4:5] op_sel:[0,1] op_sel_hi:[1,1]
  v_cvt_pk_bf16_f32 v48, v64, v65
  v_cvt_pk_bf16_f32 v49, v66, v67
  v_cvt_pk_bf16_f32 v50, v68, v69
  v_cvt_pk_bf16_f32 v51, v70, v71
  v_cvt_pk_bf16_f32 v52, v72, v73
  v_cvt_pk_bf16_f32 v53, v74, v75
  v_cvt_pk_bf16_f32 v54, v76, v77
  v_cvt_pk_bf16_f32 v55, v78, v79
  s_cmp_eq_u32 s17, 0
  s_cbranch_scc1 mk_sg52
  buffer_store_dwordx4 v[48:51], v1, s[4:7], s38 offen
  buffer_store_dwordx4 v[52:55], v1, s[4:7], s38 offen offset:1024
mk_sd53:
  s_mov_b32 s51, s37
  v_lshlrev_b32 v64, 16, v8
  v_and_b32 v65, 0xffff0000, v8
  v_lshlrev_b32 v66, 16, v9
  v_and_b32 v67, 0xffff0000, v9
  v_lshlrev_b32 v68, 16, v10
  v_and_b32 v69, 0xffff0000, v10
  v_lshlrev_b32 v70, 16, v11
  v_and_b32 v71, 0xffff0000, v11
  v_lshlrev_b32 v72, 16, v12
  v_and_b32 v73, 0xffff0000, v12
  v_lshlrev_b32 v74, 16, v13
  v_and_b32 v75, 0xffff0000, v13
  v_lshlrev_b32 v76, 16, v14
  v_and_b32 v77, 0xffff0000, v14
  v_lshlrev_b32 v78, 16, v15
  v_and_b32 v79, 0xffff0000, v15
  s_mul_i32 s38, s26, 28672
  s_lshl_b32 s35, s28, 11
  s_add_u32 s38, s38, s35
  s_add_u32 s38, s38, s18
  s_lshr_b32 s30, s28, 1
  s_and_b32 s31, s28, 1
  s_lshl_b32 s39, s30, 12
  s_lshl_b32 s35, s26, 9
  s_add_u32 s39, s39, s35
  s_lshl_b32 s35, s31, 3
  s_add_u32 s39, s39, s35
  s_add_u32 s39, s39, s18
  s_add_u32 s39, s39, 1212416
  s_lshl_b32 s37, s26, 7
  s_lshl_b32 s35, s28, 3
  s_add_u32 s37, s37, s35
  s_add_u32 s37, s37, s57
  s_add_u32 s37, s37, 1247232
  s_mul_i32 s40, s26, 114688
  s_lshl_b32 s35, s20, 13
  s_add_u32 s40, s40, s35
  s_add_u32 s40, s40, s18
  s_add_u32 s40, s40, 262144
  s_mul_i32 s41, s27, 114688
  s_lshl_b32 s35, s20, 13
  s_add_u32 s41, s41, s35
  s_add_u32 s41, s41, s18
  s_add_u32 s41, s41, 262144
  s_lshl_b32 s30, s26, 7
  s_lshl_b32 s31, s27, 7
  v_and_b32 v7, 15, v2
  v_lshlrev_b32 v7, 3, v7
  v_add_u32 v4, s30, v7
  v_add_u32 v7, s31, v7
  v_cmp_gt_u32 vcc, 16, v2
  s_nop 1
  v_cndmask_b32 v7, v7, v4, vcc
  s_lshl_b32 s56, s20, 5
  s_add_u32 s56, s56, s57
  s_add_u32 s56, s56, 1246208
  v_mov_b32 v4, s58
  v_mov_b32 v5, s59
  s_mov_b64 exec, 1
  s_waitcnt vmcnt(0)
  s_cmp_eq_u32 s17, 0
  s_cbranch_scc1 mk_sg54
  buffer_store_dwordx2 v[4:5], v1, s[4:7], s51 offen
mk_sd55:
  s_mov_b64 exec, -1
  s_barrier
  s_cmp_ge_u32 s22, 28
  s_cbranch_scc1 mk_end
  s_mov_b32 exec_lo, 0xf000f
  s_mov_b32 exec_hi, 0x0
  s_mov_b32 s36, 0
mk_pl56:
  buffer_load_dwordx2 v[4:5], v7, s[4:7], s56 offen sc1
  s_add_u32 s36, s36, 1
  s_cmp_ge_u32 s36, 0x40000
  s_cbranch_scc1 mk_end
  s_waitcnt vmcnt(0)
  v_cmp_ne_u64 vcc, s[58:59], v[4:5]
  s_cbranch_vccnz mk_pl56
  s_mov_b64 exec, -1
  buffer_load_dwordx4 v[128:131], v1, s[4:7], s41 offen sc1
  buffer_load_dwordx4 v[132:135], v1, s[4:7], s41 offen offset:1024 sc1
  buffer_load_dwordx4 v[136:139], v1, s[4:7], s41 offen offset:2048 sc1
  buffer_load_dwordx4 v[140:143], v1, s[4:7], s41 offen offset:3072 sc1
  s_add_u32 s41, s41, 4096
  buffer_load_dwordx4 v[144:147], v1, s[4:7], s41 offen sc1
  buffer_load_dwordx4 v[148:151], v1, s[4:7], s41 offen offset:1024 sc1
  buffer_load_dwordx4 v[152:155], v1, s[4:7], s41 offen offset:2048 sc1
  buffer_load_dwordx4 v[156:159], v1, s[4:7], s41 offen offset:3072 sc1
  s_waitcnt vmcnt(7)
  v_mfma_f32_32x32x16_bf16 v[96:111], v[192:195], v[128:131], 0
  buffer_load_dwordx4 v[160:163], v1, s[4:7], s40 offen sc1
  v_mfma_f32_32x32x16_bf16 v[112:127], v[196:199], v[128:131], 0
  s_waitcnt vmcnt(7)
  v_mfma_f32_32x32x16_bf16 v[96:111], v[200:203], v[132:135], v[96:111]
  buffer_load_dwordx4 v[164:167], v1, s[4:7], s40 offen offset:1024 sc1
  v_mfma_f32_32x32x16_bf16 v[112:127], v[204:207], v[132:135], v[112:127]
  s_waitcnt vmcnt(7)
  v_mfma_f32_32x32x16_bf16 v[96:111], v[208:211], v[136:139], v[96:111]
  buffer_load_dwordx4 v[168:171], v1, s[4:7], s40 offen offset:2048 sc1
  v_mfma_f32_32x32x16_bf16 v[112:127], v[212:215], v[136:139], v[112:127]
  s_waitcnt vmcnt(7)
  v_mfma_f32_32x32x16_bf16 v[96:111], v[216:219], v[140:143], v[96:111]
  buffer_load_dwordx4 v[172:175], v1, s[4:7], s40 offen offset:3072 sc1
  v_mfma_f32_32x32x16_bf16 v[112:127], v[220:223], v[140:143], v[112:127]
  s_waitcnt vmcnt(7)
  v_mfma_f32_32x32x16_bf16 v[96:111], v[224:227], v[144:147], v[96:111]
  s_add_u32 s40, s40, 4096
  buffer_load_dwordx4 v[176:179], v1, s[4:7], s40 offen sc1
  v_mfma_f32_32x32x16_bf16 v[112:127], v[228:231], v[144:147], v[112:127]
  s_waitcnt vmcnt(7)
  v_mfma_f32_32x32x16_bf16 v[96:111], v[232:235], v[148:151], v[96:111]
  buffer_load_dwordx4 v[180:183], v1, s[4:7], s40 offen offset:1024 sc1
  v_mfma_f32_32x32x16_bf16 v[112:127], v[236:239], v[148:151], v[112:127]
  s_waitcnt vmcnt(7)
  v_mfma_f32_32x32x16_bf16 v[96:111], v[240:243], v[152:155], v[96:111]
  buffer_load_dwordx4 v[184:187], v1, s[4:7], s40 offen offset:2048 sc1
  v_mfma_f32_32x32x16_bf16 v[112:127], v[244:247], v[152:155], v[112:127]
  s_waitcnt vmcnt(7)
  v_mfma_f32_32x32x16_bf16 v[96:111], v[248:251], v[156:159], v[96:111]
  buffer_load_dwordx4 v[188:191], v1, s[4:7], s40 offen offset:3072 sc1
  v_mfma_f32_32x32x16_bf16 v[112:127], v[252:255], v[156:159], v[112:127]
  s_waitcnt vmcnt(7)
  v_mfma_f32_32x32x16_bf16 v[80:95], v[196:199], v[160:163], 0
  v_lshlrev_b32 v16, 4, v2
  v_mov_b32 v4, 0x7fffff00
  v_cmp_eq_u32 vcc, 1, v3
  s_nop 1
  v_cndmask_b32 v16, v16, v4, vcc
  s_lshl_b32 s31, s24, 11
  s_add_u32 s31, s31, 3751936
  v_mfma_f32_32x32x16_bf16 v[64:79], v[192:195], v[160:163], v[64:79]
  s_waitcnt vmcnt(6)
  v_mfma_f32_32x32x16_bf16 v[80:95], v[204:207], v[164:167], v[80:95]
  buffer_load_dwordx4 v[32:35], v16, s[4:7], s31 offen sc1
  ds_write_b128 v61, v[96:99] offset:0
  v_mfma_f32_32x32x16_bf16 v[64:79], v[200:203], v[164:167], v[64:79]
  ds_write_b128 v61, v[100:103] offset:1024
  s_waitcnt vmcnt(6)
  v_mfma_f32_32x32x16_bf16 v[80:95], v[212:215], v[168:171], v[80:95]
  buffer_load_dwordx4 v[36:39], v16, s[4:7], s31 offen offset:512 sc1
  ds_write_b128 v61, v[104:107] offset:2048
  v_mfma_f32_32x32x16_bf16 v[64:79], v[208:211], v[168:171], v[64:79]
  ds_write_b128 v61, v[108:111] offset:3072
  s_waitcnt vmcnt(6)
  v_mfma_f32_32x32x16_bf16 v[80:95], v[220:223], v[172:175], v[80:95]
  buffer_load_dwordx4 v[40:43], v16, s[4:7], s31 offen offset:1024 sc1
  ds_write_b128 v62, v[112:115] offset:0
  v_mfma_f32_32x32x16_bf16 v[64:79], v[216:219], v[172:175], v[64:79]
  ds_write_b128 v62, v[116:119] offset:1024
  s_waitcnt vmcnt(6)
  v_mfma_f32_32x32x16_bf16 v[80:95], v[228:231], v[176:179], v[80:95]
  buffer_load_dwordx4 v[44:47], v16, s[4:7], s31 offen offset:1536 sc1
  ds_write_b128 v62, v[120:123] offset:2048
  s_waitcnt vmcnt(6)
  v_mfma_f32_32x32x16_bf16 v[80:95], v[236:239], v[180:183], v[80:95]
  ds_write_b128 v62, v[124:127] offset:3072
  s_waitcnt vmcnt(5)
  v_mfma_f32_32x32x16_bf16 v[80:95], v[244:247], v[184:187], v[80:95]
  s_waitcnt vmcnt(4)
  v_mfma_f32_32x32x16_bf16 v[80:95], v[252:255], v[188:191], v[80:95]
  v_mfma_f32_32x32x16_bf16 v[64:79], v[224:227], v[176:179], v[64:79]
  v_mov_b32 v20, 0
  v_mov_b32 v21, 0
  v_mov_b32 v22, 0
  v_mov_b32 v23, 0
  v_mov_b32 v26, 0x3f803f80
  v_lshlrev_b32 v7, 4, v2
  v_mfma_f32_32x32x16_bf16 v[64:79], v[232:235], v[180:183], v[64:79]
  s_nop 3
  ds_write_b128 v60, v[80:83] offset:0
  v_mfma_f32_32x32x16_bf16 v[64:79], v[240:243], v[184:187], v[64:79]
  ds_write_b128 v60, v[84:87] offset:1024
  ds_write_b128 v60, v[88:91] offset:2048
  v_mfma_f32_32x32x16_bf16 v[64:79], v[248:251], v[188:191], v[64:79]
  ds_write_b128 v60, v[92:95] offset:3072
  s_waitcnt lgkmcnt(0)
  s_barrier
  ds_read_b128 v[144:147], v63 offset:4096
  ds_read_b128 v[148:151], v63 offset:5120
  ds_read_b128 v[152:155], v63 offset:6144
  ds_read_b128 v[156:159], v63 offset:7168
  ds_read_b128 v[160:163], v63 offset:8192
  ds_read_b128 v[164:167], v63 offset:9216
  ds_read_b128 v[168:171], v63 offset:10240
  ds_read_b128 v[172:175], v63 offset:11264
  ds_read_b128 v[128:131], v63 offset:0
  ds_read_b128 v[132:135], v63 offset:1024
  ds_read_b128 v[136:139], v63 offset:2048
  ds_read_b128 v[140:143], v63 offset:3072
  s_waitcnt lgkmcnt(8)
  v_pk_add_f32 v[64:65], v[64:65], v[144:145]
  v_pk_add_f32 v[66:67], v[66:67], v[146:147]
  v_pk_add_f32 v[68:69], v[68:69], v[148:149]
  v_pk_add_f32 v[70:71], v[70:71], v[150:151]
  v_pk_add_f32 v[72:73], v[72:73], v[152:153]
  v_pk_add_f32 v[74:75], v[74:75], v[154:155]
  v_pk_add_f32 v[76:77], v[76:77], v[156:157]
  v_pk_add_f32 v[78:79], v[78:79], v[158:159]
  s_waitcnt lgkmcnt(4)
  v_pk_add_f32 v[64:65], v[64:65], v[160:161]
  v_pk_add_f32 v[66:67], v[66:67], v[162:163]
  v_pk_add_f32 v[68:69], v[68:69], v[164:165]
  v_pk_add_f32 v[70:71], v[70:71], v[166:167]
  v_pk_add_f32 v[72:73], v[72:73], v[168:169]
  v_pk_add_f32 v[74:75], v[74:75], v[170:171]
  v_pk_add_f32 v[76:77], v[76:77], v[172:173]
  v_pk_add_f32 v[78:79], v[78:79], v[174:175]
  s_waitcnt lgkmcnt(0)
  v_pk_add_f32 v[64:65], v[64:65], v[128:129]
  v_pk_add_f32 v[66:67], v[66:67], v[130:131]
  v_pk_add_f32 v[68:69], v[68:69], v[132:133]
  v_pk_add_f32 v[70:71], v[70:71], v[134:135]
  v_pk_add_f32 v[72:73], v[72:73], v[136:137]
  v_pk_add_f32 v[74:75], v[74:75], v[138:139]
  v_pk_add_f32 v[76:77], v[76:77], v[140:141]
  v_pk_add_f32 v[78:79], v[78:79], v[142:143]
  v_cvt_pk_bf16_f32 v8, v64, v65
  v_cvt_pk_bf16_f32 v9, v66, v67
  v_cvt_pk_bf16_f32 v10, v68, v69
  v_cvt_pk_bf16_f32 v11, v70, v71
  v_cvt_pk_bf16_f32 v12, v72, v73
  v_cvt_pk_bf16_f32 v13, v74, v75
  v_cvt_pk_bf16_f32 v14, v76, v77
  v_cvt_pk_bf16_f32 v15, v78, v79
  s_cmp_eq_u32 s17, 0
  s_cbranch_scc1 mk_sg58
  buffer_store_dwordx4 v[8:11], v1, s[4:7], s38 offen
  buffer_store_dwordx4 v[12:15], v1, s[4:7], s38 offen offset:1024
mk_sd59:
  v_dot2c_f32_bf16 v20, v8, v26
  v_dot2c_f32_bf16 v21, v8, v8
  v_dot2c_f32_bf16 v22, v9, v26
  v_dot2c_f32_bf16 v23, v9, v9
  v_dot2c_f32_bf16 v20, v10, v26
  v_dot2c_f32_bf16 v21, v10, v10
  v_dot2c_f32_bf16 v22, v11, v26
  v_dot2c_f32_bf16 v23, v11, v11
  v_dot2c_f32_bf16 v20, v12, v26
  v_dot2c_f32_bf16 v21, v12, v12
  v_dot2c_f32_bf16 v22, v13, v26
  v_dot2c_f32_bf16 v23, v13, v13
  v_dot2c_f32_bf16 v20, v14, v26
  v_dot2c_f32_bf16 v21, v14, v14
  v_dot2c_f32_bf16 v22, v15, v26
  v_dot2c_f32_bf16 v23, v15, v15
  s_nop 2
  v_pk_add_f32 v[20:21], v[20:21], v[22:23]
  v_mov_b32 v24, v20
  v_mov_b32 v25, v21
  s_nop 0
  v_permlane32_swap_b32 v20, v24
  v_permlane32_swap_b32 v21, v25
  v_pk_add_f32 v[20:21], v[20:21], v[24:25]
  s_mov_b32 exec_hi, 0
  s_cmp_eq_u32 s17, 0
  s_cbranch_scc1 mk_sg60
  buffer_store_dwordx2 v[20:21], v7, s[4:7], s39 offen
mk_sd61:
  s_mov_b32 exec_hi, -1
  s_mov_b32 s51, s37
  s_mul_i32 s40, s25, 28672
  s_add_u32 s40, s40, s18
  s_lshl_b32 s45, s25, 9
  s_add_u32 s45, s45, s18
  s_add_u32 s45, s45, 1212416
  s_mul_i32 s38, s25, 114688
  s_lshl_b32 s35, s24, 13
  s_add_u32 s38, s38, s35
  s_add_u32 s38, s38, s18
  s_add_u32 s38, s38, 262144
  s_add_u32 s39, s38, 4096
  s_lshl_b32 s37, s25, 7
  s_lshl_b32 s35, s24, 3
  s_add_u32 s37, s37, s35
  s_add_u32 s37, s37, s57
  s_add_u32 s37, s37, 1248256
  v_lshrrev_b32 v7, 1, v1
  s_lshl_b32 s56, s25, 7
  s_add_u32 s56, s56, s57
  s_add_u32 s56, s56, 1247232
  s_waitcnt vmcnt(3)
  v_pk_add_f32 v[32:33], v[32:33], v[34:35]
  v_add_f32 v32, v32, v33
  v_cvt_pk_bf16_f32 v49, v32, v32
  v_and_b32 v49, 0xffff0000, v49
  v_sub_f32 v32, v32, v49
  v_cvt_pk_bf16_f32 v48, v49, v32
  v_mov_b32 v49, v48
  v_mov_b32 v50, 0
  v_mov_b32 v51, 0
  v_pk_add_f32 v[36:37], v[36:37], v[38:39]
  v_add_f32 v36, v36, v37
  v_cvt_pk_bf16_f32 v53, v36, v36
  v_and_b32 v53, 0xffff0000, v53
  v_sub_f32 v36, v36, v53
  v_cvt_pk_bf16_f32 v52, v53, v36
  v_mov_b32 v53, v52
  v_mov_b32 v54, 0
  v_mov_b32 v55, 0
  v_pk_add_f32 v[40:41], v[40:41], v[42:43]
  v_add_f32 v40, v40, v41
  v_cvt_pk_bf16_f32 v57, v40, v40
  v_and_b32 v57, 0xffff0000, v57
  v_sub_f32 v40, v40, v57
  v_cvt_pk_bf16_f32 v56, v57, v40
  v_mov_b32 v57, v56
  v_mov_b32 v58, 0
  v_mov_b32 v59, 0
  v_pk_add_f32 v[44:45], v[44:45], v[46:47]
  v_add_f32 v44, v44, v45
  v_cvt_pk_bf16_f32 v61, v44, v44
  v_and_b32 v61, 0xffff0000, v61
  v_sub_f32 v44, v44, v61
  v_cvt_pk_bf16_f32 v60, v61, v44
  v_mov_b32 v61, v60
  v_mov_b32 v62, 0
  v_mov_b32 v63, 0
  v_mov_b32 v4, s58
  v_mov_b32 v5, s59
  s_mov_b64 exec, 1
  s_waitcnt vmcnt(0)
  s_cmp_eq_u32 s17, 0
  s_cbranch_scc1 mk_sg62
  buffer_store_dwordx2 v[4:5], v1, s[4:7], s51 offen
mk_sd63:
  s_mov_b64 exec, -1
  s_barrier
  ds_read_b64_tr_b16 v[16:17], v6 offset:0
  ds_read_b64_tr_b16 v[18:19], v6 offset:512
  ds_read_b64_tr_b16 v[20:21], v6 offset:28672
  ds_read_b64_tr_b16 v[22:23], v6 offset:29184
  ds_read_b64_tr_b16 v[24:25], v6 offset:57344
  ds_read_b64_tr_b16 v[26:27], v6 offset:57856
  ds_read_b64_tr_b16 v[28:29], v0 offset:20480
  ds_read_b64_tr_b16 v[30:31], v0 offset:20992
  ds_read_b64_tr_b16 v[32:33], v6 offset:1024
  ds_read_b64_tr_b16 v[34:35], v6 offset:1536
  ds_read_b64_tr_b16 v[36:37], v6 offset:29696
  ds_read_b64_tr_b16 v[38:39], v6 offset:30208
  s_mov_b32 exec_lo, 0x3fff
  s_mov_b32 exec_hi, 0x0
  s_mov_b32 s36, 0
mk_pl64:
  buffer_load_dwordx2 v[4:5], v7, s[4:7], s56 offen sc1
  s_add_u32 s36, s36, 1
  s_cmp_ge_u32 s36, 0x40000
  s_cbranch_scc1 mk_end
  s_waitcnt vmcnt(0)
  v_cmp_ne_u64 vcc, s[58:59], v[4:5]
  s_cbranch_vccnz mk_pl64
  s_mov_b64 exec, -1
  buffer_load_dwordx4 v[128:131], v1, s[4:7], s40 offen sc1
  buffer_load_dwordx4 v[132:135], v1, s[4:7], s40 offen offset:1024 sc1
  buffer_load_dwordx4 v[136:139], v1, s[4:7], s40 offen offset:2048 sc1
  buffer_load_dwordx4 v[140:143], v1, s[4:7], s40 offen offset:3072 sc1
  s_add_u32 s40, s40, 4096
  buffer_load_dwordx4 v[144:147], v1, s[4:7], s40 offen sc1
  v_lshlrev_b32 v7, 4, v2
  v_lshlrev_b32 v4, 14, v3
  v_add_u32 v7, v7, v4
  v_mov_b32 v4, 0x7fffff00
  v_cmp_eq_u32 vcc, 1, v3
  s_nop 1
  v_cndmask_b32 v5, v7, v4, vcc
  s_waitcnt vmcnt(4)
  s_waitcnt lgkmcnt(8)
  v_mfma_f32_32x32x16_bf16 v[64:79], v[16:19], v[128:131], 0
  buffer_load_dwordx4 v[148:151], v1, s[4:7], s40 offen offset:1024 sc1
  ds_read_b64_tr_b16 v[40:41], v6 offset:58368
  ds_read_b64_tr_b16 v[42:43], v6 offset:58880
  v_mfma_f32_32x32x16_bf16 v[80:95], v[20:23], v[128:131], 0
  ds_read_b64_tr_b16 v[44:45], v0 offset:21504
  ds_read_b64_tr_b16 v[46:47], v0 offset:22016
  s_waitcnt lgkmcnt(8)
  v_mfma_f32_32x32x16_bf16 v[96:111], v[24:27], v[128:131], 0
  buffer_load_dwordx4 v[240:243], v7, s[4:7], s45 offen sc1
  s_add_u32 s45, s45, 4096
  ds_read_b64_tr_b16 v[16:17], v6 offset:2048
  ds_read_b64_tr_b16 v[18:19], v6 offset:2560
  v_mfma_f32_32x32x16_bf16 v[112:127], v[28:31], v[128:131], 0
  ds_read_b64_tr_b16 v[20:21], v6 offset:30720
  ds_read_b64_tr_b16 v[22:23], v6 offset:31232
  s_waitcnt vmcnt(5)
  s_waitcnt lgkmcnt(8)
  v_mfma_f32_32x32x16_bf16 v[64:79], v[32:35], v[132:135], v[64:79]
  buffer_load_dwordx4 v[152:155], v1, s[4:7], s40 offen offset:2048 sc1
  ds_read_b64_tr_b16 v[24:25], v6 offset:59392
  ds_read_b64_tr_b16 v[26:27], v6 offset:59904
  v_mfma_f32_32x32x16_bf16 v[80:95], v[36:39], v[132:135], v[80:95]
  ds_read_b64_tr_b16 v[28:29], v0 offset:22528
  ds_read_b64_tr_b16 v[30:31], v0 offset:23040
  s_waitcnt lgkmcnt(8)
  v_mfma_f32_32x32x16_bf16 v[96:111], v[40:43], v[132:135], v[96:111]
  buffer_load_dwordx4 v[244:247], v7, s[4:7], s45 offen sc1
  s_add_u32 s45, s45, 4096
  ds_read_b64_tr_b16 v[32:33], v6 offset:3072
  ds_read_b64_tr_b16 v[34:35], v6 offset:3584
  v_mfma_f32_32x32x16_bf16 v[112:127], v[44:47], v[132:135], v[112:127]
  ds_read_b64_tr_b16 v[36:37], v6 offset:31744
  ds_read_b64_tr_b16 v[38:39], v6 offset:32256
  s_waitcnt vmcnt(6)
  s_waitcnt lgkmcnt(8)
  v_mfma_f32_32x32x16_bf16 v[64:79], v[16:19], v[136:139], v[64:79]
  buffer_load_dwordx4 v[156:159], v1, s[4:7], s40 offen offset:3072 sc1
  ds_read_b64_tr_b16 v[40:41], v6 offset:60416
  ds_read_b64_tr_b16 v[42:43], v6 offset:60928
  v_mfma_f32_32x32x16_bf16 v[80:95], v[20:23], v[136:139], v[80:95]
  ds_read_b64_tr_b16 v[44:45], v0 offset:23552
  ds_read_b64_tr_b16 v[46:47], v0 offset:24064
  s_waitcnt lgkmcnt(8)
  v_mfma_f32_32x32x16_bf16 v[96:111], v[24:27], v[136:139], v[96:111]
  buffer_load_dwordx4 v[248:251], v7, s[4:7], s45 offen sc1
  s_add_u32 s45, s45, 4096
  ds_read_b64_tr_b16 v[16:17], v6 offset:4096
  ds_read_b64_tr_b16 v[18:19], v6 offset:4608
  v_mfma_f32_32x32x16_bf16 v[112:127], v[28:31], v[136:139], v[112:127]
  ds_read_b64_tr_b16 v[20:21], v6 offset:32768
  ds_read_b64_tr_b16 v[22:23], v6 offset:33280
  s_waitcnt vmcnt(7)
  s_waitcnt lgkmcnt(8)
  v_mfma_f32_32x32x16_bf16 v[64:79], v[32:35], v[140:143], v[64:79]
  s_add_u32 s40, s40, 4096
  buffer_load_dwordx4 v[160:163], v1, s[4:7], s40 offen sc1
  ds_read_b64_tr_b16 v[24:25], v6 offset:61440
  ds_read_b64_tr_b16 v[26:27], v6 offset:61952
  v_mfma_f32_32x32x16_bf16 v[80:95], v[36:39], v[140:143], v[80:95]
  ds_read_b64_tr_b16 v[28:29], v0 offset:24576
  ds_read_b64_tr_b16 v[30:31], v0 offset:25088
  s_waitcnt lgkmcnt(8)
  v_mfma_f32_32x32x16_bf16 v[96:111], v[40:43], v[140:143], v[96:111]
  buffer_load_dwordx4 v[252:255], v5, s[4:7], s45 offen sc1
  ds_read_b64_tr_b16 v[32:33], v6 offset:5120
  ds_read_b64_tr_b16 v[34:35], v6 offset:5632
  v_mfma_f32_32x32x16_bf16 v[112:127], v[44:47], v[140:143], v[112:127]
  ds_read_b64_tr_b16 v[36:37], v6 offset:33792
  ds_read_b64_tr_b16 v[38:39], v6 offset:34304
  s_waitcnt vmcnt(8)
  s_waitcnt lgkmcnt(8)
  v_mfma_f32_32x32x16_bf16 v[64:79], v[16:19], v[144:147], v[64:79]
  buffer_load_dwordx4 v[164:167], v1, s[4:7], s40 offen offset:1024 sc1
  ds_read_b64_tr_b16 v[40:41], v6 offset:62464
  ds_read_b64_tr_b16 v[42:43], v6 offset:62976
  v_mfma_f32_32x32x16_bf16 v[80:95], v[20:23], v[144:147], v[80:95]
  ds_read_b64_tr_b16 v[44:45], v0 offset:25600
  ds_read_b64_tr_b16 v[46:47], v0 offset:26112
  s_waitcnt lgkmcnt(8)
  v_mfma_f32_32x32x16_bf16 v[96:111], v[24:27], v[144:147], v[96:111]
  buffer_load_dwordx4 v[168:171], v1, s[4:7], s40 offen offset:2048 sc1
  ds_read_b64_tr_b16 v[16:17], v6 offset:6144
  ds_read_b64_tr_b16 v[18:19], v6 offset:6656
  v_mfma_f32_32x32x16_bf16 v[112:127], v[28:31], v[144:147], v[112:127]
  ds_read_b64_tr_b16 v[20:21], v6 offset:34816
  ds_read_b64_tr_b16 v[22:23], v6 offset:35328
  s_waitcnt vmcnt(9)
  s_waitcnt lgkmcnt(8)
  v_mfma_f32_32x32x16_bf16 v[64:79], v[32:35], v[148:151], v[64:79]
  buffer_load_dwordx4 v[172:175], v1, s[4:7], s40 offen offset:3072 sc1
  ds_read_b64_tr_b16 v[24:25], v6 offset:63488
  ds_read_b64_tr_b16 v[26:27], v6 offset:64000
  v_mfma_f32_32x32x16_bf16 v[80:95], v[36:39], v[148:151], v[80:95]
  ds_read_b64_tr_b16 v[28:29], v0 offset:26624
  ds_read_b64_tr_b16 v[30:31], v0 offset:27136
  s_waitcnt lgkmcnt(8)
  v_mfma_f32_32x32x16_bf16 v[96:111], v[40:43], v[148:151], v[96:111]
  s_add_u32 s40, s40, 4096
  buffer_load_dwordx4 v[176:179], v1, s[4:7], s40 offen sc1
  ds_read_b64_tr_b16 v[32:33], v6 offset:7168
  ds_read_b64_tr_b16 v[34:35], v6 offset:7680
  v_mfma_f32_32x32x16_bf16 v[112:127], v[44:47], v[148:151], v[112:127]
  ds_read_b64_tr_b16 v[36:37], v6 offset:35840
  ds_read_b64_tr_b16 v[38:39], v6 offset:36352
  s_waitcnt vmcnt(9)
  s_waitcnt lgkmcnt(8)
  v_mfma_f32_32x32x16_bf16 v[64:79], v[16:19], v[152:155], v[64:79]
  buffer_load_dwordx4 v[180:183], v1, s[4:7], s40 offen offset:1024 sc1
  ds_read_b64_tr_b16 v[40:41], v6 offset:64512
  ds_read_b64_tr_b16 v[42:43], v6 offset:65024
  v_mfma_f32_32x32x16_bf16 v[80:95], v[20:23], v[152:155], v[80:95]
  ds_read_b64_tr_b16 v[44:45], v0 offset:27648
  ds_read_b64_tr_b16 v[46:47], v0 offset:28160
  s_waitcnt lgkmcnt(8)
  v_mfma_f32_32x32x16_bf16 v[96:111], v[24:27], v[152:155], v[96:111]
  buffer_load_dwordx4 v[184:187], v1, s[4:7], s40 offen offset:2048 sc1
  ds_read_b64_tr_b16 v[16:17], v6 offset:8192
  ds_read_b64_tr_b16 v[18:19], v6 offset:8704
  v_mfma_f32_32x32x16_bf16 v[112:127], v[28:31], v[152:155], v[112:127]
  ds_read_b64_tr_b16 v[20:21], v6 offset:36864
  ds_read_b64_tr_b16 v[22:23], v6 offset:37376
  s_waitcnt vmcnt(9)
  s_waitcnt lgkmcnt(8)
  v_mfma_f32_32x32x16_bf16 v[64:79], v[32:35], v[156:159], v[64:79]
  buffer_load_dwordx4 v[188:191], v1, s[4:7], s40 offen offset:3072 sc1
  ds_read_b64_tr_b16 v[24:25], v0 offset:0
  ds_read_b64_tr_b16 v[26:27], v0 offset:512
  v_mfma_f32_32x32x16_bf16 v[80:95], v[36:39], v[156:159], v[80:95]
  ds_read_b64_tr_b16 v[28:29], v0 offset:28672
  ds_read_b64_tr_b16 v[30:31], v0 offset:29184
  s_waitcnt lgkmcnt(8)
  v_mfma_f32_32x32x16_bf16 v[96:111], v[40:43], v[156:159], v[96:111]
  s_add_u32 s40, s40, 4096
  buffer_load_dwordx4 v[192:195], v1, s[4:7], s40 offen sc1
  ds_read_b64_tr_b16 v[32:33], v6 offset:9216
  ds_read_b64_tr_b16 v[34:35], v6 offset:9728
  v_mfma_f32_32x32x16_bf16 v[112:127], v[44:47], v[156:159], v[112:127]
  ds_read_b64_tr_b16 v[36:37], v6 offset:37888
  ds_read_b64_tr_b16 v[38:39], v6 offset:38400
  s_waitcnt vmcnt(9)
  s_waitcnt lgkmcnt(8)
  v_mfma_f32_32x32x16_bf16 v[64:79], v[16:19], v[160:163], v[64:79]
  buffer_load_dwordx4 v[196:199], v1, s[4:7], s40 offen offset:1024 sc1
  ds_read_b64_tr_b16 v[40:41], v0 offset:1024
  ds_read_b64_tr_b16 v[42:43], v0 offset:1536
  s_waitcnt vmcnt(9)
  v_add_f32 v240, v240, v242
  v_add_f32 v241, v241, v243
  v_mfma_f32_32x32x16_bf16 v[80:95], v[20:23], v[160:163], v[80:95]
  ds_read_b64_tr_b16 v[44:45], v0 offset:29696
  ds_read_b64_tr_b16 v[46:47], v0 offset:30208
  v_add_f32 v244, v244, v246
  v_add_f32 v245, v245, v247
  s_waitcnt lgkmcnt(8)
  v_mfma_f32_32x32x16_bf16 v[96:111], v[24:27], v[160:163], v[96:111]
  buffer_load_dwordx4 v[200:203], v1, s[4:7], s40 offen offset:2048 sc1
  ds_read_b64_tr_b16 v[16:17], v6 offset:10240
  ds_read_b64_tr_b16 v[18:19], v6 offset:10752
  v_add_f32 v248, v248, v250
  v_add_f32 v249, v249, v251
  v_mfma_f32_32x32x16_bf16 v[112:127], v[28:31], v[160:163], v[112:127]
  ds_read_b64_tr_b16 v[20:21], v6 offset:38912
  ds_read_b64_tr_b16 v[22:23], v6 offset:39424
  v_add_f32 v252, v252, v254
  v_add_f32 v253, v253, v255
  s_waitcnt vmcnt(9)
  s_waitcnt lgkmcnt(8)
  v_mfma_f32_32x32x16_bf16 v[64:79], v[32:35], v[164:167], v[64:79]
  buffer_load_dwordx4 v[204:207], v1, s[4:7], s40 offen offset:3072 sc1
  ds_read_b64_tr_b16 v[24:25], v0 offset:2048
  ds_read_b64_tr_b16 v[26:27], v0 offset:2560
  v_add_f32 v240, v240, v244
  v_add_f32 v241, v241, v245
  v_mfma_f32_32x32x16_bf16 v[80:95], v[36:39], v[164:167], v[80:95]
  ds_read_b64_tr_b16 v[28:29], v0 offset:30720
  ds_read_b64_tr_b16 v[30:31], v0 offset:31232
  v_add_f32 v248, v248, v252
  v_add_f32 v249, v249, v253
  s_waitcnt lgkmcnt(8)
  v_mfma_f32_32x32x16_bf16 v[96:111], v[40:43], v[164:167], v[96:111]
  s_add_u32 s40, s40, 4096
  buffer_load_dwordx4 v[208:211], v1, s[4:7], s40 offen sc1
  ds_read_b64_tr_b16 v[32:33], v6 offset:11264
  ds_read_b64_tr_b16 v[34:35], v6 offset:11776
  v_add_f32 v240, v240, v248
  v_add_f32 v241, v241, v249
  v_mfma_f32_32x32x16_bf16 v[112:127], v[44:47], v[164:167], v[112:127]
  ds_read_b64_tr_b16 v[36:37], v6 offset:39936
  ds_read_b64_tr_b16 v[38:39], v6 offset:40448
  v_mov_b32 v242, v240
  v_mov_b32 v243, v241
  s_waitcnt vmcnt(10)
  s_waitcnt lgkmcnt(8)
  v_mfma_f32_32x32x16_bf16 v[64:79], v[16:19], v[168:171], v[64:79]
  buffer_load_dwordx4 v[212:215], v1, s[4:7], s40 offen offset:1024 sc1
  ds_read_b64_tr_b16 v[40:41], v0 offset:3072
  ds_read_b64_tr_b16 v[42:43], v0 offset:3584
  v_mov_b32 v246, 0
  v_mov_b32 v247, 0
  v_mfma_f32_32x32x16_bf16 v[80:95], v[20:23], v[168:171], v[80:95]
  ds_read_b64_tr_b16 v[44:45], v0 offset:31744
  ds_read_b64_tr_b16 v[46:47], v0 offset:32256
  v_permlane32_swap_b32 v240, v242
  v_permlane32_swap_b32 v241, v243
  s_waitcnt lgkmcnt(8)
  v_mfma_f32_32x32x16_bf16 v[96:111], v[24:27], v[168:171], v[96:111]
  buffer_load_dwordx4 v[216:219], v1, s[4:7], s40 offen offset:2048 sc1
  ds_read_b64_tr_b16 v[16:17], v6 offset:12288
  ds_read_b64_tr_b16 v[18:19], v6 offset:12800
  v_add_f32 v240, v240, v242
  v_add_f32 v241, v241, v243
  v_mfma_f32_32x32x16_bf16 v[112:127], v[28:31], v[168:171], v[112:127]
  ds_read_b64_tr_b16 v[20:21], v6 offset:40960
  ds_read_b64_tr_b16 v[22:23], v6 offset:41472
  v_mul_f32 v240, 0xbb124925, v240
  v_mul_f32 v241, 0x3b124925, v241
  s_waitcnt vmcnt(11)
  s_waitcnt lgkmcnt(8)
  v_mfma_f32_32x32x16_bf16 v[64:79], v[32:35], v[172:175], v[64:79]
  buffer_load_dwordx4 v[220:223], v1, s[4:7], s40 offen offset:3072 sc1
  ds_read_b64_tr_b16 v[24:25], v0 offset:4096
  ds_read_b64_tr_b16 v[26:27], v0 offset:4608
  v_fma_f32 v241, -v240, v240, v241
  v_max_f32 v241, 0, v241
  v_mfma_f32_32x32x16_bf16 v[80:95], v[36:39], v[172:175], v[80:95]
  ds_read_b64_tr_b16 v[28:29], v0 offset:32768
  ds_read_b64_tr_b16 v[30:31], v0 offset:33280
  v_add_f32 v241, 0x3727c5ac, v241
  v_rsq_f32 v241, v241
  s_waitcnt lgkmcnt(8)
  v_mfma_f32_32x32x16_bf16 v[96:111], v[40:43], v[172:175], v[96:111]
  s_add_u32 s40, s40, 4096
  buffer_load_dwordx4 v[224:227], v1, s[4:7], s40 offen sc1
  ds_read_b64_tr_b16 v[32:33], v6 offset:13312
  ds_read_b64_tr_b16 v[34:35], v6 offset:13824
  v_cvt_pk_bf16_f32 v244, v240, v240
  v_and_b32 v245, 0xffff0000, v244
  v_mfma_f32_32x32x16_bf16 v[112:127], v[44:47], v[172:175], v[112:127]
  ds_read_b64_tr_b16 v[36:37], v6 offset:41984
  ds_read_b64_tr_b16 v[38:39], v6 offset:42496
  v_sub_f32 v245, v240, v245
  v_cvt_pk_bf16_f32 v245, v245, v245
  s_waitcnt vmcnt(12)
  s_waitcnt lgkmcnt(8)
  v_mfma_f32_32x32x16_bf16 v[64:79], v[16:19], v[176:179], v[64:79]
  buffer_load_dwordx4 v[228:231], v1, s[4:7], s40 offen offset:1024 sc1
  ds_read_b64_tr_b16 v[40:41], v0 offset:5120
  ds_read_b64_tr_b16 v[42:43], v0 offset:5632
  s_lshl_b32 s30, s20, 7
  s_add_u32 s30, s30, 114688
  v_mfma_f32_32x32x16_bf16 v[80:95], v[20:23], v[176:179], v[80:95]
  ds_read_b64_tr_b16 v[44:45], v0 offset:33792
  ds_read_b64_tr_b16 v[46:47], v0 offset:34304
  v_lshlrev_b32 v4, 2, v2
  v_add_u32 v4, s30, v4
  s_waitcnt lgkmcnt(8)
  v_mfma_f32_32x32x16_bf16 v[96:111], v[24:27], v[176:179], v[96:111]
  buffer_load_dwordx4 v[232:235], v1, s[4:7], s40 offen offset:2048 sc1
  ds_read_b64_tr_b16 v[16:17], v6 offset:14336
  ds_read_b64_tr_b16 v[18:19], v6 offset:14848
  v_mfma_f32_32x32x16_bf16 v[112:127], v[28:31], v[176:179], v[112:127]
  ds_read_b64_tr_b16 v[20:21], v6 offset:43008
  ds_read_b64_tr_b16 v[22:23], v6 offset:43520
  s_waitcnt vmcnt(13)
  s_waitcnt lgkmcnt(8)
  v_mfma_f32_32x32x16_bf16 v[64:79], v[32:35], v[180:183], v[64:79]
  buffer_load_dwordx4 v[236:239], v1, s[4:7], s40 offen offset:3072 sc1
  ds_read_b64_tr_b16 v[24:25], v0 offset:6144
  ds_read_b64_tr_b16 v[26:27], v0 offset:6656
  v_mfma_f32_32x32x16_bf16 v[80:95], v[36:39], v[180:183], v[80:95]
  ds_read_b64_tr_b16 v[28:29], v0 offset:34816
  ds_read_b64_tr_b16 v[30:31], v0 offset:35328
  s_waitcnt lgkmcnt(8)
  v_mfma_f32_32x32x16_bf16 v[96:111], v[40:43], v[180:183], v[96:111]
  ds_read_b64_tr_b16 v[32:33], v6 offset:15360
  ds_read_b64_tr_b16 v[34:35], v6 offset:15872
  v_mfma_f32_32x32x16_bf16 v[112:127], v[44:47], v[180:183], v[112:127]
  ds_read_b64_tr_b16 v[36:37], v6 offset:44032
  ds_read_b64_tr_b16 v[38:39], v6 offset:44544
  s_waitcnt vmcnt(13)
  s_waitcnt lgkmcnt(8)
  v_mfma_f32_32x32x16_bf16 v[64:79], v[16:19], v[184:187], v[64:79]
  ds_read_b64_tr_b16 v[40:41], v0 offset:7168
  ds_read_b64_tr_b16 v[42:43], v0 offset:7680
  v_mfma_f32_32x32x16_bf16 v[64:79], v[48:51], v[244:247], v[64:79]
  v_mfma_f32_32x32x16_bf16 v[80:95], v[20:23], v[184:187], v[80:95]
  ds_read_b64_tr_b16 v[44:45], v0 offset:35840
  ds_read_b64_tr_b16 v[46:47], v0 offset:36352
  v_mfma_f32_32x32x16_bf16 v[80:95], v[52:55], v[244:247], v[80:95]
  s_waitcnt lgkmcnt(8)
  v_mfma_f32_32x32x16_bf16 v[96:111], v[24:27], v[184:187], v[96:111]
  ds_read_b64_tr_b16 v[16:17], v6 offset:16384
  ds_read_b64_tr_b16 v[18:19], v6 offset:16896
  v_mfma_f32_32x32x16_bf16 v[96:111], v[56:59], v[244:247], v[96:111]
  v_mfma_f32_32x32x16_bf16 v[112:127], v[28:31], v[184:187], v[112:127]
  ds_read_b64_tr_b16 v[20:21], v6 offset:45056
  ds_read_b64_tr_b16 v[22:23], v6 offset:45568
  v_mfma_f32_32x32x16_bf16 v[112:127], v[60:63], v[244:247], v[112:127]
  ds_write_b32 v4, v241 offset:0
  s_waitcnt vmcnt(12)
  s_waitcnt lgkmcnt(9)
  v_mfma_f32_32x32x16_bf16 v[64:79], v[32:35], v[188:191], v[64:79]
  ds_read_b64_tr_b16 v[24:25], v0 offset:8192
  ds_read_b64_tr_b16 v[26:27], v0 offset:8704
  v_mfma_f32_32x32x16_bf16 v[80:95], v[36:39], v[188:191], v[80:95]
  ds_read_b64_tr_b16 v[28:29], v0 offset:36864
  ds_read_b64_tr_b16 v[30:31], v0 offset:37376
  s_waitcnt lgkmcnt(9)
  v_mfma_f32_32x32x16_bf16 v[96:111], v[40:43], v[188:191], v[96:111]
  ds_read_b64_tr_b16 v[32:33], v6 offset:17408
  ds_read_b64_tr_b16 v[34:35], v6 offset:17920
  v_mfma_f32_32x32x16_bf16 v[112:127], v[44:47], v[188:191], v[112:127]
  ds_read_b64_tr_b16 v[36:37], v6 offset:46080
  ds_read_b64_tr_b16 v[38:39], v6 offset:46592
  s_waitcnt vmcnt(11)
  s_waitcnt lgkmcnt(9)
  v_mfma_f32_32x32x16_bf16 v[64:79], v[16:19], v[192:195], v[64:79]
  ds_read_b64_tr_b16 v[40:41], v0 offset:9216
  ds_read_b64_tr_b16 v[42:43], v0 offset:9728
  v_mfma_f32_32x32x16_bf16 v[80:95], v[20:23], v[192:195], v[80:95]
  ds_read_b64_tr_b16 v[44:45], v0 offset:37888
  ds_read_b64_tr_b16 v[46:47], v0 offset:38400
  s_waitcnt lgkmcnt(8)
  v_mfma_f32_32x32x16_bf16 v[96:111], v[24:27], v[192:195], v[96:111]
  ds_read_b64_tr_b16 v[16:17], v6 offset:18432
  ds_read_b64_tr_b16 v[18:19], v6 offset:18944
  v_mfma_f32_32x32x16_bf16 v[112:127], v[28:31], v[192:195], v[112:127]
  ds_read_b64_tr_b16 v[20:21], v6 offset:47104
  ds_read_b64_tr_b16 v[22:23], v6 offset:47616
  s_waitcnt vmcnt(10)
  s_waitcnt lgkmcnt(8)
  v_mfma_f32_32x32x16_bf16 v[64:79], v[32:35], v[196:199], v[64:79]
  ds_read_b64_tr_b16 v[24:25], v0 offset:10240
  ds_read_b64_tr_b16 v[26:27], v0 offset:10752
  v_mfma_f32_32x32x16_bf16 v[80:95], v[36:39], v[196:199], v[80:95]
  ds_read_b64_tr_b16 v[28:29], v0 offset:38912
  ds_read_b64_tr_b16 v[30:31], v0 offset:39424
  s_waitcnt lgkmcnt(8)
  v_mfma_f32_32x32x16_bf16 v[96:111], v[40:43], v[196:199], v[96:111]
  ds_read_b64_tr_b16 v[32:33], v6 offset:19456
  ds_read_b64_tr_b16 v[34:35], v6 offset:19968
  v_mfma_f32_32x32x16_bf16 v[112:127], v[44:47], v[196:199], v[112:127]
  ds_read_b64_tr_b16 v[36:37], v6 offset:48128
  ds_read_b64_tr_b16 v[38:39], v6 offset:48640
  s_waitcnt vmcnt(9)
  s_waitcnt lgkmcnt(8)
  v_mfma_f32_32x32x16_bf16 v[64:79], v[16:19], v[200:203], v[64:79]
  ds_read_b64_tr_b16 v[40:41], v0 offset:11264
  ds_read_b64_tr_b16 v[42:43], v0 offset:11776
  v_mfma_f32_32x32x16_bf16 v[80:95], v[20:23], v[200:203], v[80:95]
  ds_read_b64_tr_b16 v[44:45], v0 offset:39936
  ds_read_b64_tr_b16 v[46:47], v0 offset:40448
  s_waitcnt lgkmcnt(8)
  v_mfma_f32_32x32x16_bf16 v[96:111], v[24:27], v[200:203], v[96:111]
  ds_read_b64_tr_b16 v[16:17], v6 offset:20480
  ds_read_b64_tr_b16 v[18:19], v6 offset:20992
  v_mfma_f32_32x32x16_bf16 v[112:127], v[28:31], v[200:203], v[112:127]
  ds_read_b64_tr_b16 v[20:21], v6 offset:49152
  ds_read_b64_tr_b16 v[22:23], v6 offset:49664
  s_waitcnt vmcnt(8)
  s_waitcnt lgkmcnt(8)
  v_mfma_f32_32x32x16_bf16 v[64:79], v[32:35], v[204:207], v[64:79]
  ds_read_b64_tr_b16 v[24:25], v0 offset:12288
  ds_read_b64_tr_b16 v[26:27], v0 offset:12800
  v_mfma_f32_32x32x16_bf16 v[80:95], v[36:39], v[204:207], v[80:95]
  ds_read_b64_tr_b16 v[28:29], v0 offset:40960
  ds_read_b64_tr_b16 v[30:31], v0 offset:41472
  s_waitcnt lgkmcnt(8)
  v_mfma_f32_32x32x16_bf16 v[96:111], v[40:43], v[204:207], v[96:111]
  ds_read_b64_tr_b16 v[32:33], v6 offset:21504
  ds_read_b64_tr_b16 v[34:35], v6 offset:22016
  v_mfma_f32_32x32x16_bf16 v[112:127], v[44:47], v[204:207], v[112:127]
  ds_read_b64_tr_b16 v[36:37], v6 offset:50176
  ds_read_b64_tr_b16 v[38:39], v6 offset:50688
  s_waitcnt vmcnt(7)
  s_waitcnt lgkmcnt(8)
  v_mfma_f32_32x32x16_bf16 v[64:79], v[16:19], v[208:211], v[64:79]
  ds_read_b64_tr_b16 v[40:41], v0 offset:13312
  ds_read_b64_tr_b16 v[42:43], v0 offset:13824
  v_mfma_f32_32x32x16_bf16 v[80:95], v[20:23], v[208:211], v[80:95]
  ds_read_b64_tr_b16 v[44:45], v0 offset:41984
  ds_read_b64_tr_b16 v[46:47], v0 offset:42496
  s_waitcnt lgkmcnt(8)
  v_mfma_f32_32x32x16_bf16 v[96:111], v[24:27], v[208:211], v[96:111]
  ds_read_b64_tr_b16 v[16:17], v6 offset:22528
  ds_read_b64_tr_b16 v[18:19], v6 offset:23040
  v_mfma_f32_32x32x16_bf16 v[112:127], v[28:31], v[208:211], v[112:127]
  ds_read_b64_tr_b16 v[20:21], v6 offset:51200
  ds_read_b64_tr_b16 v[22:23], v6 offset:51712
  s_waitcnt vmcnt(6)
  s_waitcnt lgkmcnt(8)
  v_mfma_f32_32x32x16_bf16 v[64:79], v[32:35], v[212:215], v[64:79]
  ds_read_b64_tr_b16 v[24:25], v0 offset:14336
  ds_read_b64_tr_b16 v[26:27], v0 offset:14848
  v_mfma_f32_32x32x16_bf16 v[80:95], v[36:39], v[212:215], v[80:95]
  ds_read_b64_tr_b16 v[28:29], v0 offset:43008
  ds_read_b64_tr_b16 v[30:31], v0 offset:43520
  s_waitcnt lgkmcnt(8)
  v_mfma_f32_32x32x16_bf16 v[96:111], v[40:43], v[212:215], v[96:111]
  ds_read_b64_tr_b16 v[32:33], v6 offset:23552
  ds_read_b64_tr_b16 v[34:35], v6 offset:24064
  v_mfma_f32_32x32x16_bf16 v[112:127], v[44:47], v[212:215], v[112:127]
  ds_read_b64_tr_b16 v[36:37], v6 offset:24576
  ds_read_b64_tr_b16 v[38:39], v6 offset:25088
  s_waitcnt vmcnt(5)
  s_waitcnt lgkmcnt(8)
  v_mfma_f32_32x32x16_bf16 v[64:79], v[16:19], v[216:219], v[64:79]
  ds_read_b64_tr_b16 v[40:41], v6 offset:25600
  ds_read_b64_tr_b16 v[42:43], v6 offset:26112
  v_mfma_f32_32x32x16_bf16 v[80:95], v[20:23], v[216:219], v[80:95]
  ds_read_b64_tr_b16 v[44:45], v6 offset:26624
  ds_read_b64_tr_b16 v[46:47], v6 offset:27136
  s_waitcnt lgkmcnt(8)
  v_mfma_f32_32x32x16_bf16 v[96:111], v[24:27], v[216:219], v[96:111]
  ds_read_b64_tr_b16 v[16:17], v6 offset:27648
  ds_read_b64_tr_b16 v[18:19], v6 offset:28160
  v_mfma_f32_32x32x16_bf16 v[112:127], v[28:31], v[216:219], v[112:127]
  ds_read_b64_tr_b16 v[20:21], v6 offset:52224
  ds_read_b64_tr_b16 v[22:23], v6 offset:52736
  s_waitcnt vmcnt(4)
  s_waitcnt lgkmcnt(8)
  v_mfma_f32_32x32x16_bf16 v[64:79], v[32:35], v[220:223], v[64:79]
  ds_read_b64_tr_b16 v[24:25], v6 offset:53248
  ds_read_b64_tr_b16 v[26:27], v6 offset:53760
  s_waitcnt vmcnt(3)
  v_mfma_f32_32x32x16_bf16 v[64:79], v[36:39], v[224:227], v[64:79]
  ds_read_b64_tr_b16 v[28:29], v6 offset:54272
  ds_read_b64_tr_b16 v[30:31], v6 offset:54784
  s_waitcnt vmcnt(2)
  s_waitcnt lgkmcnt(8)
  v_mfma_f32_32x32x16_bf16 v[64:79], v[40:43], v[228:231], v[64:79]
  ds_read_b64_tr_b16 v[32:33], v6 offset:55296
  ds_read_b64_tr_b16 v[34:35], v6 offset:55808
  s_waitcnt vmcnt(1)
  v_mfma_f32_32x32x16_bf16 v[64:79], v[44:47], v[232:235], v[64:79]
  ds_read_b64_tr_b16 v[36:37], v6 offset:56320
  ds_read_b64_tr_b16 v[38:39], v6 offset:56832
  s_waitcnt vmcnt(0)
  s_waitcnt lgkmcnt(8)
  v_mfma_f32_32x32x16_bf16 v[64:79], v[16:19], v[236:239], v[64:79]
  ds_read_b64_tr_b16 v[40:41], v0 offset:15360
  ds_read_b64_tr_b16 v[42:43], v0 offset:15872
  v_mfma_f32_32x32x16_bf16 v[80:95], v[20:23], v[220:223], v[80:95]
  ds_read_b64_tr_b16 v[44:45], v0 offset:16384
  ds_read_b64_tr_b16 v[46:47], v0 offset:16896
  s_waitcnt lgkmcnt(8)
  v_mfma_f32_32x32x16_bf16 v[80:95], v[24:27], v[224:227], v[80:95]
  ds_read_b64_tr_b16 v[16:17], v0 offset:17408
  ds_read_b64_tr_b16 v[18:19], v0 offset:17920
  s_nop 2
  v_cvt_pk_bf16_f32 v64, v64, v65
  v_cvt_pk_bf16_f32 v65, v66, v67
  v_cvt_pk_bf16_f32 v66, v68, v69
  v_cvt_pk_bf16_f32 v67, v70, v71
  v_mfma_f32_32x32x16_bf16 v[80:95], v[28:31], v[228:231], v[80:95]
  ds_read_b64_tr_b16 v[20:21], v0 offset:18432
  ds_read_b64_tr_b16 v[22:23], v0 offset:18944
  v_cvt_pk_bf16_f32 v68, v72, v73
  v_cvt_pk_bf16_f32 v69, v74, v75
  v_cvt_pk_bf16_f32 v70, v76, v77
  v_cvt_pk_bf16_f32 v71, v78, v79
  s_waitcnt lgkmcnt(8)
  v_mfma_f32_32x32x16_bf16 v[80:95], v[32:35], v[232:235], v[80:95]
  ds_read_b64_tr_b16 v[24:25], v0 offset:19456
  ds_read_b64_tr_b16 v[26:27], v0 offset:19968
  v_pk_max_i16 v64, v64, 0
  v_pk_max_i16 v65, v65, 0
  v_pk_max_i16 v66, v66, 0
  v_pk_max_i16 v67, v67, 0
  v_mfma_f32_32x32x16_bf16 v[80:95], v[36:39], v[236:239], v[80:95]
  ds_read_b64_tr_b16 v[28:29], v0 offset:44032
  ds_read_b64_tr_b16 v[30:31], v0 offset:44544
  v_pk_max_i16 v68, v68, 0
  v_pk_max_i16 v69, v69, 0
  v_pk_max_i16 v70, v70, 0
  v_pk_max_i16 v71, v71, 0
  s_waitcnt lgkmcnt(8)
  v_mfma_f32_32x32x16_bf16 v[96:111], v[40:43], v[220:223], v[96:111]
  ds_read_b64_tr_b16 v[32:33], v0 offset:45056
  ds_read_b64_tr_b16 v[34:35], v0 offset:45568
  s_cmp_eq_u32 s17, 0
  s_cbranch_scc1 mk_sg66
  buffer_store_dwordx4 v[64:67], v1, s[4:7], s38 offen
  buffer_store_dwordx4 v[68:71], v1, s[4:7], s38 offen offset:1024
mk_sd67:
  v_mfma_f32_32x32x16_bf16 v[96:111], v[44:47], v[224:227], v[96:111]
  ds_read_b64_tr_b16 v[36:37], v0 offset:46080
  ds_read_b64_tr_b16 v[38:39], v0 offset:46592
  v_cvt_pk_bf16_f32 v80, v80, v81
  v_cvt_pk_bf16_f32 v81, v82, v83
  v_cvt_pk_bf16_f32 v82, v84, v85
  v_cvt_pk_bf16_f32 v83, v86, v87
  s_waitcnt lgkmcnt(8)
  v_mfma_f32_32x32x16_bf16 v[96:111], v[16:19], v[228:231], v[96:111]
  ds_read_b64_tr_b16 v[40:41], v0 offset:47104
  ds_read_b64_tr_b16 v[42:43], v0 offset:47616
  v_cvt_pk_bf16_f32 v84, v88, v89
  v_cvt_pk_bf16_f32 v85, v90, v91
  v_cvt_pk_bf16_f32 v86, v92, v93
  v_cvt_pk_bf16_f32 v87, v94, v95
  v_mfma_f32_32x32x16_bf16 v[96:111], v[20:23], v[232:235], v[96:111]
  ds_read_b64_tr_b16 v[44:45], v0 offset:48128
  ds_read_b64_tr_b16 v[46:47], v0 offset:48640
  v_pk_max_i16 v80, v80, 0
  v_pk_max_i16 v81, v81, 0
  v_pk_max_i16 v82, v82, 0
  v_pk_max_i16 v83, v83, 0
  s_waitcnt lgkmcnt(8)
  v_mfma_f32_32x32x16_bf16 v[96:111], v[24:27], v[236:239], v[96:111]
  v_pk_max_i16 v84, v84, 0
  v_pk_max_i16 v85, v85, 0
  v_pk_max_i16 v86, v86, 0
  v_pk_max_i16 v87, v87, 0
  v_mfma_f32_32x32x16_bf16 v[112:127], v[28:31], v[220:223], v[112:127]
  s_cmp_eq_u32 s17, 0
  s_cbranch_scc1 mk_sg68
  buffer_store_dwordx4 v[80:83], v1, s[4:7], s38 offen offset:2048
  buffer_store_dwordx4 v[84:87], v1, s[4:7], s38 offen offset:3072
mk_sd69:
  s_waitcnt lgkmcnt(4)
  v_mfma_f32_32x32x16_bf16 v[112:127], v[32:35], v[224:227], v[112:127]
  s_nop 2
  v_cvt_pk_bf16_f32 v96, v96, v97
  v_cvt_pk_bf16_f32 v97, v98, v99
  v_cvt_pk_bf16_f32 v98, v100, v101
  v_cvt_pk_bf16_f32 v99, v102, v103
  v_mfma_f32_32x32x16_bf16 v[112:127], v[36:39], v[228:231], v[112:127]
  v_cvt_pk_bf16_f32 v100, v104, v105
  v_cvt_pk_bf16_f32 v101, v106, v107
  v_cvt_pk_bf16_f32 v102, v108, v109
  v_cvt_pk_bf16_f32 v103, v110, v111
  s_waitcnt lgkmcnt(0)
  v_mfma_f32_32x32x16_bf16 v[112:127], v[40:43], v[232:235], v[112:127]
  v_pk_max_i16 v96, v96, 0
  v_pk_max_i16 v97, v97, 0
  v_pk_max_i16 v98, v98, 0
  v_pk_max_i16 v99, v99, 0
  v_mfma_f32_32x32x16_bf16 v[112:127], v[44:47], v[236:239], v[112:127]
  v_pk_max_i16 v100, v100, 0
  v_pk_max_i16 v101, v101, 0
  v_pk_max_i16 v102, v102, 0
  v_pk_max_i16 v103, v103, 0
  s_cmp_eq_u32 s17, 0
  s_cbranch_scc1 mk_sg70
  buffer_store_dwordx4 v[96:99], v1, s[4:7], s39 offen
  buffer_store_dwordx4 v[100:103], v1, s[4:7], s39 offen offset:1024
mk_sd71:
  s_nop 5
  v_cvt_pk_bf16_f32 v112, v112, v113
  v_cvt_pk_bf16_f32 v113, v114, v115
  v_cvt_pk_bf16_f32 v114, v116, v117
  v_cvt_pk_bf16_f32 v115, v118, v119
  v_cvt_pk_bf16_f32 v116, v120, v121
  v_cvt_pk_bf16_f32 v117, v122, v123
  v_cvt_pk_bf16_f32 v118, v124, v125
  v_cvt_pk_bf16_f32 v119, v126, v127
  v_pk_max_i16 v112, v112, 0
  v_pk_max_i16 v113, v113, 0
  v_pk_max_i16 v114, v114, 0
  v_pk_max_i16 v115, v115, 0
  v_pk_max_i16 v116, v116, 0
  v_pk_max_i16 v117, v117, 0
  v_pk_max_i16 v118, v118, 0
  v_pk_max_i16 v119, v119, 0
  s_cmp_eq_u32 s17, 0
  s_cbranch_scc1 mk_sg72
  buffer_store_dwordx4 v[112:115], v1, s[4:7], s39 offen offset:2048
  buffer_store_dwordx4 v[116:119], v1, s[4:7], s39 offen offset:3072
mk_sd73:
  s_mov_b32 s51, s37
  s_xor_b32 s30, s20, 1
  s_mul_i32 s30, s30, 12288
  s_add_u32 s30, s30, 114688
  v_add_u32 v60, s30, v1
  s_xor_b32 s30, s20, 2
  s_mul_i32 s30, s30, 12288
  s_add_u32 s30, s30, 118784
  v_add_u32 v61, s30, v1
  s_xor_b32 s30, s20, 3
  s_mul_i32 s30, s30, 12288
  s_add_u32 s30, s30, 122880
  v_add_u32 v62, s30, v1
  s_mul_i32 s30, s20, 12288
  s_add_u32 s30, s30, 114688
  v_add_u32 v63, s30, v1
  v_lshlrev_b32 v16, 16, v8
  v_and_b32 v17, 0xffff0000, v8
  v_lshlrev_b32 v18, 16, v9
  v_and_b32 v19, 0xffff0000, v9
  v_lshlrev_b32 v20, 16, v10
  v_and_b32 v21, 0xffff0000, v10
  v_lshlrev_b32 v22, 16, v11
  v_and_b32 v23, 0xffff0000, v11
  v_lshlrev_b32 v24, 16, v12
  v_and_b32 v25, 0xffff0000, v12
  v_lshlrev_b32 v26, 16, v13
  v_and_b32 v27, 0xffff0000, v13
  v_lshlrev_b32 v28, 16, v14
  v_and_b32 v29, 0xffff0000, v14
  v_lshlrev_b32 v30, 16, v15
  v_and_b32 v31, 0xffff0000, v15
  s_mul_i32 s38, s26, 28672
  s_lshl_b32 s35, s28, 11
  s_add_u32 s38, s38, s35
  s_add_u32 s38, s38, s18
  s_lshr_b32 s30, s28, 1
  s_and_b32 s31, s28, 1
  s_lshl_b32 s39, s30, 12
  s_lshl_b32 s35, s26, 9
  s_add_u32 s39, s39, s35
  s_lshl_b32 s35, s31, 3
  s_add_u32 s39, s39, s35
  s_add_u32 s39, s39, s18
  s_add_u32 s39, s39, 1179648
  s_lshl_b32 s37, s26, 7
  s_lshl_b32 s35, s28, 3
  s_add_u32 s37, s37, s35
  s_add_u32 s37, s37, s57
  s_add_u32 s37, s37, 1249280
  s_mul_i32 s40, s26, 114688
  s_mul_i32 s35, s20, 28672
  s_add_u32 s40, s40, s35
  s_add_u32 s40, s40, s18
  s_add_u32 s40, s40, 262144
  s_mul_i32 s41, s27, 114688
  s_mul_i32 s35, s20, 28672
  s_add_u32 s41, s41, s35
  s_add_u32 s41, s41, s18
  s_add_u32 s41, s41, 262144
  s_lshl_b32 s30, s26, 7
  s_lshl_b32 s31, s27, 7
  v_and_b32 v7, 15, v2
  v_lshlrev_b32 v7, 3, v7
  v_add_u32 v4, s30, v7
  v_add_u32 v7, s31, v7
  v_cmp_gt_u32 vcc, 16, v2
  s_nop 1
  v_cndmask_b32 v7, v7, v4, vcc
  s_mul_i32 s30, s20, 7
  s_lshr_b32 s30, s30, 1
  s_lshl_b32 s56, s30, 3
  s_add_u32 s56, s56, s57
  s_add_u32 s56, s56, 1248256
  v_mov_b32 v4, s58
  v_mov_b32 v5, s59
  s_mov_b64 exec, 1
  s_waitcnt vmcnt(0)
  s_cmp_eq_u32 s17, 0
  s_cbranch_scc1 mk_sg74
  buffer_store_dwordx2 v[4:5], v1, s[4:7], s51 offen
mk_sd75:
  s_mov_b64 exec, -1
  s_waitcnt lgkmcnt(0)
  s_barrier
  s_and_b32 s30, s26, 3
  s_lshl_b32 s30, s30, 7
  s_add_u32 s30, s30, 114688
  v_lshlrev_b32 v4, 2, v2
  v_add_u32 v4, s30, v4
  ds_read_b32 v32, v4 offset:0
  s_waitcnt lgkmcnt(0)
  s_barrier
  s_mov_b32 exec_lo, 0xf000f
  s_mov_b32 exec_hi, 0x0
  s_mov_b32 s36, 0
mk_pl76:
  buffer_load_dwordx2 v[4:5], v7, s[4:7], s56 offen sc1
  s_add_u32 s36, s36, 1
  s_cmp_ge_u32 s36, 0x40000
  s_cbranch_scc1 mk_end
  s_waitcnt vmcnt(0)
  v_cmp_ne_u64 vcc, s[58:59], v[4:5]
  s_cbranch_vccnz mk_pl76
  s_mov_b64 exec, -1
  buffer_load_dwordx4 v[128:131], v1, s[4:7], s41 offen sc1
  buffer_load_dwordx4 v[132:135], v1, s[4:7], s41 offen offset:1024 sc1
  buffer_load_dwordx4 v[136:139], v1, s[4:7], s41 offen offset:2048 sc1
  buffer_load_dwordx4 v[140:143], v1, s[4:7], s41 offen offset:3072 sc1
  s_add_u32 s41, s41, 4096
  buffer_load_dwordx4 v[144:147], v1, s[4:7], s41 offen sc1
  buffer_load_dwordx4 v[148:151], v1, s[4:7], s41 offen offset:1024 sc1
  buffer_load_dwordx4 v[152:155], v1, s[4:7], s41 offen offset:2048 sc1
  buffer_load_dwordx4 v[156:159], v1, s[4:7], s41 offen offset:3072 sc1
  s_waitcnt vmcnt(7)
  v_mfma_f32_32x32x16_bf16 v[96:111], a[0:3], v[128:131], 0
  s_add_u32 s41, s41, 4096
  buffer_load_dwordx4 v[160:163], v1, s[4:7], s41 offen sc1
  v_mfma_f32_32x32x16_bf16 v[112:127], a[4:7], v[128:131], 0
  s_waitcnt vmcnt(7)
  v_mfma_f32_32x32x16_bf16 v[96:111], a[8:11], v[132:135], v[96:111]
  buffer_load_dwordx4 v[164:167], v1, s[4:7], s41 offen offset:1024 sc1
  v_mfma_f32_32x32x16_bf16 v[112:127], a[12:15], v[132:135], v[112:127]
  s_waitcnt vmcnt(7)
  v_mfma_f32_32x32x16_bf16 v[96:111], a[16:19], v[136:139], v[96:111]
  buffer_load_dwordx4 v[168:171], v1, s[4:7], s41 offen offset:2048 sc1
  v_mfma_f32_32x32x16_bf16 v[112:127], a[20:23], v[136:139], v[112:127]
  s_waitcnt vmcnt(7)
  v_mfma_f32_32x32x16_bf16 v[96:111], a[24:27], v[140:143], v[96:111]
  buffer_load_dwordx4 v[172:175], v1, s[4:7], s41 offen offset:3072 sc1
  v_mfma_f32_32x32x16_bf16 v[112:127], a[28:31], v[140:143], v[112:127]
  s_waitcnt vmcnt(7)
  v_mfma_f32_32x32x16_bf16 v[96:111], a[32:35], v[144:147], v[96:111]
  s_add_u32 s41, s41, 4096
  buffer_load_dwordx4 v[176:179], v1, s[4:7], s41 offen sc1
  v_mfma_f32_32x32x16_bf16 v[112:127], a[36:39], v[144:147], v[112:127]
  s_waitcnt vmcnt(7)
  v_mfma_f32_32x32x16_bf16 v[96:111], a[40:43], v[148:151], v[96:111]
  buffer_load_dwordx4 v[180:183], v1, s[4:7], s41 offen offset:1024 sc1
  v_mfma_f32_32x32x16_bf16 v[112:127], a[44:47], v[148:151], v[112:127]
  s_waitcnt vmcnt(7)
  v_mfma_f32_32x32x16_bf16 v[96:111], a[48:51], v[152:155], v[96:111]
  buffer_load_dwordx4 v[184:187], v1, s[4:7], s41 offen offset:2048 sc1
  v_mfma_f32_32x32x16_bf16 v[112:127], a[52:55], v[152:155], v[112:127]
  s_waitcnt vmcnt(7)
  v_mfma_f32_32x32x16_bf16 v[96:111], a[56:59], v[156:159], v[96:111]
  buffer_load_dwordx4 v[188:191], v1, s[4:7], s41 offen offset:3072 sc1
  v_mfma_f32_32x32x16_bf16 v[112:127], a[60:63], v[156:159], v[112:127]
  s_waitcnt vmcnt(7)
  v_mfma_f32_32x32x16_bf16 v[96:111], a[64:67], v[160:163], v[96:111]
  s_add_u32 s41, s41, 4096
  buffer_load_dwordx4 v[192:195], v1, s[4:7], s41 offen sc1
  v_mfma_f32_32x32x16_bf16 v[112:127], a[68:71], v[160:163], v[112:127]
  s_waitcnt vmcnt(7)
  v_mfma_f32_32x32x16_bf16 v[96:111], a[72:75], v[164:167], v[96:111]
  buffer_load_dwordx4 v[196:199], v1, s[4:7], s41 offen offset:1024 sc1
  v_mfma_f32_32x32x16_bf16 v[112:127], a[76:79], v[164:167], v[112:127]
  s_waitcnt vmcnt(7)
  v_mfma_f32_32x32x16_bf16 v[96:111], a[80:83], v[168:171], v[96:111]
  buffer_load_dwordx4 v[200:203], v1, s[4:7], s41 offen offset:2048 sc1
  v_mfma_f32_32x32x16_bf16 v[112:127], a[84:87], v[168:171], v[112:127]
  s_waitcnt vmcnt(7)
  v_mfma_f32_32x32x16_bf16 v[96:111], a[88:91], v[172:175], v[96:111]
  buffer_load_dwordx4 v[204:207], v1, s[4:7], s41 offen offset:3072 sc1
  v_mfma_f32_32x32x16_bf16 v[112:127], a[92:95], v[172:175], v[112:127]
  s_waitcnt vmcnt(7)
  v_mfma_f32_32x32x16_bf16 v[96:111], a[96:99], v[176:179], v[96:111]
  s_add_u32 s41, s41, 4096
  buffer_load_dwordx4 v[128:131], v1, s[4:7], s41 offen sc1
  v_mfma_f32_32x32x16_bf16 v[112:127], a[100:103], v[176:179], v[112:127]
  s_waitcnt vmcnt(7)
  v_mfma_f32_32x32x16_bf16 v[96:111], a[104:107], v[180:183], v[96:111]
  buffer_load_dwordx4 v[132:135], v1, s[4:7], s41 offen offset:1024 sc1
  v_mfma_f32_32x32x16_bf16 v[112:127], a[108:111], v[180:183], v[112:127]
  s_waitcnt vmcnt(7)
  v_mfma_f32_32x32x16_bf16 v[96:111], a[112:115], v[184:187], v[96:111]
  buffer_load_dwordx4 v[136:139], v1, s[4:7], s41 offen offset:2048 sc1
  v_mfma_f32_32x32x16_bf16 v[112:127], a[116:119], v[184:187], v[112:127]
  s_waitcnt vmcnt(7)
  v_mfma_f32_32x32x16_bf16 v[96:111], a[120:123], v[188:191], v[96:111]
  buffer_load_dwordx4 v[140:143], v1, s[4:7], s41 offen offset:3072 sc1
  v_mfma_f32_32x32x16_bf16 v[112:127], a[124:127], v[188:191], v[112:127]
  s_waitcnt vmcnt(7)
  v_mfma_f32_32x32x16_bf16 v[96:111], a[128:131], v[192:195], v[96:111]
  s_add_u32 s41, s41, 4096
  buffer_load_dwordx4 v[144:147], v1, s[4:7], s41 offen sc1
  v_mfma_f32_32x32x16_bf16 v[112:127], a[132:135], v[192:195], v[112:127]
  s_waitcnt vmcnt(7)
  v_mfma_f32_32x32x16_bf16 v[96:111], a[136:139], v[196:199], v[96:111]
  buffer_load_dwordx4 v[148:151], v1, s[4:7], s41 offen offset:1024 sc1
  v_mfma_f32_32x32x16_bf16 v[112:127], a[140:143], v[196:199], v[112:127]
  s_waitcnt vmcnt(7)
  v_mfma_f32_32x32x16_bf16 v[96:111], a[144:147], v[200:203], v[96:111]
  buffer_load_dwordx4 v[152:155], v1, s[4:7], s41 offen offset:2048 sc1
  v_mfma_f32_32x32x16_bf16 v[112:127], a[148:151], v[200:203], v[112:127]
  s_waitcnt vmcnt(7)
  v_mfma_f32_32x32x16_bf16 v[96:111], a[152:155], v[204:207], v[96:111]
  buffer_load_dwordx4 v[156:159], v1, s[4:7], s41 offen offset:3072 sc1
  v_mfma_f32_32x32x16_bf16 v[112:127], a[156:159], v[204:207], v[112:127]
  s_waitcnt vmcnt(7)
  v_mfma_f32_32x32x16_bf16 v[96:111], a[160:163], v[128:131], v[96:111]
  buffer_load_dwordx4 v[160:163], v1, s[4:7], s40 offen sc1
  v_mfma_f32_32x32x16_bf16 v[112:127], a[164:167], v[128:131], v[112:127]
  s_waitcnt vmcnt(7)
  v_mfma_f32_32x32x16_bf16 v[96:111], a[168:171], v[132:135], v[96:111]
  buffer_load_dwordx4 v[164:167], v1, s[4:7], s40 offen offset:1024 sc1
  v_mfma_f32_32x32x16_bf16 v[112:127], a[172:175], v[132:135], v[112:127]
  s_waitcnt vmcnt(7)
  v_mfma_f32_32x32x16_bf16 v[96:111], a[176:179], v[136:139], v[96:111]
  buffer_load_dwordx4 v[168:171], v1, s[4:7], s40 offen offset:2048 sc1
  v_mfma_f32_32x32x16_bf16 v[112:127], a[180:183], v[136:139], v[112:127]
  s_waitcnt vmcnt(7)
  v_mfma_f32_32x32x16_bf16 v[96:111], a[184:187], v[140:143], v[96:111]
  buffer_load_dwordx4 v[172:175], v1, s[4:7], s40 offen offset:3072 sc1
  v_mfma_f32_32x32x16_bf16 v[112:127], a[188:191], v[140:143], v[112:127]
  s_waitcnt vmcnt(7)
  v_mfma_f32_32x32x16_bf16 v[96:111], a[192:195], v[144:147], v[96:111]
  s_add_u32 s40, s40, 4096
  buffer_load_dwordx4 v[176:179], v1, s[4:7], s40 offen sc1
  v_mfma_f32_32x32x16_bf16 v[112:127], a[196:199], v[144:147], v[112:127]
  s_waitcnt vmcnt(7)
  v_mfma_f32_32x32x16_bf16 v[96:111], a[200:203], v[148:151], v[96:111]
  buffer_load_dwordx4 v[180:183], v1, s[4:7], s40 offen offset:1024 sc1
  v_mfma_f32_32x32x16_bf16 v[112:127], a[204:207], v[148:151], v[112:127]
  s_waitcnt vmcnt(7)
  v_mfma_f32_32x32x16_bf16 v[96:111], a[208:211], v[152:155], v[96:111]
  buffer_load_dwordx4 v[184:187], v1, s[4:7], s40 offen offset:2048 sc1
  v_mfma_f32_32x32x16_bf16 v[112:127], a[212:215], v[152:155], v[112:127]
  s_waitcnt vmcnt(7)
  v_mfma_f32_32x32x16_bf16 v[96:111], a[216:219], v[156:159], v[96:111]
  buffer_load_dwordx4 v[188:191], v1, s[4:7], s40 offen offset:3072 sc1
  v_mfma_f32_32x32x16_bf16 v[112:127], a[220:223], v[156:159], v[112:127]
  s_waitcnt vmcnt(7)
  v_mfma_f32_32x32x16_bf16 v[80:95], a[4:7], v[160:163], 0
  s_add_u32 s40, s40, 4096
  buffer_load_dwordx4 v[192:195], v1, s[4:7], s40 offen sc1
  v_mfma_f32_32x32x16_bf16 v[64:79], a[0:3], v[160:163], 0
  s_waitcnt vmcnt(7)
  v_mfma_f32_32x32x16_bf16 v[80:95], a[12:15], v[164:167], v[80:95]
  buffer_load_dwordx4 v[196:199], v1, s[4:7], s40 offen offset:1024 sc1
  s_nop 1
  ds_write_b128 v61, v[96:99] offset:0
  v_mfma_f32_32x32x16_bf16 v[64:79], a[8:11], v[164:167], v[64:79]
  ds_write_b128 v61, v[100:103] offset:1024
  s_waitcnt vmcnt(7)
  v_mfma_f32_32x32x16_bf16 v[80:95], a[20:23], v[168:171], v[80:95]
  buffer_load_dwordx4 v[200:203], v1, s[4:7], s40 offen offset:2048 sc1
  ds_write_b128 v61, v[104:107] offset:2048
  v_mfma_f32_32x32x16_bf16 v[64:79], a[16:19], v[168:171], v[64:79]
  ds_write_b128 v61, v[108:111] offset:3072
  s_waitcnt vmcnt(7)
  v_mfma_f32_32x32x16_bf16 v[80:95], a[28:31], v[172:175], v[80:95]
  buffer_load_dwordx4 v[204:207], v1, s[4:7], s40 offen offset:3072 sc1
  ds_write_b128 v62, v[112:115] offset:0
  v_mfma_f32_32x32x16_bf16 v[64:79], a[24:27], v[172:175], v[64:79]
  ds_write_b128 v62, v[116:119] offset:1024
  s_waitcnt vmcnt(7)
  v_mfma_f32_32x32x16_bf16 v[80:95], a[36:39], v[176:179], v[80:95]
  s_add_u32 s40, s40, 4096
  buffer_load_dwordx4 v[128:131], v1, s[4:7], s40 offen sc1
  ds_write_b128 v62, v[120:123] offset:2048
  v_mfma_f32_32x32x16_bf16 v[64:79], a[32:35], v[176:179], v[64:79]
  ds_write_b128 v62, v[124:127] offset:3072
  s_waitcnt vmcnt(7)
  v_mfma_f32_32x32x16_bf16 v[80:95], a[44:47], v[180:183], v[80:95]
  buffer_load_dwordx4 v[132:135], v1, s[4:7], s40 offen offset:1024 sc1
  v_mfma_f32_32x32x16_bf16 v[64:79], a[40:43], v[180:183], v[64:79]
  s_waitcnt vmcnt(7)
  v_mfma_f32_32x32x16_bf16 v[80:95], a[52:55], v[184:187], v[80:95]
  buffer_load_dwordx4 v[136:139], v1, s[4:7], s40 offen offset:2048 sc1
  s_waitcnt lgkmcnt(0)
  s_barrier
  v_mfma_f32_32x32x16_bf16 v[64:79], a[48:51], v[184:187], v[64:79]
  ds_read_b128 v[208:211], v63 offset:4096
  s_waitcnt vmcnt(7)
  v_mfma_f32_32x32x16_bf16 v[80:95], a[60:63], v[188:191], v[80:95]
  buffer_load_dwordx4 v[140:143], v1, s[4:7], s40 offen offset:3072 sc1
  ds_read_b128 v[212:215], v63 offset:5120
  v_mfma_f32_32x32x16_bf16 v[64:79], a[56:59], v[188:191], v[64:79]
  ds_read_b128 v[216:219], v63 offset:6144
  s_waitcnt vmcnt(7)
  v_mfma_f32_32x32x16_bf16 v[80:95], a[68:71], v[192:195], v[80:95]
  s_add_u32 s40, s40, 4096
  buffer_load_dwordx4 v[144:147], v1, s[4:7], s40 offen sc1
  ds_read_b128 v[220:223], v63 offset:7168
  v_mfma_f32_32x32x16_bf16 v[64:79], a[64:67], v[192:195], v[64:79]
  ds_read_b128 v[224:227], v63 offset:8192
  s_waitcnt vmcnt(7)
  v_mfma_f32_32x32x16_bf16 v[80:95], a[76:79], v[196:199], v[80:95]
  buffer_load_dwordx4 v[148:151], v1, s[4:7], s40 offen offset:1024 sc1
  ds_read_b128 v[228:231], v63 offset:9216
  v_mfma_f32_32x32x16_bf16 v[64:79], a[72:75], v[196:199], v[64:79]
  ds_read_b128 v[232:235], v63 offset:10240
  s_waitcnt vmcnt(7)
  v_mfma_f32_32x32x16_bf16 v[80:95], a[84:87], v[200:203], v[80:95]
  buffer_load_dwordx4 v[152:155], v1, s[4:7], s40 offen offset:2048 sc1
  ds_read_b128 v[236:239], v63 offset:11264
  v_mfma_f32_32x32x16_bf16 v[64:79], a[80:83], v[200:203], v[64:79]
  s_waitcnt vmcnt(7)
  v_mfma_f32_32x32x16_bf16 v[80:95], a[92:95], v[204:207], v[80:95]
  buffer_load_dwordx4 v[156:159], v1, s[4:7], s40 offen offset:3072 sc1
  v_mfma_f32_32x32x16_bf16 v[64:79], a[88:91], v[204:207], v[64:79]
  s_waitcnt lgkmcnt(0)
  s_waitcnt vmcnt(7)
  v_mfma_f32_32x32x16_bf16 v[80:95], a[100:103], v[128:131], v[80:95]
  s_add_u32 s40, s40, 4096
  buffer_load_dwordx4 v[160:163], v1, s[4:7], s40 offen sc1
  v_add_f32 v208, v208, v224
  v_add_f32 v209, v209, v225
  v_add_f32 v210, v210, v226
  v_add_f32 v211, v211, v227
  v_mfma_f32_32x32x16_bf16 v[64:79], a[96:99], v[128:131], v[64:79]
  v_add_f32 v212, v212, v228
  v_add_f32 v213, v213, v229
  v_add_f32 v214, v214, v230
  v_add_f32 v215, v215, v231
  s_waitcnt vmcnt(7)
  v_mfma_f32_32x32x16_bf16 v[80:95], a[108:111], v[132:135], v[80:95]
  buffer_load_dwordx4 v[164:167], v1, s[4:7], s40 offen offset:1024 sc1
  v_add_f32 v216, v216, v232
  v_add_f32 v217, v217, v233
  v_add_f32 v218, v218, v234
  v_add_f32 v219, v219, v235
  v_mfma_f32_32x32x16_bf16 v[64:79], a[104:107], v[132:135], v[64:79]
  v_add_f32 v220, v220, v236
  v_add_f32 v221, v221, v237
  v_add_f32 v222, v222, v238
  v_add_f32 v223, v223, v239
  s_waitcnt vmcnt(7)
  v_mfma_f32_32x32x16_bf16 v[80:95], a[116:119], v[136:139], v[80:95]
  buffer_load_dwordx4 v[168:171], v1, s[4:7], s40 offen offset:2048 sc1
  v_mfma_f32_32x32x16_bf16 v[64:79], a[112:115], v[136:139], v[64:79]
  s_waitcnt vmcnt(7)
  v_mfma_f32_32x32x16_bf16 v[80:95], a[124:127], v[140:143], v[80:95]
  buffer_load_dwordx4 v[172:175], v1, s[4:7], s40 offen offset:3072 sc1
  v_mfma_f32_32x32x16_bf16 v[64:79], a[120:123], v[140:143], v[64:79]
  s_waitcnt vmcnt(7)
  v_mfma_f32_32x32x16_bf16 v[80:95], a[132:135], v[144:147], v[80:95]
  s_add_u32 s40, s40, 4096
  buffer_load_dwordx4 v[176:179], v1, s[4:7], s40 offen sc1
  v_mfma_f32_32x32x16_bf16 v[64:79], a[128:131], v[144:147], v[64:79]
  s_waitcnt vmcnt(7)
  v_mfma_f32_32x32x16_bf16 v[80:95], a[140:143], v[148:151], v[80:95]
  buffer_load_dwordx4 v[180:183], v1, s[4:7], s40 offen offset:1024 sc1
  v_mfma_f32_32x32x16_bf16 v[64:79], a[136:139], v[148:151], v[64:79]
  s_waitcnt vmcnt(7)
  v_mfma_f32_32x32x16_bf16 v[80:95], a[148:151], v[152:155], v[80:95]
  buffer_load_dwordx4 v[184:187], v1, s[4:7], s40 offen offset:2048 sc1
  v_mfma_f32_32x32x16_bf16 v[64:79], a[144:147], v[152:155], v[64:79]
  s_waitcnt vmcnt(7)
  v_mfma_f32_32x32x16_bf16 v[80:95], a[156:159], v[156:159], v[80:95]
  buffer_load_dwordx4 v[188:191], v1, s[4:7], s40 offen offset:3072 sc1
  v_mfma_f32_32x32x16_bf16 v[64:79], a[152:155], v[156:159], v[64:79]
  s_waitcnt vmcnt(7)
  v_mfma_f32_32x32x16_bf16 v[80:95], a[164:167], v[160:163], v[80:95]
  v_mfma_f32_32x32x16_bf16 v[64:79], a[160:163], v[160:163], v[64:79]
  s_waitcnt vmcnt(6)
  v_mfma_f32_32x32x16_bf16 v[80:95], a[172:175], v[164:167], v[80:95]
  v_mfma_f32_32x32x16_bf16 v[64:79], a[168:171], v[164:167], v[64:79]
  s_waitcnt vmcnt(5)
  v_mfma_f32_32x32x16_bf16 v[80:95], a[180:183], v[168:171], v[80:95]
  v_mfma_f32_32x32x16_bf16 v[64:79], a[176:179], v[168:171], v[64:79]
  s_waitcnt vmcnt(4)
  v_mfma_f32_32x32x16_bf16 v[80:95], a[188:191], v[172:175], v[80:95]
  v_mfma_f32_32x32x16_bf16 v[64:79], a[184:187], v[172:175], v[64:79]
  s_waitcnt vmcnt(3)
  v_mfma_f32_32x32x16_bf16 v[80:95], a[196:199], v[176:179], v[80:95]
  s_waitcnt vmcnt(2)
  v_mfma_f32_32x32x16_bf16 v[80:95], a[204:207], v[180:183], v[80:95]
  s_waitcnt vmcnt(1)
  v_mfma_f32_32x32x16_bf16 v[80:95], a[212:215], v[184:187], v[80:95]
  s_waitcnt vmcnt(0)
  v_mfma_f32_32x32x16_bf16 v[80:95], a[220:223], v[188:191], v[80:95]
  v_mfma_f32_32x32x16_bf16 v[64:79], a[192:195], v[176:179], v[64:79]
  v_mul_u32_u24 v5, 896, v2
  v_lshlrev_b32 v7, 4, v3
  v_add_u32 v5, v5, v7
  s_mul_i32 s30, s21, 229376
  s_mul_i32 s35, s26, 28672
  s_add_u32 s30, s30, s35
  s_lshl_b32 s35, s28, 6
  s_add_u32 s30, s30, s35
  v_mfma_f32_32x32x16_bf16 v[64:79], a[200:203], v[180:183], v[64:79]
  s_nop 1
  ds_write_b128 v60, v[80:83] offset:0
  v_mfma_f32_32x32x16_bf16 v[64:79], a[208:211], v[184:187], v[64:79]
  ds_write_b128 v60, v[84:87] offset:1024
  ds_write_b128 v60, v[88:91] offset:2048
  v_mfma_f32_32x32x16_bf16 v[64:79], a[216:219], v[188:191], v[64:79]
  ds_write_b128 v60, v[92:95] offset:3072
  s_waitcnt lgkmcnt(0)
  s_barrier
  ds_read_b128 v[240:243], v63 offset:0
  ds_read_b128 v[244:247], v63 offset:1024
  ds_read_b128 v[248:251], v63 offset:2048
  ds_read_b128 v[252:255], v63 offset:3072
  s_nop 4
  v_pk_add_f32 v[64:65], v[64:65], v[208:209]
  v_pk_add_f32 v[66:67], v[66:67], v[210:211]
  v_pk_add_f32 v[68:69], v[68:69], v[212:213]
  v_pk_add_f32 v[70:71], v[70:71], v[214:215]
  v_pk_add_f32 v[72:73], v[72:73], v[216:217]
  v_pk_add_f32 v[74:75], v[74:75], v[218:219]
  v_pk_add_f32 v[76:77], v[76:77], v[220:221]
  v_pk_add_f32 v[78:79], v[78:79], v[222:223]
  s_waitcnt lgkmcnt(0)
  v_pk_add_f32 v[64:65], v[64:65], v[240:241]
  v_pk_add_f32 v[66:67], v[66:67], v[242:243]
  v_pk_add_f32 v[68:69], v[68:69], v[244:245]
  v_pk_add_f32 v[70:71], v[70:71], v[246:247]
  v_pk_add_f32 v[72:73], v[72:73], v[248:249]
  v_pk_add_f32 v[74:75], v[74:75], v[250:251]
  v_pk_add_f32 v[76:77], v[76:77], v[252:253]
  v_pk_add_f32 v[78:79], v[78:79], v[254:255]
  v_pk_fma_f32 v[64:65], v[64:65], v[32:33], v[16:17] op_sel_hi:[1,0,1]
  v_pk_fma_f32 v[66:67], v[66:67], v[32:33], v[18:19] op_sel_hi:[1,0,1]
  v_pk_fma_f32 v[68:69], v[68:69], v[32:33], v[20:21] op_sel_hi:[1,0,1]
  v_pk_fma_f32 v[70:71], v[70:71], v[32:33], v[22:23] op_sel_hi:[1,0,1]
  v_pk_fma_f32 v[72:73], v[72:73], v[32:33], v[24:25] op_sel_hi:[1,0,1]
  v_pk_fma_f32 v[74:75], v[74:75], v[32:33], v[26:27] op_sel_hi:[1,0,1]
  v_pk_fma_f32 v[76:77], v[76:77], v[32:33], v[28:29] op_sel_hi:[1,0,1]
  v_pk_fma_f32 v[78:79], v[78:79], v[32:33], v[30:31] op_sel_hi:[1,0,1]
  v_cvt_pk_bf16_f32 v8, v64, v65
  v_cvt_pk_bf16_f32 v9, v66, v67
  v_cvt_pk_bf16_f32 v10, v68, v69
  v_cvt_pk_bf16_f32 v11, v70, v71
  v_cvt_pk_bf16_f32 v12, v72, v73
  v_cvt_pk_bf16_f32 v13, v74, v75
  v_cvt_pk_bf16_f32 v14, v76, v77
  v_cvt_pk_bf16_f32 v15, v78, v79
  v_permlane32_swap_b32 v8, v10
  v_permlane32_swap_b32 v9, v11
  v_permlane32_swap_b32 v12, v14
  v_permlane32_swap_b32 v13, v15
  buffer_store_dwordx4 v[8:11], v5, s[8:11], s30 offen
  buffer_store_dwordx4 v[12:15], v5, s[8:11], s30 offen offset:32
mk_end:
  s_endpgm
mk_idle:
  s_sub_u32 s32, s22, 28
  s_mul_i32 s30, s32, 229376
  s_mul_i32 s35, s20, 57344
  s_add_u32 s30, s30, s35
  s_add_u32 s30, s30, 458752
  v_lshlrev_b32 v4, 3, v1
  buffer_load_dword v60, v4, s[4:7], s30 offen sc1
  s_add_u32 s30, s30, 8192
  buffer_load_dword v60, v4, s[4:7], s30 offen sc1
  s_add_u32 s30, s30, 8192
  buffer_load_dword v60, v4, s[4:7], s30 offen sc1
  s_add_u32 s30, s30, 8192
  buffer_load_dword v60, v4, s[4:7], s30 offen sc1
  s_add_u32 s30, s30, 8192
  buffer_load_dword v60, v4, s[4:7], s30 offen sc1
  s_add_u32 s30, s30, 8192
  buffer_load_dword v60, v4, s[4:7], s30 offen sc1
  s_add_u32 s30, s30, 8192
  buffer_load_dword v60, v4, s[4:7], s30 offen sc1
  s_add_u32 s30, s30, 8192
  s_mul_i32 s30, s32, 114688
  s_mul_i32 s35, s20, 28672
  s_add_u32 s30, s30, s35
  v_lshlrev_b32 v4, 3, v1
  buffer_load_dword v60, v4, s[4:7], s30 offen sc1
  s_add_u32 s30, s30, 8192
  buffer_load_dword v60, v4, s[4:7], s30 offen sc1
  s_add_u32 s30, s30, 8192
  buffer_load_dword v60, v4, s[4:7], s30 offen sc1
  s_add_u32 s30, s30, 8192
  buffer_load_dword v60, v4, s[4:7], s30 offen sc1
  s_add_u32 s30, s30, 8192
  s_mul_i32 s30, s24, 28672
  s_lshl_b32 s35, s20, 10
  s_add_u32 s30, s30, s35
  s_add_u32 s30, s30, 458752
  s_lshl_b32 s44, s20, 11
  s_add_u32 m0, s44, 0
  s_add_u32 s35, s30, 0
  buffer_load_dwordx4 v1, s[4:7], s35 offen sc1 lds
  s_add_u32 m0, s44, 1024
  s_add_u32 s35, s30, 458752
  buffer_load_dwordx4 v1, s[4:7], s35 offen sc1 lds
  s_add_u32 m0, s44, 8192
  s_add_u32 s35, s30, 4096
  buffer_load_dwordx4 v1, s[4:7], s35 offen sc1 lds
  s_add_u32 m0, s44, 9216
  s_add_u32 s35, s30, 462848
  buffer_load_dwordx4 v1, s[4:7], s35 offen sc1 lds
  s_add_u32 m0, s44, 16384
  s_add_u32 s35, s30, 8192
  buffer_load_dwordx4 v1, s[4:7], s35 offen sc1 lds
  s_add_u32 m0, s44, 17408
  s_add_u32 s35, s30, 466944
  buffer_load_dwordx4 v1, s[4:7], s35 offen sc1 lds
  s_add_u32 m0, s44, 24576
  s_add_u32 s35, s30, 12288
  buffer_load_dwordx4 v1, s[4:7], s35 offen sc1 lds
  s_add_u32 m0, s44, 25600
  s_add_u32 s35, s30, 471040
  buffer_load_dwordx4 v1, s[4:7], s35 offen sc1 lds
  s_add_u32 m0, s44, 32768
  s_add_u32 s35, s30, 16384
  buffer_load_dwordx4 v1, s[4:7], s35 offen sc1 lds
  s_add_u32 m0, s44, 33792
  s_add_u32 s35, s30, 475136
  buffer_load_dwordx4 v1, s[4:7], s35 offen sc1 lds
  s_add_u32 m0, s44, 40960
  s_add_u32 s35, s30, 20480
  buffer_load_dwordx4 v1, s[4:7], s35 offen sc1 lds
  s_add_u32 m0, s44, 41984
  s_add_u32 s35, s30, 479232
  buffer_load_dwordx4 v1, s[4:7], s35 offen sc1 lds
  s_add_u32 m0, s44, 49152
  s_add_u32 s35, s30, 24576
  buffer_load_dwordx4 v1, s[4:7], s35 offen sc1 lds
  s_add_u32 m0, s44, 50176
  s_add_u32 s35, s30, 483328
  buffer_load_dwordx4 v1, s[4:7], s35 offen sc1 lds
  s_mul_i32 s30, s32, 114688
  s_mul_i32 s35, s20, 28672
  s_add_u32 s30, s30, s35
  s_add_u32 s30, s30, 1376256
  v_lshlrev_b32 v4, 3, v1
  buffer_load_dword v60, v4, s[4:7], s30 offen sc1
  s_add_u32 s30, s30, 8192
  buffer_load_dword v60, v4, s[4:7], s30 offen sc1
  s_add_u32 s30, s30, 8192
  buffer_load_dword v60, v4, s[4:7], s30 offen sc1
  s_add_u32 s30, s30, 8192
  buffer_load_dword v60, v4, s[4:7], s30 offen sc1
  s_add_u32 s30, s30, 8192
  s_mul_i32 s30, s32, 200704
  s_mul_i32 s35, s20, 50176
  s_add_u32 s30, s30, s35
  v_lshlrev_b32 v4, 3, v1
  buffer_load_dword v60, v4, s[60:63], s30 offen sc1
  s_add_u32 s30, s30, 8192
  buffer_load_dword v60, v4, s[60:63], s30 offen sc1
  s_add_u32 s30, s30, 8192
  buffer_load_dword v60, v4, s[60:63], s30 offen sc1
  s_add_u32 s30, s30, 8192
  buffer_load_dword v60, v4, s[60:63], s30 offen sc1
  s_add_u32 s30, s30, 8192
  buffer_load_dword v60, v4, s[60:63], s30 offen sc1
  s_add_u32 s30, s30, 8192
  buffer_load_dword v60, v4, s[60:63], s30 offen sc1
  s_add_u32 s30, s30, 8192
  buffer_load_dword v60, v4, s[60:63], s30 offen sc1
  s_add_u32 s30, s30, 8192
  v_lshlrev_b32 v47, 3, v2
  v_mov_b32 v4, 0x7fffff00
  v_cmp_eq_u32 vcc, 1, v3
  s_nop 1
  v_cndmask_b32 v47, v47, v4, vcc
  s_lshl_b32 s31, s24, 8
  s_add_u32 s31, s31, 3735552
  s_add_u32 s32, s31, 4096
  buffer_load_dwordx2 v[48:49], v47, s[4:7], s32 offen sc1
  v_mov_b32 v50, 0
  v_mov_b32 v51, 0
  s_add_u32 s32, s31, 8192
  buffer_load_dwordx2 v[52:53], v47, s[4:7], s32 offen sc1
  v_mov_b32 v54, 0
  v_mov_b32 v55, 0
  s_add_u32 s32, s31, 0
  buffer_load_dwordx2 v[56:57], v47, s[4:7], s32 offen sc1
  v_mov_b32 v58, 0
  v_mov_b32 v59, 0
  s_mov_b32 s16, 1
  s_add_u32 s57, s57, 4096
  s_mov_b32 s47, 12582912
  s_mov_b32 s48, 3833856
  s_mov_b64 s[52:53], 0
  v_lshrrev_b32 v7, 1, v1
  v_add_u32 v63, 0x10000, v1
  s_lshl_b32 s56, s25, 7
  s_add_u32 s56, s56, s57
  s_add_u32 s56, s56, 1245184
  s_mul_i32 s40, s25, 28672
  s_add_u32 s40, s40, s18
  s_lshl_b32 s45, s25, 9
  s_add_u32 s45, s45, s18
  s_add_u32 s45, s45, 1179648
  s_mul_i32 s42, s24, 28672
  s_lshl_b32 s35, s20, 10
  s_add_u32 s42, s42, s35
  s_lshl_b32 s44, s20, 10
  s_lshl_b32 s38, s24, 18
  s_lshl_b32 s35, s23, 14
  s_add_u32 s38, s38, s35
  s_lshl_b32 s35, s20, 12
  s_add_u32 s38, s38, s35
  s_add_u32 s38, s38, s47
  s_lshl_b32 s37, s24, 11
  s_lshl_b32 s35, s23, 7
  s_add_u32 s37, s37, s35
  s_add_u32 s37, s37, s48
  s_mov_b32 exec_lo, 0x1
  s_mov_b32 exec_hi, 0x0
  s_mov_b32 s36, 0
mk_pl78:
  s_sleep 4
  buffer_load_dwordx2 v[4:5], v7, s[4:7], s56 offen sc1
  s_add_u32 s36, s36, 1
  s_cmp_ge_u32 s36, 0x40000
  s_cbranch_scc1 mk_end
  s_waitcnt vmcnt(0)
  v_cmp_ne_u64 vcc, s[58:59], v[4:5]
  s_cbranch_vccnz mk_pl78
  s_mov_b64 exec, -1
  s_barrier
  s_branch mk_layer
mk_fbk8:
  s_lshl_b32 s30, s24, 18
  s_add_u32 s30, s30, s47
  s_mov_b32 s31, 0
  v_mov_b32 v56, 0xff800000
  v_mov_b32 v64, 0
  v_mov_b32 v65, 0
  v_mov_b32 v66, 0
  v_mov_b32 v67, 0
  v_mov_b32 v68, 0
  v_mov_b32 v69, 0
  v_mov_b32 v70, 0
  v_mov_b32 v71, 0
  v_mov_b32 v72, 0
  v_mov_b32 v73, 0
  v_mov_b32 v74, 0
  v_mov_b32 v75, 0
  v_mov_b32 v76, 0
  v_mov_b32 v77, 0
  v_mov_b32 v78, 0
  v_mov_b32 v79, 0
mk_fb80:
  buffer_load_dwordx4 v[176:179], v1, s[4:7], s30 offen offset:0 sc1
  buffer_load_dwordx4 v[180:183], v1, s[4:7], s30 offen offset:1024 sc1
  buffer_load_dwordx4 v[184:187], v1, s[4:7], s30 offen offset:2048 sc1
  buffer_load_dwordx4 v[188:191], v1, s[4:7], s30 offen offset:3072 sc1
  s_waitcnt vmcnt(0)
  v_mfma_f32_32x32x16_bf16 v[16:31], v[176:179], a[224:227], 0
  v_mfma_f32_32x32x16_bf16 v[16:31], v[180:183], a[228:231], v[16:31]
  s_nop 11
  v_max3_f32 v57, v16, v17, v56
  v_max3_f32 v57, v18, v19, v57
  v_max3_f32 v57, v20, v21, v57
  v_max3_f32 v57, v22, v23, v57
  v_max3_f32 v57, v24, v25, v57
  v_max3_f32 v57, v26, v27, v57
  v_max3_f32 v57, v28, v29, v57
  v_max3_f32 v57, v30, v31, v57
  v_mov_b32 v58, v57
  s_nop 1
  v_permlane32_swap_b32 v57, v58
  v_max_f32 v57, v57, v58
  v_sub_f32 v58, v56, v57
  v_exp_f32 v58, v58
  v_mov_b32 v56, v57
  v_sub_f32 v16, v16, v57
  v_exp_f32 v16, v16
  v_sub_f32 v17, v17, v57
  v_exp_f32 v17, v17
  v_sub_f32 v18, v18, v57
  v_exp_f32 v18, v18
  v_sub_f32 v19, v19, v57
  v_exp_f32 v19, v19
  v_sub_f32 v20, v20, v57
  v_exp_f32 v20, v20
  v_sub_f32 v21, v21, v57
  v_exp_f32 v21, v21
  v_sub_f32 v22, v22, v57
  v_exp_f32 v22, v22
  v_sub_f32 v23, v23, v57
  v_exp_f32 v23, v23
  v_sub_f32 v24, v24, v57
  v_exp_f32 v24, v24
  v_sub_f32 v25, v25, v57
  v_exp_f32 v25, v25
  v_sub_f32 v26, v26, v57
  v_exp_f32 v26, v26
  v_sub_f32 v27, v27, v57
  v_exp_f32 v27, v27
  v_sub_f32 v28, v28, v57
  v_exp_f32 v28, v28
  v_sub_f32 v29, v29, v57
  v_exp_f32 v29, v29
  v_sub_f32 v30, v30, v57
  v_exp_f32 v30, v30
  v_sub_f32 v31, v31, v57
  v_exp_f32 v31, v31
  v_mul_f32 v64, v64, v58
  v_mul_f32 v65, v65, v58
  v_mul_f32 v66, v66, v58
  v_mul_f32 v67, v67, v58
  v_mul_f32 v68, v68, v58
  v_mul_f32 v69, v69, v58
  v_mul_f32 v70, v70, v58
  v_mul_f32 v71, v71, v58
  v_mul_f32 v72, v72, v58
  v_mul_f32 v73, v73, v58
  v_mul_f32 v74, v74, v58
  v_mul_f32 v75, v75, v58
  v_mul_f32 v76, v76, v58
  v_mul_f32 v77, v77, v58
  v_mul_f32 v78, v78, v58
  v_mul_f32 v79, v79, v58
  v_cvt_pk_bf16_f32 v48, v16, v17
  v_cvt_pk_bf16_f32 v49, v18, v19
  v_cvt_pk_bf16_f32 v50, v20, v21
  v_cvt_pk_bf16_f32 v51, v22, v23
  v_cvt_pk_bf16_f32 v52, v24, v25
  v_cvt_pk_bf16_f32 v53, v26, v27
  v_cvt_pk_bf16_f32 v54, v28, v29
  v_cvt_pk_bf16_f32 v55, v30, v31
  v_mfma_f32_32x32x16_bf16 v[64:79], v[184:187], v[48:51], v[64:79]
  s_nop 0
  v_mfma_f32_32x32x16_bf16 v[64:79], v[188:191], v[52:55], v[64:79]
  s_add_u32 s30, s30, 4096
  s_add_u32 s31, s31, 1
  s_cmp_lt_u32 s31, 64
  s_nop 15
  s_cbranch_scc1 mk_fb80
  v_mov_b32 v4, v76
  v_mov_b32 v5, v76
  s_nop 1
  v_permlane32_swap_b32 v4, v5
  s_nop 1
  s_branch mk_ok7
mk_fbk51:
  s_lshl_b32 s30, s24, 18
  s_add_u32 s30, s30, s47
  s_mov_b32 s31, 0
  v_mov_b32 v56, 0xff800000
  v_mov_b32 v64, 0
  v_mov_b32 v65, 0
  v_mov_b32 v66, 0
  v_mov_b32 v67, 0
  v_mov_b32 v68, 0
  v_mov_b32 v69, 0
  v_mov_b32 v70, 0
  v_mov_b32 v71, 0
  v_mov_b32 v72, 0
  v_mov_b32 v73, 0
  v_mov_b32 v74, 0
  v_mov_b32 v75, 0
  v_mov_b32 v76, 0
  v_mov_b32 v77, 0
  v_mov_b32 v78, 0
  v_mov_b32 v79, 0
mk_fb81:
  buffer_load_dwordx4 v[176:179], v1, s[4:7], s30 offen offset:0 sc1
  buffer_load_dwordx4 v[180:183], v1, s[4:7], s30 offen offset:1024 sc1
  buffer_load_dwordx4 v[184:187], v1, s[4:7], s30 offen offset:2048 sc1
  buffer_load_dwordx4 v[188:191], v1, s[4:7], s30 offen offset:3072 sc1
  s_waitcnt vmcnt(0)
  v_mfma_f32_32x32x16_bf16 v[16:31], v[176:179], a[224:227], 0
  v_mfma_f32_32x32x16_bf16 v[16:31], v[180:183], a[228:231], v[16:31]
  s_nop 11
  v_max3_f32 v57, v16, v17, v56
  v_max3_f32 v57, v18, v19, v57
  v_max3_f32 v57, v20, v21, v57
  v_max3_f32 v57, v22, v23, v57
  v_max3_f32 v57, v24, v25, v57
  v_max3_f32 v57, v26, v27, v57
  v_max3_f32 v57, v28, v29, v57
  v_max3_f32 v57, v30, v31, v57
  v_mov_b32 v58, v57
  s_nop 1
  v_permlane32_swap_b32 v57, v58
  v_max_f32 v57, v57, v58
  v_sub_f32 v58, v56, v57
  v_exp_f32 v58, v58
  v_mov_b32 v56, v57
  v_sub_f32 v16, v16, v57
  v_exp_f32 v16, v16
  v_sub_f32 v17, v17, v57
  v_exp_f32 v17, v17
  v_sub_f32 v18, v18, v57
  v_exp_f32 v18, v18
  v_sub_f32 v19, v19, v57
  v_exp_f32 v19, v19
  v_sub_f32 v20, v20, v57
  v_exp_f32 v20, v20
  v_sub_f32 v21, v21, v57
  v_exp_f32 v21, v21
  v_sub_f32 v22, v22, v57
  v_exp_f32 v22, v22
  v_sub_f32 v23, v23, v57
  v_exp_f32 v23, v23
  v_sub_f32 v24, v24, v57
  v_exp_f32 v24, v24
  v_sub_f32 v25, v25, v57
  v_exp_f32 v25, v25
  v_sub_f32 v26, v26, v57
  v_exp_f32 v26, v26
  v_sub_f32 v27, v27, v57
  v_exp_f32 v27, v27
  v_sub_f32 v28, v28, v57
  v_exp_f32 v28, v28
  v_sub_f32 v29, v29, v57
  v_exp_f32 v29, v29
  v_sub_f32 v30, v30, v57
  v_exp_f32 v30, v30
  v_sub_f32 v31, v31, v57
  v_exp_f32 v31, v31
  v_mul_f32 v64, v64, v58
  v_mul_f32 v65, v65, v58
  v_mul_f32 v66, v66, v58
  v_mul_f32 v67, v67, v58
  v_mul_f32 v68, v68, v58
  v_mul_f32 v69, v69, v58
  v_mul_f32 v70, v70, v58
  v_mul_f32 v71, v71, v58
  v_mul_f32 v72, v72, v58
  v_mul_f32 v73, v73, v58
  v_mul_f32 v74, v74, v58
  v_mul_f32 v75, v75, v58
  v_mul_f32 v76, v76, v58
  v_mul_f32 v77, v77, v58
  v_mul_f32 v78, v78, v58
  v_mul_f32 v79, v79, v58
  v_cvt_pk_bf16_f32 v48, v16, v17
  v_cvt_pk_bf16_f32 v49, v18, v19
  v_cvt_pk_bf16_f32 v50, v20, v21
  v_cvt_pk_bf16_f32 v51, v22, v23
  v_cvt_pk_bf16_f32 v52, v24, v25
  v_cvt_pk_bf16_f32 v53, v26, v27
  v_cvt_pk_bf16_f32 v54, v28, v29
  v_cvt_pk_bf16_f32 v55, v30, v31
  v_mfma_f32_32x32x16_bf16 v[64:79], v[184:187], v[48:51], v[64:79]
  s_nop 0
  v_mfma_f32_32x32x16_bf16 v[64:79], v[188:191], v[52:55], v[64:79]
  s_add_u32 s30, s30, 4096
  s_add_u32 s31, s31, 1
  s_cmp_lt_u32 s31, 64
  s_nop 15
  s_cbranch_scc1 mk_fb81
  v_mov_b32 v4, v76
  v_mov_b32 v5, v76
  s_nop 1
  v_permlane32_swap_b32 v4, v5
  s_nop 1
  s_branch mk_ok50
mk_fss:
  s_mov_b32 exec_lo, 0xffffffff
  s_mov_b32 exec_hi, 0xffffffff
  s_mov_b32 s36, 0
mk_pl82:
  s_sleep 1
  buffer_load_dwordx2 v[4:5], v56, s[4:7], s56 offen sc1
  s_add_u32 s36, s36, 1
  s_cmp_ge_u32 s36, 0x40000
  s_cbranch_scc1 mk_end
  s_waitcnt vmcnt(0)
  v_cmp_ne_u64 vcc, s[58:59], v[4:5]
  s_cbranch_vccnz mk_pl82
  s_mov_b64 exec, -1
  s_mov_b32 s34, 8
  s_mov_b32 exec_lo, 0xffffffff
  s_mov_b32 exec_hi, 0xffffffff
  s_mov_b32 s36, 0
mk_pl84:
  s_sleep 1
  buffer_load_dwordx2 v[4:5], v56, s[4:7], s34 offen sc1
  s_add_u32 s36, s36, 1
  s_cmp_ge_u32 s36, 0x40000
  s_cbranch_scc1 mk_end
  s_waitcnt vmcnt(0)
  v_cmp_ne_u64 vcc, s[58:59], v[4:5]
  s_cbranch_vccnz mk_pl84
  s_mov_b64 exec, -1
  v_not_b32 v4, s58
  s_branch mk_fsr
mk_fs3:
  s_mov_b32 exec_lo, 0xf0
  s_mov_b32 exec_hi, 0x0
  s_mov_b32 s36, 0
mk_pl86:
  s_sleep 1
  buffer_load_dwordx2 v[4:5], v57, s[4:7], s56 offen sc1
  s_add_u32 s36, s36, 1
  s_cmp_ge_u32 s36, 0x40000
  s_cbranch_scc1 mk_end
  s_waitcnt vmcnt(0)
  v_cmp_ne_u64 vcc, s[58:59], v[4:5]
  s_cbranch_vccnz mk_pl86
  s_mov_b64 exec, -1
  s_branch mk_fr4
mk_fs5:
  s_mov_b32 exec_lo, 0xff00
  s_mov_b32 exec_hi, 0x0
  s_mov_b32 s36, 0
mk_pl88:
  s_sleep 1
  buffer_load_dwordx2 v[4:5], v57, s[4:7], s56 offen sc1
  s_add_u32 s36, s36, 1
  s_cmp_ge_u32 s36, 0x40000
  s_cbranch_scc1 mk_end
  s_waitcnt vmcnt(0)
  v_cmp_ne_u64 vcc, s[58:59], v[4:5]
  s_cbranch_vccnz mk_pl88
  s_mov_b64 exec, -1
  s_branch mk_fr6
mk_fs46:
  s_mov_b32 exec_lo, 0xf0
  s_mov_b32 exec_hi, 0x0
  s_mov_b32 s36, 0
mk_pl90:
  s_sleep 1
  buffer_load_dwordx2 v[4:5], v57, s[4:7], s56 offen sc1
  s_add_u32 s36, s36, 1
  s_cmp_ge_u32 s36, 0x40000
  s_cbranch_scc1 mk_end
  s_waitcnt vmcnt(0)
  v_cmp_ne_u64 vcc, s[58:59], v[4:5]
  s_cbranch_vccnz mk_pl90
  s_mov_b64 exec, -1
  s_branch mk_fr47
mk_fs48:
  s_mov_b32 exec_lo, 0xff00
  s_mov_b32 exec_hi, 0x0
  s_mov_b32 s36, 0
mk_pl92:
  s_sleep 1
  buffer_load_dwordx2 v[4:5], v57, s[4:7], s56 offen sc1
  s_add_u32 s36, s36, 1
  s_cmp_ge_u32 s36, 0x40000
  s_cbranch_scc1 mk_end
  s_waitcnt vmcnt(0)
  v_cmp_ne_u64 vcc, s[58:59], v[4:5]
  s_cbranch_vccnz mk_pl92
  s_mov_b64 exec, -1
  s_branch mk_fr49
mk_sg9:
  s_nop 7
  s_nop 3
  buffer_store_dwordx4 v[48:51], v1, s[4:7], s38 offen sc1
  buffer_store_dwordx4 v[52:55], v1, s[4:7], s38 offen offset:1024 sc1
  s_nop 1
  s_branch mk_sd10
mk_sg11:
  s_nop 7
  s_nop 3
  buffer_store_dwordx2 v[4:5], v1, s[4:7], s51 offen sc1
  s_nop 1
  s_branch mk_sd12
mk_sg15:
  s_nop 7
  s_nop 3
  buffer_store_dwordx4 v[8:11], v1, s[4:7], s38 offen sc1
  buffer_store_dwordx4 v[12:15], v1, s[4:7], s38 offen offset:1024 sc1
  s_nop 1
  s_branch mk_sd16
mk_sg17:
  s_nop 7
  s_nop 3
  buffer_store_dwordx2 v[20:21], v7, s[4:7], s39 offen sc1
  s_nop 1
  s_branch mk_sd18
mk_sg19:
  s_nop 7
  s_nop 3
  buffer_store_dwordx2 v[4:5], v1, s[4:7], s51 offen sc1
  s_nop 1
  s_branch mk_sd20
mk_sg23:
  s_nop 7
  s_nop 3
  buffer_store_dwordx4 v[64:67], v1, s[4:7], s38 offen sc1
  buffer_store_dwordx4 v[68:71], v1, s[4:7], s38 offen offset:1024 sc1
  s_nop 1
  s_branch mk_sd24
mk_sg25:
  s_nop 7
  s_nop 3
  buffer_store_dwordx4 v[80:83], v1, s[4:7], s38 offen offset:2048 sc1
  buffer_store_dwordx4 v[84:87], v1, s[4:7], s38 offen offset:3072 sc1
  s_nop 1
  s_branch mk_sd26
mk_sg27:
  s_nop 7
  s_nop 3
  buffer_store_dwordx4 v[96:99], v1, s[4:7], s39 offen sc1
  buffer_store_dwordx4 v[100:103], v1, s[4:7], s39 offen offset:1024 sc1
  s_nop 1
  s_branch mk_sd28
mk_sg29:
  s_nop 7
  s_nop 3
  buffer_store_dwordx4 v[112:115], v1, s[4:7], s39 offen offset:2048 sc1
  buffer_store_dwordx4 v[116:119], v1, s[4:7], s39 offen offset:3072 sc1
  s_nop 1
  s_branch mk_sd30
mk_sg31:
  s_nop 7
  s_nop 3
  buffer_store_dwordx2 v[4:5], v1, s[4:7], s51 offen sc1
  s_nop 1
  s_branch mk_sd32
mk_sg35:
  s_nop 7
  s_nop 3
  buffer_store_dwordx4 v[8:11], v1, s[4:7], s38 offen sc1
  buffer_store_dwordx4 v[12:15], v1, s[4:7], s38 offen offset:1024 sc1
  s_nop 1
  s_branch mk_sd36
mk_sg37:
  s_nop 7
  s_nop 3
  buffer_store_dwordx2 v[36:37], v7, s[4:7], s39 offen sc1
  s_nop 1
  s_branch mk_sd38
mk_sg39:
  s_nop 7
  s_nop 3
  buffer_store_dwordx2 v[4:5], v1, s[4:7], s51 offen sc1
  s_nop 1
  s_branch mk_sd40
mk_sg52:
  s_nop 7
  s_nop 3
  buffer_store_dwordx4 v[48:51], v1, s[4:7], s38 offen sc1
  buffer_store_dwordx4 v[52:55], v1, s[4:7], s38 offen offset:1024 sc1
  s_nop 1
  s_branch mk_sd53
mk_sg54:
  s_nop 7
  s_nop 3
  buffer_store_dwordx2 v[4:5], v1, s[4:7], s51 offen sc1
  s_nop 1
  s_branch mk_sd55
mk_sg58:
  s_nop 7
  s_nop 3
  buffer_store_dwordx4 v[8:11], v1, s[4:7], s38 offen sc1
  buffer_store_dwordx4 v[12:15], v1, s[4:7], s38 offen offset:1024 sc1
  s_nop 1
  s_branch mk_sd59
mk_sg60:
  s_nop 7
  s_nop 3
  buffer_store_dwordx2 v[20:21], v7, s[4:7], s39 offen sc1
  s_nop 1
  s_branch mk_sd61
mk_sg62:
  s_nop 7
  s_nop 3
  buffer_store_dwordx2 v[4:5], v1, s[4:7], s51 offen sc1
  s_nop 1
  s_branch mk_sd63
mk_sg66:
  s_nop 7
  s_nop 3
  buffer_store_dwordx4 v[64:67], v1, s[4:7], s38 offen sc1
  buffer_store_dwordx4 v[68:71], v1, s[4:7], s38 offen offset:1024 sc1
  s_nop 1
  s_branch mk_sd67
mk_sg68:
  s_nop 7
  s_nop 3
  buffer_store_dwordx4 v[80:83], v1, s[4:7], s38 offen offset:2048 sc1
  buffer_store_dwordx4 v[84:87], v1, s[4:7], s38 offen offset:3072 sc1
  s_nop 1
  s_branch mk_sd69
mk_sg70:
  s_nop 7
  s_nop 3
  buffer_store_dwordx4 v[96:99], v1, s[4:7], s39 offen sc1
  buffer_store_dwordx4 v[100:103], v1, s[4:7], s39 offen offset:1024 sc1
  s_nop 1
  s_branch mk_sd71
mk_sg72:
  s_nop 7
  s_nop 3
  buffer_store_dwordx4 v[112:115], v1, s[4:7], s39 offen offset:2048 sc1
  buffer_store_dwordx4 v[116:119], v1, s[4:7], s39 offen offset:3072 sc1
  s_nop 1
  s_branch mk_sd73
mk_sg74:
  s_nop 7
  s_nop 3
  buffer_store_dwordx2 v[4:5], v1, s[4:7], s51 offen sc1
  s_nop 1
  s_branch mk_sd75
mk_last:
  s_endpgm
.section .rodata,"a"
.p2align 6
.amdhsa_kernel interleave_layers__mha_block__dense_activation_relu__prompt_kernel
  .amdhsa_next_free_vgpr 512
  .amdhsa_next_free_sgpr 102
  .amdhsa_accum_offset 256
  .amdhsa_group_segment_fixed_size 0
  .amdhsa_kernarg_size 72
  .amdhsa_user_sgpr_count 2
  .amdhsa_user_sgpr_kernarg_segment_ptr 1
  .amdhsa_system_sgpr_workgroup_id_x 1
.end_amdhsa_kernel
```
